```python
import torch

def _softmax(x, axis=-1):
    return torch.softmax(x, dim=axis)
def _gelu(x):
    return torch.nn.functional.gelu(x, approximate="tanh")
def _silu(x):
    return torch.nn.functional.silu(x)
def _sigmoid(x):
    return torch.sigmoid(x)
def _layernorm(x, axis=-1, eps=1e-5):
    m = x.mean(dim=axis, keepdim=True)
    v = x.var(dim=axis, keepdim=True, unbiased=False)
    return (x - m) / torch.sqrt(v + eps)
def _scatter_add(tgt, idx, src, axis=0):
    return tgt.clone().index_add_(axis, idx, src)
def _segment_sum(src, seg, n):
    out = torch.zeros((n,) + src.shape[1:], dtype=src.dtype)
    return out.index_add_(0, seg, src)
def _pad(x, pw):
    flat = tuple(v for pair in reversed(pw) for v in pair)
    return torch.nn.functional.pad(x, flat)

kernel_name = 'recurrent_scan__sliding_block_cached__dense_activation_squared_relu__prompt'

def setup_inputs():

    _w = (lambda a: (lambda t: t.to(torch.bfloat16) if t.is_floating_point() else t)(torch.as_tensor(a)))
    def _A_setup():
        B, Sq, D = 1, 2048, 1024
        Hq, Hkv, Sk, Dh = 32, 4, 2048, 128
        assert Hq % Hkv == 0, (Hq, Hkv)
        return {
            "x": _w((lambda *s: torch.randn(*s, dtype=torch.bfloat16) * 0.05)(B, Sq, D)),
            "k_cache": _w((lambda *s: torch.randn(*s, dtype=torch.bfloat16) * 0.8)(B, Hkv, Sk, Dh)),
            "v_cache": _w((lambda *s: torch.randn(*s, dtype=torch.bfloat16) * 0.2)(B, Hkv, Sk, Dh)),
            "wq": _w((lambda *s: torch.randn(*s, dtype=torch.bfloat16) * 0.8)(D, Hq * Dh) * (D ** -0.5)),
            "wo": _w((lambda *s: torch.randn(*s, dtype=torch.bfloat16) * 0.2)(Hq * Dh, D) * ((Hq * Dh) ** -0.5)),
        }
    _A_in = _A_setup()

    def _B_setup():
        B, S, D, F = 1, 2048, 1024, 3584
        return {
            "x": _w((lambda *s: torch.randn(*s, dtype=torch.bfloat16) * 0.05)(B, S, D)),
            "w1": _w((lambda *s: torch.randn(*s, dtype=torch.bfloat16) * 0.1)(D, F)),
            "b1": _w((lambda *s: torch.randn(*s, dtype=torch.bfloat16) * 0.1)(F)),
            "w2": _w((lambda *s: torch.randn(*s, dtype=torch.bfloat16) * 0.1)(F, D)),
            "b2": _w((lambda *s: torch.randn(*s, dtype=torch.bfloat16) * 0.1)(D)),
        }
    _B_in = _B_setup()

    return {
        "A_x": _A_in["x"],
        "A_k_cache": _A_in["k_cache"],
        "A_v_cache": _A_in["v_cache"],
        "A_wq": _A_in["wq"],
        "A_wo": _A_in["wo"],
        "B_x": _B_in["x"],
        "B_w1": _B_in["w1"],
        "B_b1": _B_in["b1"],
        "B_w2": _B_in["w2"],
        "B_b2": _B_in["b2"],
    }

def reference(A_x, A_k_cache, A_v_cache, A_wq, A_wo, B_x, B_w1, B_b1, B_w2, B_b2):
    def _A_ref(x, k_cache, v_cache, wq, wo):
        B, Sq, D = x.shape
        Hq, Dh = 32, 128
        Hkv, Sk = k_cache.shape[1], k_cache.shape[2]
        W = min(4096, max(256, Sk // 4))
        rep = Hq // Hkv
        q = (lambda x, *d: x.permute(*d))((x @ wq).reshape(B, Sq, Hq, Dh), 0, 2, 1, 3)
        k = (lambda x, n, axis: torch.repeat_interleave(x, n, dim=axis))(k_cache[:, :, Sk - W:, :], rep, axis=1)
        v = (lambda x, n, axis: torch.repeat_interleave(x, n, dim=axis))(v_cache[:, :, Sk - W:, :], rep, axis=1)
        scores = torch.einsum("bhqd,bhkd->bhqk", q, k) * (Dh ** -0.5)
        p = _softmax(scores, axis=-1)
        o = torch.einsum("bhqk,bhkd->bhqd", p, v)
        return (lambda x, *d: x.permute(*d))(o, 0, 2, 1, 3).reshape(B, Sq, Hq * Dh) @ wo

    def _B_ref(x, w1, b1, w2, b2):
        h = torch.einsum("bsd,df->bsf", x, w1) + b1
        zero = torch.zeros_like(h)
        r = torch.where(h > zero, h, zero)
        h = r * r
        out = torch.einsum("bsf,fd->bsd", h, w2) + b2
        return out

    x = A_x
    xn = _layernorm(x, axis=-1)
    s = _A_ref(xn, A_k_cache, A_v_cache, A_wq, A_wo)
    g = _silu(_B_ref(xn, B_w1, B_b1, B_w2, B_b2))
    return x + s * g
```

```asm
; @launch kernel=pa_kernel grid=(256,1,1) block=(256,1,1) lds=139776
.amdgcn_target "amdgcn-amd-amdhsa--gfx950"
.text
.globl pa_kernel
.p2align 8
.type pa_kernel,@function
pa_kernel:
pa_start:
    s_cmp_ge_u32 s2, 256
    s_cbranch_scc1 pa_done
    s_load_dwordx2 s[4:5], s[0:1], 24
    s_load_dwordx4 s[88:91], s[0:1], 48
    s_load_dwordx2 s[6:7], s[0:1], 96
    s_load_dwordx2 s[92:93], s[0:1], 32
    s_load_dwordx2 s[94:95], s[0:1], 64
    s_load_dwordx2 s[96:97], s[0:1], 0
    s_load_dwordx4 s[52:55], s[0:1], 8
    s_load_dwordx2 s[56:57], s[0:1], 88
    v_lshrrev_b32 v245, 6, v0
    v_and_b32 v240, 63, v0
    v_readfirstlane_b32 s3, v245
    s_and_b32 s40, s2, 7
    s_lshr_b32 s41, s2, 3
    s_lshl_b32 s42, s40, 2
    s_and_b32 s40, s41, 3
    s_add_u32 s42, s42, s40
    s_lshr_b32 s41, s41, 2
    s_lshl_b32 s43, s41, 2
    s_add_u32 s43, s43, s3
    v_lshrrev_b32 v245, 4, v240
    v_and_b32 v246, 15, v240
    v_lshlrev_b32 v242, 16, v245
    v_lshl_add_u32 v242, v246, 4, v242
    v_add_u32 v247, 2, v246
    v_and_b32 v248, 1, v246
    v_cmp_gt_u32 vcc, 12, v246
    s_nop 1
    v_cndmask_b32 v247, v248, v247, vcc
    s_bitcmp1_b32 s42, 0
    s_cselect_b64 vcc, -1, 0
    v_cndmask_b32 v247, v246, v247, vcc
    v_mul_u32_u24 v243, 57344, v245
    v_lshl_add_u32 v243, v247, 4, v243
    v_add_u32 v249, 7136, v242
    v_add_u32 v250, 6112, v243
    v_and_b32 v247, 1, v245
    v_lshlrev_b32 v247, 2, v247
    v_bfe_u32 v248, v240, 2, 2
    v_add_u32 v247, v247, v248
    v_mul_u32_u24 v241, 1056, v247
    v_lshrrev_b32 v247, 1, v245
    v_lshl_add_u32 v241, v247, 8, v241
    v_and_b32 v247, 3, v240
    v_lshl_add_u32 v241, v247, 3, v241
    v_lshlrev_b32 v244, 4, v240
    v_lshlrev_b32 v245, 3, v245
    s_lshl_b32 s37, s42, 8
    s_lshl_b32 s40, s3, 14
    s_add_u32 s37, s37, s40
    s_mul_i32 s38, s42, 224
    s_mul_i32 s40, s3, 14336
    s_add_u32 s45, s38, s40
    s_mul_i32 s39, s3, 2112
    s_mul_i32 s40, s43, 139264
    s_and_b32 s41, s42, 1
    s_lshl_b32 s41, s41, 5
    s_add_u32 s46, s38, s41
    s_bitcmp1_b32 s42, 0
    s_cselect_b32 s41, 0, 192
    s_add_u32 s41, s38, s41
    s_mov_b32 s38, s45
    s_mov_b32 s36, 0
    v_and_b32 v100, 7, v240
    v_bfe_u32 v101, v240, 3, 1
    v_bfe_u32 v102, v240, 4, 1
    v_lshrrev_b32 v103, 5, v240
    v_lshlrev_b32 v104, 11, v100
    v_lshl_add_u32 v104, v102, 6, v104
    v_lshl_add_u32 v104, v101, 4, v104
    v_lshl_add_u32 v104, v103, 5, v104
    s_lshr_b32 s47, s2, 5
    s_lshl_b32 s48, s47, 8
    s_lshl_b32 s49, s42, 3
    s_add_u32 s48, s48, s49
    s_lshl_b32 s48, s48, 11
    s_lshl_b32 s49, s3, 9
    s_add_u32 s48, s48, s49
    s_waitcnt lgkmcnt(0)
    s_mov_b32 s60, s96
    s_mov_b32 s61, s97
    s_mov_b32 s62, 0x400000
    s_mov_b32 s63, 0x20000
    buffer_load_dwordx4 v[16:19], v104, s[60:63], s48 offen offset:0
    buffer_load_dwordx4 v[20:23], v104, s[60:63], s48 offen offset:128
    buffer_load_dwordx4 v[24:27], v104, s[60:63], s48 offen offset:256
    buffer_load_dwordx4 v[28:31], v104, s[60:63], s48 offen offset:384
    s_mov_b32 s32, s56
    s_mov_b32 s33, s57
    s_mov_b32 s34, 256
    s_mov_b32 s35, 0x20000
    v_mov_b32 v121, 0
    s_or_b32 s49, s2, s3
    s_cmp_lg_u32 s49, 0
    s_cbranch_scc1 pa_nonce
    s_memrealtime s[50:51]
    s_waitcnt lgkmcnt(0)
    s_or_b32 s50, s50, 1
    v_mov_b32 v120, s50
    buffer_store_dword v120, v121, s[32:35], 0 offen sc1
pa_nonce:
    s_lshl_b32 s49, s2, 2
    s_add_u32 s49, s49, s3
    s_and_b32 s50, s49, 511
    s_lshr_b32 s51, s50, 7
    s_lshl_b32 s51, s51, 19
    s_lshr_b32 s40, s50, 3
    s_and_b32 s40, s40, 15
    s_lshl_b32 s40, s40, 13
    s_add_u32 s51, s51, s40
    s_add_u32 s51, s51, 393216
    s_cmp_ge_u32 s49, 512
    s_cselect_b32 s28, s54, s52
    s_cselect_b32 s29, s55, s53
    s_mov_b32 s30, 2097152
    s_mov_b32 s31, 0x20000
    s_cbranch_scc1 pa_ldv
    s_lshr_b32 s40, s50, 2
    s_and_b32 s40, s40, 1
    s_lshl_b32 s40, s40, 12
    s_add_u32 s51, s51, s40
    s_and_b32 s40, s50, 3
    s_lshl_b32 s40, s40, 6
    s_add_u32 s51, s51, s40
    v_and_b32 v106, 15, v240
    v_lshlrev_b32 v106, 8, v106
    v_lshrrev_b32 v105, 4, v240
    v_lshl_add_u32 v106, v105, 4, v106
    s_branch pa_ldj
pa_ldv:
    s_and_b32 s40, s50, 7
    s_lshl_b32 s40, s40, 5
    s_add_u32 s51, s51, s40
    v_lshrrev_b32 v106, 1, v240
    v_lshlrev_b32 v106, 8, v106
    v_and_b32 v105, 1, v240
    v_lshl_add_u32 v106, v105, 4, v106
pa_ldj:
    buffer_load_dwordx4 v[108:111], v106, s[28:31], s51 offen nt
    s_getpc_b64 s[60:61]
pa_start_pc1:
    s_sub_u32 s60, s60, pa_start_pc1-pa_start
    s_subb_u32 s61, s61, 0
    s_mov_b32 s62, code_end_label-pa_start
    s_mov_b32 s63, 0x20000
    s_lshr_b32 s40, s2, 3
    s_lshl_b32 s40, s40, 2
    s_add_u32 s40, s40, s3
    s_lshl_b32 s40, s40, 10
    v_lshlrev_b32 v246, 4, v240
    buffer_load_dwordx4 v[124:127], v246, s[60:63], s40 offen
    s_mul_i32 s40, s43, 139264
    s_mov_b32 s20, s90
    s_mov_b32 s21, s91
    s_mov_b32 s22, 0x1c00
    s_mov_b32 s23, 0x20000
    buffer_load_dwordx2 v[142:143], v245, s[20:23], s46 offen offset:0
    buffer_load_dwordx2 v[158:159], v245, s[20:23], s46 offen offset:32
    buffer_load_dwordx2 v[174:175], v245, s[20:23], s46 offen offset:64
    buffer_load_dwordx2 v[190:191], v245, s[20:23], s46 offen offset:96
    buffer_load_dwordx2 v[206:207], v245, s[20:23], s46 offen offset:128
    buffer_load_dwordx2 v[222:223], v245, s[20:23], s46 offen offset:160
    buffer_load_dwordx2 v[238:239], v245, s[20:23], s41 offen
    s_mov_b32 s8, s4
    s_mov_b32 s9, s5
    s_mov_b32 s10, 0x800000
    s_mov_b32 s11, 0x20000
    s_mov_b32 s12, s88
    s_mov_b32 s13, s89
    s_mov_b32 s14, 0x700000
    s_mov_b32 s15, 0x20000
    s_add_u32 s24, s6, s40
    s_addc_u32 s25, s7, 0
    s_mov_b32 s26, 131072
    s_mov_b32 s27, 0x20000
    s_add_u32 m0, s39, 0
    s_nop 0
    buffer_load_dwordx4 v242, s[8:11], s37 offen nt lds
    buffer_load_dwordx4 v249, s[8:11], s37 offen offset:1056 nt lds
    s_add_u32 m0, s39, 8448
    s_nop 0
    buffer_load_dwordx4 v243, s[12:15], s38 offen nt lds
    buffer_load_dwordx4 v250, s[12:15], s38 offen offset:1056 nt lds
    s_add_u32 s37, s37, 262144
    s_add_u32 s38, s38, 229376
    s_add_u32 m0, s39, 16896
    s_nop 0
    buffer_load_dwordx4 v242, s[8:11], s37 offen nt lds
    buffer_load_dwordx4 v249, s[8:11], s37 offen offset:1056 nt lds
    s_add_u32 m0, s39, 25344
    s_nop 0
    buffer_load_dwordx4 v243, s[12:15], s38 offen nt lds
    buffer_load_dwordx4 v250, s[12:15], s38 offen offset:1056 nt lds
    s_add_u32 s37, s37, 262144
    s_add_u32 s38, s38, 229376
    s_add_u32 m0, s39, 33792
    s_nop 0
    buffer_load_dwordx4 v242, s[8:11], s37 offen nt lds
    buffer_load_dwordx4 v249, s[8:11], s37 offen offset:1056 nt lds
    s_add_u32 m0, s39, 42240
    s_nop 0
    buffer_load_dwordx4 v243, s[12:15], s38 offen nt lds
    buffer_load_dwordx4 v250, s[12:15], s38 offen offset:1056 nt lds
    s_add_u32 s37, s37, 262144
    s_add_u32 s38, s38, 229376
    s_mov_b32 s16, s6
    s_mov_b32 s17, s7
    s_mov_b32 s18, 0x10000000
    s_mov_b32 s19, 0x20000
    s_waitcnt vmcnt(24)
    v_lshlrev_b32 v32, 16, v16
    v_and_b32 v33, 0xffff0000, v16
    v_lshlrev_b32 v34, 16, v17
    v_and_b32 v35, 0xffff0000, v17
    v_lshlrev_b32 v36, 16, v18
    v_and_b32 v37, 0xffff0000, v18
    v_lshlrev_b32 v38, 16, v19
    v_and_b32 v39, 0xffff0000, v19
    s_waitcnt vmcnt(23)
    v_lshlrev_b32 v40, 16, v20
    v_and_b32 v41, 0xffff0000, v20
    v_lshlrev_b32 v42, 16, v21
    v_and_b32 v43, 0xffff0000, v21
    v_lshlrev_b32 v44, 16, v22
    v_and_b32 v45, 0xffff0000, v22
    v_lshlrev_b32 v46, 16, v23
    v_and_b32 v47, 0xffff0000, v23
    s_waitcnt vmcnt(22)
    v_lshlrev_b32 v48, 16, v24
    v_and_b32 v49, 0xffff0000, v24
    v_lshlrev_b32 v50, 16, v25
    v_and_b32 v51, 0xffff0000, v25
    v_lshlrev_b32 v52, 16, v26
    v_and_b32 v53, 0xffff0000, v26
    v_lshlrev_b32 v54, 16, v27
    v_and_b32 v55, 0xffff0000, v27
    s_waitcnt vmcnt(21)
    v_lshlrev_b32 v56, 16, v28
    v_and_b32 v57, 0xffff0000, v28
    v_lshlrev_b32 v58, 16, v29
    v_and_b32 v59, 0xffff0000, v29
    v_lshlrev_b32 v60, 16, v30
    v_and_b32 v61, 0xffff0000, v30
    v_lshlrev_b32 v62, 16, v31
    v_and_b32 v63, 0xffff0000, v31
    v_lshlrev_b32 v6, 4, v100
    v_add_u32 v6, 135168, v6
    s_lshl_b32 s41, s3, 2
    v_add_u32 v7, s41, v6
    v_pk_add_f32 v[72:73], v[32:33], v[40:41]
    v_pk_add_f32 v[74:75], v[34:35], v[42:43]
    v_pk_add_f32 v[76:77], v[36:37], v[44:45]
    v_pk_add_f32 v[78:79], v[38:39], v[46:47]
    v_pk_add_f32 v[72:73], v[72:73], v[48:49]
    v_pk_add_f32 v[74:75], v[74:75], v[50:51]
    v_pk_add_f32 v[76:77], v[76:77], v[52:53]
    v_pk_add_f32 v[78:79], v[78:79], v[54:55]
    v_pk_add_f32 v[72:73], v[72:73], v[56:57]
    v_pk_add_f32 v[74:75], v[74:75], v[58:59]
    v_pk_add_f32 v[76:77], v[76:77], v[60:61]
    v_pk_add_f32 v[78:79], v[78:79], v[62:63]
    v_pk_add_f32 v[72:73], v[72:73], v[74:75]
    v_pk_add_f32 v[76:77], v[76:77], v[78:79]
    v_pk_add_f32 v[72:73], v[72:73], v[76:77]
    v_add_f32 v72, v72, v73
    s_nop 1
    v_add_f32_dpp v72, v72, v72 row_ror:8 row_mask:0xf bank_mask:0xf
    v_mov_b32 v9, v72
    s_nop 1
    v_permlane16_swap_b32 v72, v9
    v_add_f32 v72, v72, v9
    v_mov_b32 v9, v72
    s_nop 1
    v_permlane32_swap_b32 v72, v9
    v_add_f32 v72, v72, v9
    ds_write_b32 v7, v72 offset:0
    s_waitcnt lgkmcnt(0)
    s_barrier
    ds_read_b128 v[64:67], v6 offset:0
    s_waitcnt lgkmcnt(0)
    v_add_f32 v64, v64, v65
    v_add_f32 v66, v66, v67
    v_add_f32 v8, v64, v66
    v_mul_f32 v10, 0xba800000, v8
    v_mov_b32 v11, v10
    v_pk_add_f32 v[80:81], v[32:33], v[10:11]
    v_pk_mul_f32 v[72:73], v[80:81], v[80:81]
    v_pk_add_f32 v[82:83], v[34:35], v[10:11]
    v_pk_mul_f32 v[74:75], v[82:83], v[82:83]
    v_pk_add_f32 v[84:85], v[36:37], v[10:11]
    v_pk_mul_f32 v[76:77], v[84:85], v[84:85]
    v_pk_add_f32 v[86:87], v[38:39], v[10:11]
    v_pk_mul_f32 v[78:79], v[86:87], v[86:87]
    v_pk_add_f32 v[80:81], v[40:41], v[10:11]
    v_pk_fma_f32 v[72:73], v[80:81], v[80:81], v[72:73]
    v_pk_add_f32 v[82:83], v[42:43], v[10:11]
    v_pk_fma_f32 v[74:75], v[82:83], v[82:83], v[74:75]
    v_pk_add_f32 v[84:85], v[44:45], v[10:11]
    v_pk_fma_f32 v[76:77], v[84:85], v[84:85], v[76:77]
    v_pk_add_f32 v[86:87], v[46:47], v[10:11]
    v_pk_fma_f32 v[78:79], v[86:87], v[86:87], v[78:79]
    v_pk_add_f32 v[80:81], v[48:49], v[10:11]
    v_pk_fma_f32 v[72:73], v[80:81], v[80:81], v[72:73]
    v_pk_add_f32 v[82:83], v[50:51], v[10:11]
    v_pk_fma_f32 v[74:75], v[82:83], v[82:83], v[74:75]
    v_pk_add_f32 v[84:85], v[52:53], v[10:11]
    v_pk_fma_f32 v[76:77], v[84:85], v[84:85], v[76:77]
    v_pk_add_f32 v[86:87], v[54:55], v[10:11]
    v_pk_fma_f32 v[78:79], v[86:87], v[86:87], v[78:79]
    v_pk_add_f32 v[80:81], v[56:57], v[10:11]
    v_pk_fma_f32 v[72:73], v[80:81], v[80:81], v[72:73]
    v_pk_add_f32 v[82:83], v[58:59], v[10:11]
    v_pk_fma_f32 v[74:75], v[82:83], v[82:83], v[74:75]
    v_pk_add_f32 v[84:85], v[60:61], v[10:11]
    v_pk_fma_f32 v[76:77], v[84:85], v[84:85], v[76:77]
    v_pk_add_f32 v[86:87], v[62:63], v[10:11]
    v_pk_fma_f32 v[78:79], v[86:87], v[86:87], v[78:79]
    v_pk_add_f32 v[72:73], v[72:73], v[74:75]
    v_pk_add_f32 v[76:77], v[76:77], v[78:79]
    v_pk_add_f32 v[72:73], v[72:73], v[76:77]
    v_add_f32 v72, v72, v73
    s_nop 1
    v_add_f32_dpp v72, v72, v72 row_ror:8 row_mask:0xf bank_mask:0xf
    v_mov_b32 v9, v72
    s_nop 1
    v_permlane16_swap_b32 v72, v9
    v_add_f32 v72, v72, v9
    v_mov_b32 v9, v72
    s_nop 1
    v_permlane32_swap_b32 v72, v9
    v_add_f32 v72, v72, v9
    ds_write_b32 v7, v72 offset:128
    s_waitcnt lgkmcnt(0)
    s_barrier
    ds_read_b128 v[64:67], v6 offset:128
    s_waitcnt lgkmcnt(0)
    v_add_f32 v64, v64, v65
    v_add_f32 v66, v66, v67
    v_add_f32 v8, v64, v66
    s_cmp_lg_u32 s3, 0
    s_cbranch_scc1 pa_nl
    buffer_load_dword v251, v121, s[32:35], 0 offen sc1
pa_nl:
    v_mul_f32 v12, 0x3a800000, v8
    v_cvt_pk_bf16_f32 v14, v10, v12
    v_and_b32 v12, 0xffff0000, v14
    v_lshlrev_b32 v10, 16, v14
    v_add_f32 v12, 0x3727c5ac, v12
    v_mov_b32 v11, v10
    v_cvt_pk_bf16_f32 v14, v12, v12
    v_and_b32 v12, 0xffff0000, v14
    v_sqrt_f32 v12, v12
    s_nop 0
    v_cvt_pk_bf16_f32 v14, v12, v12
    v_and_b32 v12, 0xffff0000, v14
    v_rcp_f32 v14, v12
    v_sub_f32 v12, 0, v12
    v_mov_b32 v15, v14
    v_mov_b32 v13, v12
    s_lshl_b32 s48, s47, 2
    s_lshr_b32 s41, s42, 3
    s_add_u32 s48, s48, s41
    s_mul_i32 s48, s48, 139264
    s_lshr_b32 s41, s42, 1
    s_and_b32 s41, s41, 3
    s_lshl_b32 s41, s41, 10
    s_add_u32 s48, s48, s41
    s_and_b32 s41, s42, 1
    s_lshl_b32 s41, s41, 7
    s_add_u32 s48, s48, s41
    s_lshl_b32 s41, s3, 15
    s_add_u32 s48, s48, s41
    v_lshlrev_b32 v5, 12, v102
    v_lshl_add_u32 v5, v101, 9, v5
    v_lshl_add_u32 v5, v103, 8, v5
    v_lshl_add_u32 v5, v100, 4, v5
    v_pk_add_f32 v[32:33], v[32:33], v[10:11]
    v_cvt_pk_bf16_f32 v16, v32, v33
    v_lshlrev_b32 v32, 16, v16
    v_and_b32 v33, 0xffff0000, v16
    v_pk_mul_f32 v[80:81], v[32:33], v[14:15]
    v_cvt_pk_bf16_f32 v16, v80, v81
    v_pk_add_f32 v[34:35], v[34:35], v[10:11]
    v_cvt_pk_bf16_f32 v17, v34, v35
    v_lshlrev_b32 v34, 16, v17
    v_and_b32 v35, 0xffff0000, v17
    v_pk_mul_f32 v[82:83], v[34:35], v[14:15]
    v_cvt_pk_bf16_f32 v17, v82, v83
    v_pk_add_f32 v[36:37], v[36:37], v[10:11]
    v_cvt_pk_bf16_f32 v18, v36, v37
    v_lshlrev_b32 v36, 16, v18
    v_and_b32 v37, 0xffff0000, v18
    v_pk_mul_f32 v[84:85], v[36:37], v[14:15]
    v_cvt_pk_bf16_f32 v18, v84, v85
    v_pk_add_f32 v[38:39], v[38:39], v[10:11]
    v_cvt_pk_bf16_f32 v19, v38, v39
    v_lshlrev_b32 v38, 16, v19
    v_and_b32 v39, 0xffff0000, v19
    v_pk_mul_f32 v[86:87], v[38:39], v[14:15]
    v_cvt_pk_bf16_f32 v19, v86, v87
    v_permlane32_swap_b32 v16, v18
    s_nop 0
    v_permlane32_swap_b32 v17, v19
    buffer_store_dwordx4 v[16:19], v5, s[16:19], s48 offen sc1
    s_add_u32 s48, s48, 8192
    v_pk_add_f32 v[40:41], v[40:41], v[10:11]
    v_cvt_pk_bf16_f32 v20, v40, v41
    v_lshlrev_b32 v40, 16, v20
    v_and_b32 v41, 0xffff0000, v20
    v_pk_mul_f32 v[80:81], v[40:41], v[14:15]
    v_cvt_pk_bf16_f32 v20, v80, v81
    v_pk_add_f32 v[42:43], v[42:43], v[10:11]
    v_cvt_pk_bf16_f32 v21, v42, v43
    v_lshlrev_b32 v42, 16, v21
    v_and_b32 v43, 0xffff0000, v21
    v_pk_mul_f32 v[82:83], v[42:43], v[14:15]
    v_cvt_pk_bf16_f32 v21, v82, v83
    v_pk_add_f32 v[44:45], v[44:45], v[10:11]
    v_cvt_pk_bf16_f32 v22, v44, v45
    v_lshlrev_b32 v44, 16, v22
    v_and_b32 v45, 0xffff0000, v22
    v_pk_mul_f32 v[84:85], v[44:45], v[14:15]
    v_cvt_pk_bf16_f32 v22, v84, v85
    v_pk_add_f32 v[46:47], v[46:47], v[10:11]
    v_cvt_pk_bf16_f32 v23, v46, v47
    v_lshlrev_b32 v46, 16, v23
    v_and_b32 v47, 0xffff0000, v23
    v_pk_mul_f32 v[86:87], v[46:47], v[14:15]
    v_cvt_pk_bf16_f32 v23, v86, v87
    v_permlane32_swap_b32 v20, v22
    s_nop 0
    v_permlane32_swap_b32 v21, v23
    buffer_store_dwordx4 v[20:23], v5, s[16:19], s48 offen sc1
    s_add_u32 s48, s48, 8192
    v_pk_add_f32 v[48:49], v[48:49], v[10:11]
    v_cvt_pk_bf16_f32 v24, v48, v49
    v_lshlrev_b32 v48, 16, v24
    v_and_b32 v49, 0xffff0000, v24
    v_pk_mul_f32 v[80:81], v[48:49], v[14:15]
    v_cvt_pk_bf16_f32 v24, v80, v81
    v_pk_add_f32 v[50:51], v[50:51], v[10:11]
    v_cvt_pk_bf16_f32 v25, v50, v51
    v_lshlrev_b32 v50, 16, v25
    v_and_b32 v51, 0xffff0000, v25
    v_pk_mul_f32 v[82:83], v[50:51], v[14:15]
    v_cvt_pk_bf16_f32 v25, v82, v83
    v_pk_add_f32 v[52:53], v[52:53], v[10:11]
    v_cvt_pk_bf16_f32 v26, v52, v53
    v_lshlrev_b32 v52, 16, v26
    v_and_b32 v53, 0xffff0000, v26
    v_pk_mul_f32 v[84:85], v[52:53], v[14:15]
    v_cvt_pk_bf16_f32 v26, v84, v85
    v_pk_add_f32 v[54:55], v[54:55], v[10:11]
    v_cvt_pk_bf16_f32 v27, v54, v55
    v_lshlrev_b32 v54, 16, v27
    v_and_b32 v55, 0xffff0000, v27
    v_pk_mul_f32 v[86:87], v[54:55], v[14:15]
    v_cvt_pk_bf16_f32 v27, v86, v87
    v_permlane32_swap_b32 v24, v26
    s_nop 0
    v_permlane32_swap_b32 v25, v27
    buffer_store_dwordx4 v[24:27], v5, s[16:19], s48 offen sc1
    s_add_u32 s48, s48, 8192
    v_pk_add_f32 v[56:57], v[56:57], v[10:11]
    v_cvt_pk_bf16_f32 v28, v56, v57
    v_lshlrev_b32 v56, 16, v28
    v_and_b32 v57, 0xffff0000, v28
    v_pk_mul_f32 v[80:81], v[56:57], v[14:15]
    v_cvt_pk_bf16_f32 v28, v80, v81
    v_pk_add_f32 v[58:59], v[58:59], v[10:11]
    v_cvt_pk_bf16_f32 v29, v58, v59
    v_lshlrev_b32 v58, 16, v29
    v_and_b32 v59, 0xffff0000, v29
    v_pk_mul_f32 v[82:83], v[58:59], v[14:15]
    v_cvt_pk_bf16_f32 v29, v82, v83
    v_pk_add_f32 v[60:61], v[60:61], v[10:11]
    v_cvt_pk_bf16_f32 v30, v60, v61
    v_lshlrev_b32 v60, 16, v30
    v_and_b32 v61, 0xffff0000, v30
    v_pk_mul_f32 v[84:85], v[60:61], v[14:15]
    v_cvt_pk_bf16_f32 v30, v84, v85
    v_pk_add_f32 v[62:63], v[62:63], v[10:11]
    v_cvt_pk_bf16_f32 v31, v62, v63
    v_lshlrev_b32 v62, 16, v31
    v_and_b32 v63, 0xffff0000, v31
    v_pk_mul_f32 v[86:87], v[62:63], v[14:15]
    v_cvt_pk_bf16_f32 v31, v86, v87
    v_permlane32_swap_b32 v28, v30
    s_nop 0
    v_permlane32_swap_b32 v29, v31
    buffer_store_dwordx4 v[28:31], v5, s[16:19], s48 offen sc1
    s_lshl_b32 s51, s50, 10
    s_cmp_ge_u32 s49, 512
    s_cbranch_scc1 pa_stv
    s_mov_b32 s41, 0x3e0293ee
    s_waitcnt vmcnt(24)
    v_lshlrev_b32 v112, 16, v108
    v_and_b32 v113, 0xffff0000, v108
    v_mul_f32 v112, s41, v112
    v_mul_f32 v113, s41, v113
    v_cvt_pk_bf16_f32 v108, v112, v113
    v_lshlrev_b32 v112, 16, v109
    v_and_b32 v113, 0xffff0000, v109
    v_mul_f32 v112, s41, v112
    v_mul_f32 v113, s41, v113
    v_cvt_pk_bf16_f32 v109, v112, v113
    v_lshlrev_b32 v112, 16, v110
    v_and_b32 v113, 0xffff0000, v110
    v_mul_f32 v112, s41, v112
    v_mul_f32 v113, s41, v113
    v_cvt_pk_bf16_f32 v110, v112, v113
    v_lshlrev_b32 v112, 16, v111
    v_and_b32 v113, 0xffff0000, v111
    v_mul_f32 v112, s41, v112
    v_mul_f32 v113, s41, v113
    v_cvt_pk_bf16_f32 v111, v112, v113
    v_permlane32_swap_b32 v108, v110
    s_nop 0
    v_permlane32_swap_b32 v109, v111
    v_and_b32 v114, 15, v240
    v_lshlrev_b32 v114, 4, v114
    v_lshl_add_u32 v114, v102, 9, v114
    v_lshl_add_u32 v114, v103, 8, v114
    s_add_u32 s51, s51, 5242880
    s_branch pa_stj
pa_stv:
    s_waitcnt vmcnt(24)
    s_lshl_b32 s41, s3, 10
    s_add_u32 s41, s41, 135680
    v_add_u32 v114, s41, v244
    ds_write_b128 v114, v[108:111]
    v_lshrrev_b32 v115, 2, v240
    v_lshlrev_b32 v115, 5, v115
    v_and_b32 v116, 3, v240
    v_lshl_add_u32 v115, v116, 3, v115
    v_add_u32 v115, s41, v115
    s_waitcnt lgkmcnt(0)
    ds_read_b64_tr_b16 v[108:109], v115
    ds_read_b64_tr_b16 v[110:111], v115 offset:512
    s_waitcnt lgkmcnt(0)
    v_mov_b32 v114, v244
    s_add_u32 s51, s51, 5767168
pa_stj:
    buffer_store_dwordx4 v[108:111], v114, s[16:19], s51 offen sc1
    v_mov_b32 v0, 0
    v_mov_b32 v1, 0
    v_mov_b32 v2, 0
    v_mov_b32 v3, 0
    v_mov_b32 v4, 0
    v_mov_b32 v5, 0
    v_mov_b32 v6, 0
    v_mov_b32 v7, 0
    v_mov_b32 v8, 0
    v_mov_b32 v9, 0
    v_mov_b32 v10, 0
    v_mov_b32 v11, 0
    v_mov_b32 v12, 0
    v_mov_b32 v13, 0
    v_mov_b32 v14, 0
    v_mov_b32 v15, 0
    v_mov_b32 v16, 0
    v_mov_b32 v17, 0
    v_mov_b32 v18, 0
    v_mov_b32 v19, 0
    v_mov_b32 v20, 0
    v_mov_b32 v21, 0
    v_mov_b32 v22, 0
    v_mov_b32 v23, 0
    v_mov_b32 v24, 0
    v_mov_b32 v25, 0
    v_mov_b32 v26, 0
    v_mov_b32 v27, 0
    v_mov_b32 v28, 0
    v_mov_b32 v29, 0
    v_mov_b32 v30, 0
    v_mov_b32 v31, 0
    v_mov_b32 v32, 0
    v_mov_b32 v33, 0
    v_mov_b32 v34, 0
    v_mov_b32 v35, 0
    v_mov_b32 v36, 0
    v_mov_b32 v37, 0
    v_mov_b32 v38, 0
    v_mov_b32 v39, 0
    v_mov_b32 v40, 0
    v_mov_b32 v41, 0
    v_mov_b32 v42, 0
    v_mov_b32 v43, 0
    v_mov_b32 v44, 0
    v_mov_b32 v45, 0
    v_mov_b32 v46, 0
    v_mov_b32 v47, 0
    v_mov_b32 v48, 0
    v_mov_b32 v49, 0
    v_mov_b32 v50, 0
    v_mov_b32 v51, 0
    v_mov_b32 v52, 0
    v_mov_b32 v53, 0
    v_mov_b32 v54, 0
    v_mov_b32 v55, 0
    v_mov_b32 v56, 0
    v_mov_b32 v57, 0
    v_mov_b32 v58, 0
    v_mov_b32 v59, 0
    v_mov_b32 v60, 0
    v_mov_b32 v61, 0
    v_mov_b32 v62, 0
    v_mov_b32 v63, 0
    v_mov_b32 v64, 0
    v_mov_b32 v65, 0
    v_mov_b32 v66, 0
    v_mov_b32 v67, 0
    v_mov_b32 v68, 0
    v_mov_b32 v69, 0
    v_mov_b32 v70, 0
    v_mov_b32 v71, 0
    v_mov_b32 v72, 0
    v_mov_b32 v73, 0
    v_mov_b32 v74, 0
    v_mov_b32 v75, 0
    v_mov_b32 v76, 0
    v_mov_b32 v77, 0
    v_mov_b32 v78, 0
    v_mov_b32 v79, 0
    v_mov_b32 v80, 0
    v_mov_b32 v81, 0
    v_mov_b32 v82, 0
    v_mov_b32 v83, 0
    v_mov_b32 v84, 0
    v_mov_b32 v85, 0
    v_mov_b32 v86, 0
    v_mov_b32 v87, 0
    v_mov_b32 v88, 0
    v_mov_b32 v89, 0
    v_mov_b32 v90, 0
    v_mov_b32 v91, 0
    v_mov_b32 v92, 0
    v_mov_b32 v93, 0
    v_mov_b32 v94, 0
    v_mov_b32 v95, 0
    v_mov_b32 v96, 0
    v_mov_b32 v97, 0
    v_mov_b32 v98, 0
    v_mov_b32 v99, 0
    v_mov_b32 v100, 0
    v_mov_b32 v101, 0
    v_mov_b32 v102, 0
    v_mov_b32 v103, 0
    v_mov_b32 v104, 0
    v_mov_b32 v105, 0
    v_mov_b32 v106, 0
    v_mov_b32 v107, 0
    v_mov_b32 v108, 0
    v_mov_b32 v109, 0
    v_mov_b32 v110, 0
    v_mov_b32 v111, 0
    v_mov_b32 v112, 0
    v_mov_b32 v113, 0
    v_mov_b32 v114, 0
    v_mov_b32 v115, 0
    v_mov_b32 v116, 0
    v_mov_b32 v117, 0
    v_mov_b32 v118, 0
    v_mov_b32 v119, 0
    v_mov_b32 v120, 0
    v_mov_b32 v121, 0
    v_mov_b32 v122, 0
    v_mov_b32 v123, 0
    s_waitcnt vmcnt(24)
    v_mov_b32 v124, 0
    v_mov_b32 v125, 0
    v_mov_b32 v126, 0
    v_mov_b32 v127, 0
    s_waitcnt vmcnt(23)
    v_lshlrev_b32 v128, 16, v142
    v_and_b32 v129, 0xffff0000, v142
    v_lshlrev_b32 v130, 16, v143
    v_and_b32 v131, 0xffff0000, v143
    v_lshlrev_b32 v132, 16, v142
    v_and_b32 v133, 0xffff0000, v142
    v_lshlrev_b32 v134, 16, v143
    v_and_b32 v135, 0xffff0000, v143
    v_lshlrev_b32 v136, 16, v142
    v_and_b32 v137, 0xffff0000, v142
    v_lshlrev_b32 v138, 16, v143
    v_and_b32 v139, 0xffff0000, v143
    v_lshlrev_b32 v140, 16, v142
    v_and_b32 v141, 0xffff0000, v142
    v_lshlrev_b32 v142, 16, v143
    v_mov_b32 v143, v139
    s_waitcnt vmcnt(22)
    v_lshlrev_b32 v144, 16, v158
    v_and_b32 v145, 0xffff0000, v158
    v_lshlrev_b32 v146, 16, v159
    v_and_b32 v147, 0xffff0000, v159
    v_lshlrev_b32 v148, 16, v158
    v_and_b32 v149, 0xffff0000, v158
    v_lshlrev_b32 v150, 16, v159
    v_and_b32 v151, 0xffff0000, v159
    v_lshlrev_b32 v152, 16, v158
    v_and_b32 v153, 0xffff0000, v158
    v_lshlrev_b32 v154, 16, v159
    v_and_b32 v155, 0xffff0000, v159
    v_lshlrev_b32 v156, 16, v158
    v_and_b32 v157, 0xffff0000, v158
    v_lshlrev_b32 v158, 16, v159
    v_mov_b32 v159, v155
    s_waitcnt vmcnt(21)
    v_lshlrev_b32 v160, 16, v174
    v_and_b32 v161, 0xffff0000, v174
    v_lshlrev_b32 v162, 16, v175
    v_and_b32 v163, 0xffff0000, v175
    v_lshlrev_b32 v164, 16, v174
    v_and_b32 v165, 0xffff0000, v174
    v_lshlrev_b32 v166, 16, v175
    v_and_b32 v167, 0xffff0000, v175
    v_lshlrev_b32 v168, 16, v174
    v_and_b32 v169, 0xffff0000, v174
    v_lshlrev_b32 v170, 16, v175
    v_and_b32 v171, 0xffff0000, v175
    v_lshlrev_b32 v172, 16, v174
    v_and_b32 v173, 0xffff0000, v174
    v_lshlrev_b32 v174, 16, v175
    v_mov_b32 v175, v171
    s_waitcnt vmcnt(20)
    v_lshlrev_b32 v176, 16, v190
    v_and_b32 v177, 0xffff0000, v190
    v_lshlrev_b32 v178, 16, v191
    v_and_b32 v179, 0xffff0000, v191
    v_lshlrev_b32 v180, 16, v190
    v_and_b32 v181, 0xffff0000, v190
    v_lshlrev_b32 v182, 16, v191
    v_and_b32 v183, 0xffff0000, v191
    v_lshlrev_b32 v184, 16, v190
    v_and_b32 v185, 0xffff0000, v190
    v_lshlrev_b32 v186, 16, v191
    v_and_b32 v187, 0xffff0000, v191
    v_lshlrev_b32 v188, 16, v190
    v_and_b32 v189, 0xffff0000, v190
    v_lshlrev_b32 v190, 16, v191
    v_mov_b32 v191, v187
    s_waitcnt vmcnt(19)
    v_lshlrev_b32 v192, 16, v206
    v_and_b32 v193, 0xffff0000, v206
    v_lshlrev_b32 v194, 16, v207
    v_and_b32 v195, 0xffff0000, v207
    v_lshlrev_b32 v196, 16, v206
    v_and_b32 v197, 0xffff0000, v206
    v_lshlrev_b32 v198, 16, v207
    v_and_b32 v199, 0xffff0000, v207
    v_lshlrev_b32 v200, 16, v206
    v_and_b32 v201, 0xffff0000, v206
    v_lshlrev_b32 v202, 16, v207
    v_and_b32 v203, 0xffff0000, v207
    v_lshlrev_b32 v204, 16, v206
    v_and_b32 v205, 0xffff0000, v206
    v_lshlrev_b32 v206, 16, v207
    v_mov_b32 v207, v203
    s_waitcnt vmcnt(18)
    v_lshlrev_b32 v208, 16, v222
    v_and_b32 v209, 0xffff0000, v222
    v_lshlrev_b32 v210, 16, v223
    v_and_b32 v211, 0xffff0000, v223
    v_lshlrev_b32 v212, 16, v222
    v_and_b32 v213, 0xffff0000, v222
    v_lshlrev_b32 v214, 16, v223
    v_and_b32 v215, 0xffff0000, v223
    v_lshlrev_b32 v216, 16, v222
    v_and_b32 v217, 0xffff0000, v222
    v_lshlrev_b32 v218, 16, v223
    v_and_b32 v219, 0xffff0000, v223
    v_lshlrev_b32 v220, 16, v222
    v_and_b32 v221, 0xffff0000, v222
    v_lshlrev_b32 v222, 16, v223
    v_mov_b32 v223, v219
    s_waitcnt vmcnt(17)
    v_lshlrev_b32 v224, 16, v238
    v_and_b32 v225, 0xffff0000, v238
    v_lshlrev_b32 v226, 16, v239
    v_and_b32 v227, 0xffff0000, v239
    v_lshlrev_b32 v228, 16, v238
    v_and_b32 v229, 0xffff0000, v238
    v_lshlrev_b32 v230, 16, v239
    v_and_b32 v231, 0xffff0000, v239
    v_lshlrev_b32 v232, 16, v238
    v_and_b32 v233, 0xffff0000, v238
    v_lshlrev_b32 v234, 16, v239
    v_and_b32 v235, 0xffff0000, v239
    v_lshlrev_b32 v236, 16, v238
    v_and_b32 v237, 0xffff0000, v238
    v_lshlrev_b32 v238, 16, v239
    v_mov_b32 v239, v235
    s_waitcnt vmcnt(0)
    s_barrier
    s_cmp_lg_u32 s3, 0
    s_cbranch_scc1 pa_xnf
    s_mov_b32 s48, 0x80000
pa_np:
    v_readfirstlane_b32 s100, v251
    s_nop 4
    s_cmp_lg_u32 s100, 0
    s_cbranch_scc1 pa_nok
    v_mov_b32 v246, 0
    buffer_load_dword v251, v246, s[32:35], 0 offen sc1
    s_waitcnt vmcnt(0)
    s_sub_u32 s48, s48, 1
    s_cmp_lg_u32 s48, 0
    s_cbranch_scc1 pa_np
pa_nok:
    s_lshl_b32 s48, s47, 5
    s_add_u32 s49, s48, s42
    s_lshl_b32 s48, s48, 7
    s_add_u32 s48, s48, 49283072
    s_lshl_b32 s49, s49, 7
    s_add_u32 s49, s49, 49283072
    v_mov_b32 v246, 0
    v_mov_b32 v247, s100
    s_mov_b64 exec, 1
    buffer_store_dword v247, v246, s[16:19], s49 offen sc1
    s_mov_b64 exec, -1
    v_mov_b32 v246, 135424
    ds_write_b32 v246, v247
    s_waitcnt lgkmcnt(0)
pa_xnf:
    s_cmp_lg_u32 s3, 0
    s_cbranch_scc1 pa_xnok
    s_mov_b64 exec, 0xffffffff
    v_lshlrev_b32 v248, 7, v240
    s_mov_b32 s49, 0x80000
pa_xnp:
    buffer_load_dword v247, v248, s[16:19], s48 offen sc1
    s_waitcnt vmcnt(0)
    v_cmp_ne_u32 vcc, s100, v247
    s_nop 4
    s_cbranch_vccz pa_xnq
    s_sleep 1
    s_sub_u32 s49, s49, 1
    s_cmp_lg_u32 s49, 0
    s_cbranch_scc1 pa_xnp
pa_xnq:
    s_mov_b64 exec, -1
pa_xnok:
    s_barrier
    v_mov_b32 v246, 135424
    ds_read_b32 v247, v246
    buffer_load_dwordx4 a[60:63], v244, s[24:27], s36 offen offset:0 sc1
    buffer_load_dwordx4 a[64:67], v244, s[24:27], s36 offen offset:1024 sc1
    buffer_load_dwordx4 a[68:71], v244, s[24:27], s36 offen offset:2048 sc1
    buffer_load_dwordx4 a[72:75], v244, s[24:27], s36 offen offset:3072 sc1
    s_add_u32 s36, s36, 4096
    buffer_load_dwordx4 a[76:79], v244, s[24:27], s36 offen offset:0 sc1
    buffer_load_dwordx4 a[80:83], v244, s[24:27], s36 offen offset:1024 sc1
    buffer_load_dwordx4 a[84:87], v244, s[24:27], s36 offen offset:2048 sc1
    buffer_load_dwordx4 a[88:91], v244, s[24:27], s36 offen offset:3072 sc1
    s_add_u32 s36, s36, 4096
    buffer_load_dwordx4 a[92:95], v244, s[24:27], s36 offen offset:0 sc1
    buffer_load_dwordx4 a[96:99], v244, s[24:27], s36 offen offset:1024 sc1
    buffer_load_dwordx4 a[100:103], v244, s[24:27], s36 offen offset:2048 sc1
    buffer_load_dwordx4 a[104:107], v244, s[24:27], s36 offen offset:3072 sc1
    s_add_u32 s36, s36, 4096
    v_and_b32 v248, 31, v240
    v_lshlrev_b32 v248, 7, v248
    v_lshrrev_b32 v246, 5, v240
    v_lshl_add_u32 v248, v246, 14, v248
    s_lshr_b32 s48, s42, 3
    s_lshl_b32 s48, s48, 12
    s_add_u32 s48, s48, 49283072
    s_cmp_eq_u32 s3, 0
    s_cselect_b32 s47, 1, 0x7fff
    s_barrier
    ds_read_b64_tr_b16 a[0:1], v241 offset:0
    ds_read_b64_tr_b16 a[2:3], v241 offset:512
    ds_read_b64_tr_b16 a[4:5], v241 offset:32
    ds_read_b64_tr_b16 a[6:7], v241 offset:544
    ds_read_b64_tr_b16 a[8:9], v241 offset:64
    ds_read_b64_tr_b16 a[10:11], v241 offset:576
    ds_read_b64_tr_b16 a[12:13], v241 offset:96
    ds_read_b64_tr_b16 a[14:15], v241 offset:608
    ds_read_b64_tr_b16 a[16:17], v241 offset:128
    ds_read_b64_tr_b16 a[18:19], v241 offset:640
    ds_read_b64_tr_b16 a[20:21], v241 offset:160
    ds_read_b64_tr_b16 a[22:23], v241 offset:672
    ds_read_b64_tr_b16 a[24:25], v241 offset:192
    ds_read_b64_tr_b16 a[26:27], v241 offset:704
    ds_read_b64_tr_b16 a[28:29], v241 offset:224
    ds_read_b64_tr_b16 a[30:31], v241 offset:736
    ds_read_b64_tr_b16 a[32:33], v241 offset:8448
    ds_read_b64_tr_b16 a[34:35], v241 offset:8960
    ds_read_b64_tr_b16 a[36:37], v241 offset:8480
    ds_read_b64_tr_b16 a[38:39], v241 offset:8992
    ds_read_b64_tr_b16 a[40:41], v241 offset:8512
    ds_read_b64_tr_b16 a[42:43], v241 offset:9024
    ds_read_b64_tr_b16 a[44:45], v241 offset:8544
    ds_read_b64_tr_b16 a[46:47], v241 offset:9056
    ds_read_b64_tr_b16 a[48:49], v241 offset:8576
    ds_read_b64_tr_b16 a[50:51], v241 offset:9088
    ds_read_b64_tr_b16 a[52:53], v241 offset:8608
    ds_read_b64_tr_b16 a[54:55], v241 offset:9120
    ds_read_b64_tr_b16 a[56:57], v241 offset:8640
    ds_read_b64_tr_b16 a[58:59], v241 offset:9152
    s_waitcnt lgkmcnt(15)
    v_readfirstlane_b32 s100, v247
    s_mov_b32 s44, 4
pa_g1:
    s_waitcnt vmcnt(12)
    s_barrier
    s_waitcnt vmcnt(11)
    v_mfma_f32_16x16x32_bf16 v[0:3], a[0:3], a[60:63], v[0:3]
    s_add_u32 m0, s39, 50688
    s_waitcnt vmcnt(10)
    v_mfma_f32_16x16x32_bf16 v[4:7], a[0:3], a[64:67], v[4:7]
    buffer_load_dwordx4 v242, s[8:11], s37 offen nt lds
    s_waitcnt vmcnt(10)
    v_mfma_f32_16x16x32_bf16 v[8:11], a[0:3], a[68:71], v[8:11]
    s_waitcnt vmcnt(9)
    v_mfma_f32_16x16x32_bf16 v[12:15], a[0:3], a[72:75], v[12:15]
    ds_read_b64_tr_b16 a[0:1], v241 offset:16896
    v_mfma_f32_16x16x32_bf16 v[28:31], a[4:7], a[72:75], v[28:31]
    ds_read_b64_tr_b16 a[2:3], v241 offset:17408
    v_mfma_f32_16x16x32_bf16 v[24:27], a[4:7], a[68:71], v[24:27]
    buffer_load_dwordx4 v249, s[8:11], s37 offen offset:1056 nt lds
    v_mfma_f32_16x16x32_bf16 v[20:23], a[4:7], a[64:67], v[20:23]
    v_mfma_f32_16x16x32_bf16 v[16:19], a[4:7], a[60:63], v[16:19]
    ds_read_b64_tr_b16 a[4:5], v241 offset:16928
    v_mfma_f32_16x16x32_bf16 v[32:35], a[8:11], a[60:63], v[32:35]
    ds_read_b64_tr_b16 a[6:7], v241 offset:17440
    s_add_u32 m0, s39, 59136
    v_mfma_f32_16x16x32_bf16 v[36:39], a[8:11], a[64:67], v[36:39]
    buffer_load_dwordx4 v243, s[12:15], s38 offen nt lds
    v_mfma_f32_16x16x32_bf16 v[40:43], a[8:11], a[68:71], v[40:43]
    v_mfma_f32_16x16x32_bf16 v[44:47], a[8:11], a[72:75], v[44:47]
    ds_read_b64_tr_b16 a[8:9], v241 offset:16960
    v_mfma_f32_16x16x32_bf16 v[60:63], a[12:15], a[72:75], v[60:63]
    ds_read_b64_tr_b16 a[10:11], v241 offset:17472
    v_mfma_f32_16x16x32_bf16 v[56:59], a[12:15], a[68:71], v[56:59]
    buffer_load_dwordx4 v250, s[12:15], s38 offen offset:1056 nt lds
    v_mfma_f32_16x16x32_bf16 v[52:55], a[12:15], a[64:67], v[52:55]
    v_mfma_f32_16x16x32_bf16 v[48:51], a[12:15], a[60:63], v[48:51]
    ds_read_b64_tr_b16 a[12:13], v241 offset:16992
    v_mfma_f32_16x16x32_bf16 v[64:67], a[16:19], a[60:63], v[64:67]
    ds_read_b64_tr_b16 a[14:15], v241 offset:17504
    v_mfma_f32_16x16x32_bf16 v[68:71], a[16:19], a[64:67], v[68:71]
    s_add_u32 s37, s37, 262144
    v_mfma_f32_16x16x32_bf16 v[72:75], a[16:19], a[68:71], v[72:75]
    s_add_u32 s38, s38, 229376
    v_mfma_f32_16x16x32_bf16 v[76:79], a[16:19], a[72:75], v[76:79]
    ds_read_b64_tr_b16 a[16:17], v241 offset:17024
    v_mfma_f32_16x16x32_bf16 v[92:95], a[20:23], a[72:75], v[92:95]
    ds_read_b64_tr_b16 a[18:19], v241 offset:17536
    v_mfma_f32_16x16x32_bf16 v[88:91], a[20:23], a[68:71], v[88:91]
    v_mfma_f32_16x16x32_bf16 v[84:87], a[20:23], a[64:67], v[84:87]
    v_mfma_f32_16x16x32_bf16 v[80:83], a[20:23], a[60:63], v[80:83]
    ds_read_b64_tr_b16 a[20:21], v241 offset:17056
    v_mfma_f32_16x16x32_bf16 v[96:99], a[24:27], a[60:63], v[96:99]
    ds_read_b64_tr_b16 a[22:23], v241 offset:17568
    v_mfma_f32_16x16x32_bf16 v[100:103], a[24:27], a[64:67], v[100:103]
    v_mfma_f32_16x16x32_bf16 v[104:107], a[24:27], a[68:71], v[104:107]
    v_mfma_f32_16x16x32_bf16 v[108:111], a[24:27], a[72:75], v[108:111]
    ds_read_b64_tr_b16 a[24:25], v241 offset:17088
    s_waitcnt lgkmcnt(9)
    v_mfma_f32_16x16x32_bf16 v[124:127], a[28:31], a[72:75], v[124:127]
    ds_read_b64_tr_b16 a[26:27], v241 offset:17600
    v_mfma_f32_16x16x32_bf16 v[120:123], a[28:31], a[68:71], v[120:123]
    v_mfma_f32_16x16x32_bf16 v[116:119], a[28:31], a[64:67], v[116:119]
    buffer_load_dwordx4 a[108:111], v244, s[24:27], s36 offen offset:0 sc1
    v_mfma_f32_16x16x32_bf16 v[112:115], a[28:31], a[60:63], v[112:115]
    ds_read_b64_tr_b16 a[28:29], v241 offset:17120
    v_mfma_f32_16x16x32_bf16 v[128:131], a[32:35], a[60:63], v[128:131]
    ds_read_b64_tr_b16 a[30:31], v241 offset:17632
    v_mfma_f32_16x16x32_bf16 v[132:135], a[32:35], a[64:67], v[132:135]
    v_mfma_f32_16x16x32_bf16 v[136:139], a[32:35], a[68:71], v[136:139]
    buffer_load_dwordx4 a[112:115], v244, s[24:27], s36 offen offset:1024 sc1
    v_mfma_f32_16x16x32_bf16 v[140:143], a[32:35], a[72:75], v[140:143]
    ds_read_b64_tr_b16 a[32:33], v241 offset:25344
    v_mfma_f32_16x16x32_bf16 v[156:159], a[36:39], a[72:75], v[156:159]
    ds_read_b64_tr_b16 a[34:35], v241 offset:25856
    v_mfma_f32_16x16x32_bf16 v[152:155], a[36:39], a[68:71], v[152:155]
    v_mfma_f32_16x16x32_bf16 v[148:151], a[36:39], a[64:67], v[148:151]
    buffer_load_dwordx4 a[116:119], v244, s[24:27], s36 offen offset:2048 sc1
    v_mfma_f32_16x16x32_bf16 v[144:147], a[36:39], a[60:63], v[144:147]
    ds_read_b64_tr_b16 a[36:37], v241 offset:25376
    v_mfma_f32_16x16x32_bf16 v[160:163], a[40:43], a[60:63], v[160:163]
    ds_read_b64_tr_b16 a[38:39], v241 offset:25888
    v_mfma_f32_16x16x32_bf16 v[164:167], a[40:43], a[64:67], v[164:167]
    v_mfma_f32_16x16x32_bf16 v[168:171], a[40:43], a[68:71], v[168:171]
    buffer_load_dwordx4 a[120:123], v244, s[24:27], s36 offen offset:3072 sc1
    v_mfma_f32_16x16x32_bf16 v[172:175], a[40:43], a[72:75], v[172:175]
    ds_read_b64_tr_b16 a[40:41], v241 offset:25408
    v_mfma_f32_16x16x32_bf16 v[188:191], a[44:47], a[72:75], v[188:191]
    ds_read_b64_tr_b16 a[42:43], v241 offset:25920
    v_mfma_f32_16x16x32_bf16 v[184:187], a[44:47], a[68:71], v[184:187]
    v_mfma_f32_16x16x32_bf16 v[180:183], a[44:47], a[64:67], v[180:183]
    s_add_u32 s36, s36, 4096
    v_mfma_f32_16x16x32_bf16 v[176:179], a[44:47], a[60:63], v[176:179]
    ds_read_b64_tr_b16 a[44:45], v241 offset:25440
    v_mfma_f32_16x16x32_bf16 v[192:195], a[48:51], a[60:63], v[192:195]
    ds_read_b64_tr_b16 a[46:47], v241 offset:25952
    v_mfma_f32_16x16x32_bf16 v[196:199], a[48:51], a[64:67], v[196:199]
    v_mfma_f32_16x16x32_bf16 v[200:203], a[48:51], a[68:71], v[200:203]
    v_mfma_f32_16x16x32_bf16 v[204:207], a[48:51], a[72:75], v[204:207]
    ds_read_b64_tr_b16 a[48:49], v241 offset:25472
    v_mfma_f32_16x16x32_bf16 v[220:223], a[52:55], a[72:75], v[220:223]
    ds_read_b64_tr_b16 a[50:51], v241 offset:25984
    v_mfma_f32_16x16x32_bf16 v[216:219], a[52:55], a[68:71], v[216:219]
    v_mfma_f32_16x16x32_bf16 v[212:215], a[52:55], a[64:67], v[212:215]
    v_mfma_f32_16x16x32_bf16 v[208:211], a[52:55], a[60:63], v[208:211]
    ds_read_b64_tr_b16 a[52:53], v241 offset:25504
    v_mfma_f32_16x16x32_bf16 v[224:227], a[56:59], a[60:63], v[224:227]
    ds_read_b64_tr_b16 a[54:55], v241 offset:26016
    v_mfma_f32_16x16x32_bf16 v[228:231], a[56:59], a[64:67], v[228:231]
    v_mfma_f32_16x16x32_bf16 v[232:235], a[56:59], a[68:71], v[232:235]
    v_mfma_f32_16x16x32_bf16 v[236:239], a[56:59], a[72:75], v[236:239]
    ds_read_b64_tr_b16 a[56:57], v241 offset:25536
    ds_read_b64_tr_b16 a[58:59], v241 offset:26048
    s_waitcnt vmcnt(12)
    s_barrier
    s_waitcnt vmcnt(15)
    v_mfma_f32_16x16x32_bf16 v[0:3], a[0:3], a[76:79], v[0:3]
    s_add_u32 m0, s39, 67584
    s_waitcnt vmcnt(14)
    v_mfma_f32_16x16x32_bf16 v[4:7], a[0:3], a[80:83], v[4:7]
    buffer_load_dwordx4 v242, s[8:11], s37 offen nt lds
    s_waitcnt vmcnt(14)
    v_mfma_f32_16x16x32_bf16 v[8:11], a[0:3], a[84:87], v[8:11]
    s_waitcnt vmcnt(13)
    v_mfma_f32_16x16x32_bf16 v[12:15], a[0:3], a[88:91], v[12:15]
    ds_read_b64_tr_b16 a[0:1], v241 offset:33792
    v_mfma_f32_16x16x32_bf16 v[28:31], a[4:7], a[88:91], v[28:31]
    ds_read_b64_tr_b16 a[2:3], v241 offset:34304
    v_mfma_f32_16x16x32_bf16 v[24:27], a[4:7], a[84:87], v[24:27]
    buffer_load_dwordx4 v249, s[8:11], s37 offen offset:1056 nt lds
    v_mfma_f32_16x16x32_bf16 v[20:23], a[4:7], a[80:83], v[20:23]
    v_mfma_f32_16x16x32_bf16 v[16:19], a[4:7], a[76:79], v[16:19]
    ds_read_b64_tr_b16 a[4:5], v241 offset:33824
    s_waitcnt lgkmcnt(9)
    v_mfma_f32_16x16x32_bf16 v[32:35], a[8:11], a[76:79], v[32:35]
    ds_read_b64_tr_b16 a[6:7], v241 offset:34336
    s_add_u32 m0, s39, 76032
    v_mfma_f32_16x16x32_bf16 v[36:39], a[8:11], a[80:83], v[36:39]
    buffer_load_dwordx4 v243, s[12:15], s38 offen nt lds
    v_mfma_f32_16x16x32_bf16 v[40:43], a[8:11], a[84:87], v[40:43]
    v_mfma_f32_16x16x32_bf16 v[44:47], a[8:11], a[88:91], v[44:47]
    ds_read_b64_tr_b16 a[8:9], v241 offset:33856
    v_mfma_f32_16x16x32_bf16 v[60:63], a[12:15], a[88:91], v[60:63]
    ds_read_b64_tr_b16 a[10:11], v241 offset:34368
    v_mfma_f32_16x16x32_bf16 v[56:59], a[12:15], a[84:87], v[56:59]
    buffer_load_dwordx4 v250, s[12:15], s38 offen offset:1056 nt lds
    v_mfma_f32_16x16x32_bf16 v[52:55], a[12:15], a[80:83], v[52:55]
    v_mfma_f32_16x16x32_bf16 v[48:51], a[12:15], a[76:79], v[48:51]
    ds_read_b64_tr_b16 a[12:13], v241 offset:33888
    v_mfma_f32_16x16x32_bf16 v[64:67], a[16:19], a[76:79], v[64:67]
    ds_read_b64_tr_b16 a[14:15], v241 offset:34400
    v_mfma_f32_16x16x32_bf16 v[68:71], a[16:19], a[80:83], v[68:71]
    s_add_u32 s37, s37, 262144
    v_mfma_f32_16x16x32_bf16 v[72:75], a[16:19], a[84:87], v[72:75]
    s_add_u32 s38, s38, 229376
    v_mfma_f32_16x16x32_bf16 v[76:79], a[16:19], a[88:91], v[76:79]
    ds_read_b64_tr_b16 a[16:17], v241 offset:33920
    v_mfma_f32_16x16x32_bf16 v[92:95], a[20:23], a[88:91], v[92:95]
    ds_read_b64_tr_b16 a[18:19], v241 offset:34432
    v_mfma_f32_16x16x32_bf16 v[88:91], a[20:23], a[84:87], v[88:91]
    v_mfma_f32_16x16x32_bf16 v[84:87], a[20:23], a[80:83], v[84:87]
    v_mfma_f32_16x16x32_bf16 v[80:83], a[20:23], a[76:79], v[80:83]
    ds_read_b64_tr_b16 a[20:21], v241 offset:33952
    v_mfma_f32_16x16x32_bf16 v[96:99], a[24:27], a[76:79], v[96:99]
    ds_read_b64_tr_b16 a[22:23], v241 offset:34464
    v_mfma_f32_16x16x32_bf16 v[100:103], a[24:27], a[80:83], v[100:103]
    v_mfma_f32_16x16x32_bf16 v[104:107], a[24:27], a[84:87], v[104:107]
    v_mfma_f32_16x16x32_bf16 v[108:111], a[24:27], a[88:91], v[108:111]
    ds_read_b64_tr_b16 a[24:25], v241 offset:33984
    v_mfma_f32_16x16x32_bf16 v[124:127], a[28:31], a[88:91], v[124:127]
    ds_read_b64_tr_b16 a[26:27], v241 offset:34496
    v_mfma_f32_16x16x32_bf16 v[120:123], a[28:31], a[84:87], v[120:123]
    v_mfma_f32_16x16x32_bf16 v[116:119], a[28:31], a[80:83], v[116:119]
    buffer_load_dwordx4 a[124:127], v244, s[24:27], s36 offen offset:0 sc1
    v_mfma_f32_16x16x32_bf16 v[112:115], a[28:31], a[76:79], v[112:115]
    ds_read_b64_tr_b16 a[28:29], v241 offset:34016
    v_mfma_f32_16x16x32_bf16 v[128:131], a[32:35], a[76:79], v[128:131]
    ds_read_b64_tr_b16 a[30:31], v241 offset:34528
    v_mfma_f32_16x16x32_bf16 v[132:135], a[32:35], a[80:83], v[132:135]
    v_mfma_f32_16x16x32_bf16 v[136:139], a[32:35], a[84:87], v[136:139]
    buffer_load_dwordx4 a[128:131], v244, s[24:27], s36 offen offset:1024 sc1
    v_mfma_f32_16x16x32_bf16 v[140:143], a[32:35], a[88:91], v[140:143]
    ds_read_b64_tr_b16 a[32:33], v241 offset:42240
    v_mfma_f32_16x16x32_bf16 v[156:159], a[36:39], a[88:91], v[156:159]
    ds_read_b64_tr_b16 a[34:35], v241 offset:42752
    v_mfma_f32_16x16x32_bf16 v[152:155], a[36:39], a[84:87], v[152:155]
    v_mfma_f32_16x16x32_bf16 v[148:151], a[36:39], a[80:83], v[148:151]
    buffer_load_dwordx4 a[132:135], v244, s[24:27], s36 offen offset:2048 sc1
    v_mfma_f32_16x16x32_bf16 v[144:147], a[36:39], a[76:79], v[144:147]
    ds_read_b64_tr_b16 a[36:37], v241 offset:42272
    v_mfma_f32_16x16x32_bf16 v[160:163], a[40:43], a[76:79], v[160:163]
    ds_read_b64_tr_b16 a[38:39], v241 offset:42784
    v_mfma_f32_16x16x32_bf16 v[164:167], a[40:43], a[80:83], v[164:167]
    v_mfma_f32_16x16x32_bf16 v[168:171], a[40:43], a[84:87], v[168:171]
    buffer_load_dwordx4 a[136:139], v244, s[24:27], s36 offen offset:3072 sc1
    v_mfma_f32_16x16x32_bf16 v[172:175], a[40:43], a[88:91], v[172:175]
    ds_read_b64_tr_b16 a[40:41], v241 offset:42304
    v_mfma_f32_16x16x32_bf16 v[188:191], a[44:47], a[88:91], v[188:191]
    ds_read_b64_tr_b16 a[42:43], v241 offset:42816
    v_mfma_f32_16x16x32_bf16 v[184:187], a[44:47], a[84:87], v[184:187]
    v_mfma_f32_16x16x32_bf16 v[180:183], a[44:47], a[80:83], v[180:183]
    s_add_u32 s36, s36, 4096
    v_mfma_f32_16x16x32_bf16 v[176:179], a[44:47], a[76:79], v[176:179]
    ds_read_b64_tr_b16 a[44:45], v241 offset:42336
    s_waitcnt lgkmcnt(9)
    v_mfma_f32_16x16x32_bf16 v[192:195], a[48:51], a[76:79], v[192:195]
    ds_read_b64_tr_b16 a[46:47], v241 offset:42848
    v_mfma_f32_16x16x32_bf16 v[196:199], a[48:51], a[80:83], v[196:199]
    v_mfma_f32_16x16x32_bf16 v[200:203], a[48:51], a[84:87], v[200:203]
    v_mfma_f32_16x16x32_bf16 v[204:207], a[48:51], a[88:91], v[204:207]
    ds_read_b64_tr_b16 a[48:49], v241 offset:42368
    v_mfma_f32_16x16x32_bf16 v[220:223], a[52:55], a[88:91], v[220:223]
    ds_read_b64_tr_b16 a[50:51], v241 offset:42880
    v_mfma_f32_16x16x32_bf16 v[216:219], a[52:55], a[84:87], v[216:219]
    v_mfma_f32_16x16x32_bf16 v[212:215], a[52:55], a[80:83], v[212:215]
    v_mfma_f32_16x16x32_bf16 v[208:211], a[52:55], a[76:79], v[208:211]
    ds_read_b64_tr_b16 a[52:53], v241 offset:42400
    v_mfma_f32_16x16x32_bf16 v[224:227], a[56:59], a[76:79], v[224:227]
    ds_read_b64_tr_b16 a[54:55], v241 offset:42912
    v_mfma_f32_16x16x32_bf16 v[228:231], a[56:59], a[80:83], v[228:231]
    v_mfma_f32_16x16x32_bf16 v[232:235], a[56:59], a[84:87], v[232:235]
    v_mfma_f32_16x16x32_bf16 v[236:239], a[56:59], a[88:91], v[236:239]
    ds_read_b64_tr_b16 a[56:57], v241 offset:42432
    ds_read_b64_tr_b16 a[58:59], v241 offset:42944
    s_waitcnt vmcnt(12)
    s_barrier
    v_mfma_f32_16x16x32_bf16 v[0:3], a[0:3], a[92:95], v[0:3]
    s_add_u32 m0, s39, 84480
    v_mfma_f32_16x16x32_bf16 v[4:7], a[0:3], a[96:99], v[4:7]
    buffer_load_dwordx4 v242, s[8:11], s37 offen nt lds
    v_mfma_f32_16x16x32_bf16 v[8:11], a[0:3], a[100:103], v[8:11]
    v_mfma_f32_16x16x32_bf16 v[12:15], a[0:3], a[104:107], v[12:15]
    ds_read_b64_tr_b16 a[0:1], v241 offset:50688
    v_mfma_f32_16x16x32_bf16 v[28:31], a[4:7], a[104:107], v[28:31]
    ds_read_b64_tr_b16 a[2:3], v241 offset:51200
    v_mfma_f32_16x16x32_bf16 v[24:27], a[4:7], a[100:103], v[24:27]
    buffer_load_dwordx4 v249, s[8:11], s37 offen offset:1056 nt lds
    v_mfma_f32_16x16x32_bf16 v[20:23], a[4:7], a[96:99], v[20:23]
    v_mfma_f32_16x16x32_bf16 v[16:19], a[4:7], a[92:95], v[16:19]
    ds_read_b64_tr_b16 a[4:5], v241 offset:50720
    v_mfma_f32_16x16x32_bf16 v[32:35], a[8:11], a[92:95], v[32:35]
    ds_read_b64_tr_b16 a[6:7], v241 offset:51232
    s_add_u32 m0, s39, 92928
    v_mfma_f32_16x16x32_bf16 v[36:39], a[8:11], a[96:99], v[36:39]
    buffer_load_dwordx4 v243, s[12:15], s38 offen nt lds
    v_mfma_f32_16x16x32_bf16 v[40:43], a[8:11], a[100:103], v[40:43]
    v_mfma_f32_16x16x32_bf16 v[44:47], a[8:11], a[104:107], v[44:47]
    ds_read_b64_tr_b16 a[8:9], v241 offset:50752
    v_mfma_f32_16x16x32_bf16 v[60:63], a[12:15], a[104:107], v[60:63]
    ds_read_b64_tr_b16 a[10:11], v241 offset:51264
    v_mfma_f32_16x16x32_bf16 v[56:59], a[12:15], a[100:103], v[56:59]
    buffer_load_dwordx4 v250, s[12:15], s38 offen offset:1056 nt lds
    v_mfma_f32_16x16x32_bf16 v[52:55], a[12:15], a[96:99], v[52:55]
    v_mfma_f32_16x16x32_bf16 v[48:51], a[12:15], a[92:95], v[48:51]
    ds_read_b64_tr_b16 a[12:13], v241 offset:50784
    v_mfma_f32_16x16x32_bf16 v[64:67], a[16:19], a[92:95], v[64:67]
    ds_read_b64_tr_b16 a[14:15], v241 offset:51296
    v_mfma_f32_16x16x32_bf16 v[68:71], a[16:19], a[96:99], v[68:71]
    s_add_u32 s37, s37, 262144
    v_mfma_f32_16x16x32_bf16 v[72:75], a[16:19], a[100:103], v[72:75]
    s_add_u32 s38, s38, 229376
    v_mfma_f32_16x16x32_bf16 v[76:79], a[16:19], a[104:107], v[76:79]
    ds_read_b64_tr_b16 a[16:17], v241 offset:50816
    v_mfma_f32_16x16x32_bf16 v[92:95], a[20:23], a[104:107], v[92:95]
    ds_read_b64_tr_b16 a[18:19], v241 offset:51328
    v_mfma_f32_16x16x32_bf16 v[88:91], a[20:23], a[100:103], v[88:91]
    v_mfma_f32_16x16x32_bf16 v[84:87], a[20:23], a[96:99], v[84:87]
    v_mfma_f32_16x16x32_bf16 v[80:83], a[20:23], a[92:95], v[80:83]
    ds_read_b64_tr_b16 a[20:21], v241 offset:50848
    v_mfma_f32_16x16x32_bf16 v[96:99], a[24:27], a[92:95], v[96:99]
    ds_read_b64_tr_b16 a[22:23], v241 offset:51360
    v_mfma_f32_16x16x32_bf16 v[100:103], a[24:27], a[96:99], v[100:103]
    v_mfma_f32_16x16x32_bf16 v[104:107], a[24:27], a[100:103], v[104:107]
    v_mfma_f32_16x16x32_bf16 v[108:111], a[24:27], a[104:107], v[108:111]
    ds_read_b64_tr_b16 a[24:25], v241 offset:50880
    s_waitcnt lgkmcnt(9)
    v_mfma_f32_16x16x32_bf16 v[124:127], a[28:31], a[104:107], v[124:127]
    ds_read_b64_tr_b16 a[26:27], v241 offset:51392
    v_mfma_f32_16x16x32_bf16 v[120:123], a[28:31], a[100:103], v[120:123]
    v_mfma_f32_16x16x32_bf16 v[116:119], a[28:31], a[96:99], v[116:119]
    buffer_load_dwordx4 a[140:143], v244, s[24:27], s36 offen offset:0 sc1
    v_mfma_f32_16x16x32_bf16 v[112:115], a[28:31], a[92:95], v[112:115]
    ds_read_b64_tr_b16 a[28:29], v241 offset:50912
    v_mfma_f32_16x16x32_bf16 v[128:131], a[32:35], a[92:95], v[128:131]
    ds_read_b64_tr_b16 a[30:31], v241 offset:51424
    v_mfma_f32_16x16x32_bf16 v[132:135], a[32:35], a[96:99], v[132:135]
    v_mfma_f32_16x16x32_bf16 v[136:139], a[32:35], a[100:103], v[136:139]
    buffer_load_dwordx4 a[144:147], v244, s[24:27], s36 offen offset:1024 sc1
    v_mfma_f32_16x16x32_bf16 v[140:143], a[32:35], a[104:107], v[140:143]
    ds_read_b64_tr_b16 a[32:33], v241 offset:59136
    v_mfma_f32_16x16x32_bf16 v[156:159], a[36:39], a[104:107], v[156:159]
    ds_read_b64_tr_b16 a[34:35], v241 offset:59648
    v_mfma_f32_16x16x32_bf16 v[152:155], a[36:39], a[100:103], v[152:155]
    v_mfma_f32_16x16x32_bf16 v[148:151], a[36:39], a[96:99], v[148:151]
    buffer_load_dwordx4 a[148:151], v244, s[24:27], s36 offen offset:2048 sc1
    v_mfma_f32_16x16x32_bf16 v[144:147], a[36:39], a[92:95], v[144:147]
    ds_read_b64_tr_b16 a[36:37], v241 offset:59168
    v_mfma_f32_16x16x32_bf16 v[160:163], a[40:43], a[92:95], v[160:163]
    ds_read_b64_tr_b16 a[38:39], v241 offset:59680
    v_mfma_f32_16x16x32_bf16 v[164:167], a[40:43], a[96:99], v[164:167]
    v_mfma_f32_16x16x32_bf16 v[168:171], a[40:43], a[100:103], v[168:171]
    buffer_load_dwordx4 a[152:155], v244, s[24:27], s36 offen offset:3072 sc1
    v_mfma_f32_16x16x32_bf16 v[172:175], a[40:43], a[104:107], v[172:175]
    ds_read_b64_tr_b16 a[40:41], v241 offset:59200
    v_mfma_f32_16x16x32_bf16 v[188:191], a[44:47], a[104:107], v[188:191]
    ds_read_b64_tr_b16 a[42:43], v241 offset:59712
    v_mfma_f32_16x16x32_bf16 v[184:187], a[44:47], a[100:103], v[184:187]
    v_mfma_f32_16x16x32_bf16 v[180:183], a[44:47], a[96:99], v[180:183]
    s_add_u32 s36, s36, 4096
    v_mfma_f32_16x16x32_bf16 v[176:179], a[44:47], a[92:95], v[176:179]
    ds_read_b64_tr_b16 a[44:45], v241 offset:59232
    v_mfma_f32_16x16x32_bf16 v[192:195], a[48:51], a[92:95], v[192:195]
    ds_read_b64_tr_b16 a[46:47], v241 offset:59744
    v_mfma_f32_16x16x32_bf16 v[196:199], a[48:51], a[96:99], v[196:199]
    v_mfma_f32_16x16x32_bf16 v[200:203], a[48:51], a[100:103], v[200:203]
    v_mfma_f32_16x16x32_bf16 v[204:207], a[48:51], a[104:107], v[204:207]
    ds_read_b64_tr_b16 a[48:49], v241 offset:59264
    v_mfma_f32_16x16x32_bf16 v[220:223], a[52:55], a[104:107], v[220:223]
    ds_read_b64_tr_b16 a[50:51], v241 offset:59776
    v_mfma_f32_16x16x32_bf16 v[216:219], a[52:55], a[100:103], v[216:219]
    v_mfma_f32_16x16x32_bf16 v[212:215], a[52:55], a[96:99], v[212:215]
    v_mfma_f32_16x16x32_bf16 v[208:211], a[52:55], a[92:95], v[208:211]
    ds_read_b64_tr_b16 a[52:53], v241 offset:59296
    v_mfma_f32_16x16x32_bf16 v[224:227], a[56:59], a[92:95], v[224:227]
    ds_read_b64_tr_b16 a[54:55], v241 offset:59808
    v_mfma_f32_16x16x32_bf16 v[228:231], a[56:59], a[96:99], v[228:231]
    v_mfma_f32_16x16x32_bf16 v[232:235], a[56:59], a[100:103], v[232:235]
    v_mfma_f32_16x16x32_bf16 v[236:239], a[56:59], a[104:107], v[236:239]
    ds_read_b64_tr_b16 a[56:57], v241 offset:59328
    ds_read_b64_tr_b16 a[58:59], v241 offset:59840
    s_waitcnt vmcnt(12)
    s_barrier
    v_mfma_f32_16x16x32_bf16 v[0:3], a[0:3], a[108:111], v[0:3]
    v_add_u32 v241, 67584, v241
    s_add_u32 m0, s39, 101376
    v_mfma_f32_16x16x32_bf16 v[4:7], a[0:3], a[112:115], v[4:7]
    buffer_load_dwordx4 v242, s[8:11], s37 offen nt lds
    v_mfma_f32_16x16x32_bf16 v[8:11], a[0:3], a[116:119], v[8:11]
    v_mfma_f32_16x16x32_bf16 v[12:15], a[0:3], a[120:123], v[12:15]
    ds_read_b64_tr_b16 a[0:1], v241 offset:0
    v_mfma_f32_16x16x32_bf16 v[28:31], a[4:7], a[120:123], v[28:31]
    ds_read_b64_tr_b16 a[2:3], v241 offset:512
    v_mfma_f32_16x16x32_bf16 v[24:27], a[4:7], a[116:119], v[24:27]
    buffer_load_dwordx4 v249, s[8:11], s37 offen offset:1056 nt lds
    v_mfma_f32_16x16x32_bf16 v[20:23], a[4:7], a[112:115], v[20:23]
    v_mfma_f32_16x16x32_bf16 v[16:19], a[4:7], a[108:111], v[16:19]
    ds_read_b64_tr_b16 a[4:5], v241 offset:32
    s_waitcnt lgkmcnt(9)
    v_mfma_f32_16x16x32_bf16 v[32:35], a[8:11], a[108:111], v[32:35]
    ds_read_b64_tr_b16 a[6:7], v241 offset:544
    s_add_u32 m0, s39, 109824
    v_mfma_f32_16x16x32_bf16 v[36:39], a[8:11], a[112:115], v[36:39]
    buffer_load_dwordx4 v243, s[12:15], s38 offen nt lds
    v_mfma_f32_16x16x32_bf16 v[40:43], a[8:11], a[116:119], v[40:43]
    v_mfma_f32_16x16x32_bf16 v[44:47], a[8:11], a[120:123], v[44:47]
    ds_read_b64_tr_b16 a[8:9], v241 offset:64
    v_mfma_f32_16x16x32_bf16 v[60:63], a[12:15], a[120:123], v[60:63]
    ds_read_b64_tr_b16 a[10:11], v241 offset:576
    v_mfma_f32_16x16x32_bf16 v[56:59], a[12:15], a[116:119], v[56:59]
    buffer_load_dwordx4 v250, s[12:15], s38 offen offset:1056 nt lds
    v_mfma_f32_16x16x32_bf16 v[52:55], a[12:15], a[112:115], v[52:55]
    v_mfma_f32_16x16x32_bf16 v[48:51], a[12:15], a[108:111], v[48:51]
    ds_read_b64_tr_b16 a[12:13], v241 offset:96
    v_mfma_f32_16x16x32_bf16 v[64:67], a[16:19], a[108:111], v[64:67]
    ds_read_b64_tr_b16 a[14:15], v241 offset:608
    v_mfma_f32_16x16x32_bf16 v[68:71], a[16:19], a[112:115], v[68:71]
    s_add_u32 s37, s37, 262144
    v_mfma_f32_16x16x32_bf16 v[72:75], a[16:19], a[116:119], v[72:75]
    s_add_u32 s38, s38, 229376
    v_mfma_f32_16x16x32_bf16 v[76:79], a[16:19], a[120:123], v[76:79]
    ds_read_b64_tr_b16 a[16:17], v241 offset:128
    v_mfma_f32_16x16x32_bf16 v[92:95], a[20:23], a[120:123], v[92:95]
    ds_read_b64_tr_b16 a[18:19], v241 offset:640
    v_mfma_f32_16x16x32_bf16 v[88:91], a[20:23], a[116:119], v[88:91]
    v_mfma_f32_16x16x32_bf16 v[84:87], a[20:23], a[112:115], v[84:87]
    v_mfma_f32_16x16x32_bf16 v[80:83], a[20:23], a[108:111], v[80:83]
    ds_read_b64_tr_b16 a[20:21], v241 offset:160
    v_mfma_f32_16x16x32_bf16 v[96:99], a[24:27], a[108:111], v[96:99]
    ds_read_b64_tr_b16 a[22:23], v241 offset:672
    v_mfma_f32_16x16x32_bf16 v[100:103], a[24:27], a[112:115], v[100:103]
    v_mfma_f32_16x16x32_bf16 v[104:107], a[24:27], a[116:119], v[104:107]
    v_mfma_f32_16x16x32_bf16 v[108:111], a[24:27], a[120:123], v[108:111]
    ds_read_b64_tr_b16 a[24:25], v241 offset:192
    v_mfma_f32_16x16x32_bf16 v[124:127], a[28:31], a[120:123], v[124:127]
    ds_read_b64_tr_b16 a[26:27], v241 offset:704
    v_mfma_f32_16x16x32_bf16 v[120:123], a[28:31], a[116:119], v[120:123]
    v_mfma_f32_16x16x32_bf16 v[116:119], a[28:31], a[112:115], v[116:119]
    buffer_load_dwordx4 a[156:159], v244, s[24:27], s36 offen offset:0 sc1
    v_mfma_f32_16x16x32_bf16 v[112:115], a[28:31], a[108:111], v[112:115]
    ds_read_b64_tr_b16 a[28:29], v241 offset:224
    v_mfma_f32_16x16x32_bf16 v[128:131], a[32:35], a[108:111], v[128:131]
    ds_read_b64_tr_b16 a[30:31], v241 offset:736
    v_mfma_f32_16x16x32_bf16 v[132:135], a[32:35], a[112:115], v[132:135]
    v_mfma_f32_16x16x32_bf16 v[136:139], a[32:35], a[116:119], v[136:139]
    buffer_load_dwordx4 a[160:163], v244, s[24:27], s36 offen offset:1024 sc1
    v_mfma_f32_16x16x32_bf16 v[140:143], a[32:35], a[120:123], v[140:143]
    ds_read_b64_tr_b16 a[32:33], v241 offset:8448
    v_mfma_f32_16x16x32_bf16 v[156:159], a[36:39], a[120:123], v[156:159]
    ds_read_b64_tr_b16 a[34:35], v241 offset:8960
    v_mfma_f32_16x16x32_bf16 v[152:155], a[36:39], a[116:119], v[152:155]
    v_mfma_f32_16x16x32_bf16 v[148:151], a[36:39], a[112:115], v[148:151]
    buffer_load_dwordx4 a[164:167], v244, s[24:27], s36 offen offset:2048 sc1
    v_mfma_f32_16x16x32_bf16 v[144:147], a[36:39], a[108:111], v[144:147]
    ds_read_b64_tr_b16 a[36:37], v241 offset:8480
    v_mfma_f32_16x16x32_bf16 v[160:163], a[40:43], a[108:111], v[160:163]
    ds_read_b64_tr_b16 a[38:39], v241 offset:8992
    v_mfma_f32_16x16x32_bf16 v[164:167], a[40:43], a[112:115], v[164:167]
    v_mfma_f32_16x16x32_bf16 v[168:171], a[40:43], a[116:119], v[168:171]
    buffer_load_dwordx4 a[168:171], v244, s[24:27], s36 offen offset:3072 sc1
    v_mfma_f32_16x16x32_bf16 v[172:175], a[40:43], a[120:123], v[172:175]
    ds_read_b64_tr_b16 a[40:41], v241 offset:8512
    v_mfma_f32_16x16x32_bf16 v[188:191], a[44:47], a[120:123], v[188:191]
    ds_read_b64_tr_b16 a[42:43], v241 offset:9024
    v_mfma_f32_16x16x32_bf16 v[184:187], a[44:47], a[116:119], v[184:187]
    v_mfma_f32_16x16x32_bf16 v[180:183], a[44:47], a[112:115], v[180:183]
    s_add_u32 s36, s36, 4096
    v_mfma_f32_16x16x32_bf16 v[176:179], a[44:47], a[108:111], v[176:179]
    ds_read_b64_tr_b16 a[44:45], v241 offset:8544
    s_waitcnt lgkmcnt(9)
    v_mfma_f32_16x16x32_bf16 v[192:195], a[48:51], a[108:111], v[192:195]
    ds_read_b64_tr_b16 a[46:47], v241 offset:9056
    v_mfma_f32_16x16x32_bf16 v[196:199], a[48:51], a[112:115], v[196:199]
    v_mfma_f32_16x16x32_bf16 v[200:203], a[48:51], a[116:119], v[200:203]
    v_mfma_f32_16x16x32_bf16 v[204:207], a[48:51], a[120:123], v[204:207]
    ds_read_b64_tr_b16 a[48:49], v241 offset:8576
    v_mfma_f32_16x16x32_bf16 v[220:223], a[52:55], a[120:123], v[220:223]
    ds_read_b64_tr_b16 a[50:51], v241 offset:9088
    v_mfma_f32_16x16x32_bf16 v[216:219], a[52:55], a[116:119], v[216:219]
    v_mfma_f32_16x16x32_bf16 v[212:215], a[52:55], a[112:115], v[212:215]
    v_mfma_f32_16x16x32_bf16 v[208:211], a[52:55], a[108:111], v[208:211]
    ds_read_b64_tr_b16 a[52:53], v241 offset:8608
    v_mfma_f32_16x16x32_bf16 v[224:227], a[56:59], a[108:111], v[224:227]
    ds_read_b64_tr_b16 a[54:55], v241 offset:9120
    v_mfma_f32_16x16x32_bf16 v[228:231], a[56:59], a[112:115], v[228:231]
    v_mfma_f32_16x16x32_bf16 v[232:235], a[56:59], a[116:119], v[232:235]
    v_mfma_f32_16x16x32_bf16 v[236:239], a[56:59], a[120:123], v[236:239]
    ds_read_b64_tr_b16 a[56:57], v241 offset:8640
    ds_read_b64_tr_b16 a[58:59], v241 offset:9152
    s_waitcnt vmcnt(12)
    s_barrier
    v_mfma_f32_16x16x32_bf16 v[0:3], a[0:3], a[124:127], v[0:3]
    s_add_u32 m0, s39, 118272
    v_mfma_f32_16x16x32_bf16 v[4:7], a[0:3], a[128:131], v[4:7]
    buffer_load_dwordx4 v242, s[8:11], s37 offen nt lds
    v_mfma_f32_16x16x32_bf16 v[8:11], a[0:3], a[132:135], v[8:11]
    v_mfma_f32_16x16x32_bf16 v[12:15], a[0:3], a[136:139], v[12:15]
    ds_read_b64_tr_b16 a[0:1], v241 offset:16896
    v_mfma_f32_16x16x32_bf16 v[28:31], a[4:7], a[136:139], v[28:31]
    ds_read_b64_tr_b16 a[2:3], v241 offset:17408
    v_mfma_f32_16x16x32_bf16 v[24:27], a[4:7], a[132:135], v[24:27]
    buffer_load_dwordx4 v249, s[8:11], s37 offen offset:1056 nt lds
    v_mfma_f32_16x16x32_bf16 v[20:23], a[4:7], a[128:131], v[20:23]
    v_mfma_f32_16x16x32_bf16 v[16:19], a[4:7], a[124:127], v[16:19]
    ds_read_b64_tr_b16 a[4:5], v241 offset:16928
    v_mfma_f32_16x16x32_bf16 v[32:35], a[8:11], a[124:127], v[32:35]
    ds_read_b64_tr_b16 a[6:7], v241 offset:17440
    s_add_u32 m0, s39, 126720
    v_mfma_f32_16x16x32_bf16 v[36:39], a[8:11], a[128:131], v[36:39]
    buffer_load_dwordx4 v243, s[12:15], s38 offen nt lds
    v_mfma_f32_16x16x32_bf16 v[40:43], a[8:11], a[132:135], v[40:43]
    v_mfma_f32_16x16x32_bf16 v[44:47], a[8:11], a[136:139], v[44:47]
    ds_read_b64_tr_b16 a[8:9], v241 offset:16960
    v_mfma_f32_16x16x32_bf16 v[60:63], a[12:15], a[136:139], v[60:63]
    ds_read_b64_tr_b16 a[10:11], v241 offset:17472
    v_mfma_f32_16x16x32_bf16 v[56:59], a[12:15], a[132:135], v[56:59]
    buffer_load_dwordx4 v250, s[12:15], s38 offen offset:1056 nt lds
    v_mfma_f32_16x16x32_bf16 v[52:55], a[12:15], a[128:131], v[52:55]
    v_mfma_f32_16x16x32_bf16 v[48:51], a[12:15], a[124:127], v[48:51]
    ds_read_b64_tr_b16 a[12:13], v241 offset:16992
    v_mfma_f32_16x16x32_bf16 v[64:67], a[16:19], a[124:127], v[64:67]
    ds_read_b64_tr_b16 a[14:15], v241 offset:17504
    v_mfma_f32_16x16x32_bf16 v[68:71], a[16:19], a[128:131], v[68:71]
    s_add_u32 s37, s37, 262144
    v_mfma_f32_16x16x32_bf16 v[72:75], a[16:19], a[132:135], v[72:75]
    s_add_u32 s38, s38, 229376
    v_mfma_f32_16x16x32_bf16 v[76:79], a[16:19], a[136:139], v[76:79]
    ds_read_b64_tr_b16 a[16:17], v241 offset:17024
    v_mfma_f32_16x16x32_bf16 v[92:95], a[20:23], a[136:139], v[92:95]
    ds_read_b64_tr_b16 a[18:19], v241 offset:17536
    v_mfma_f32_16x16x32_bf16 v[88:91], a[20:23], a[132:135], v[88:91]
    v_mfma_f32_16x16x32_bf16 v[84:87], a[20:23], a[128:131], v[84:87]
    v_mfma_f32_16x16x32_bf16 v[80:83], a[20:23], a[124:127], v[80:83]
    ds_read_b64_tr_b16 a[20:21], v241 offset:17056
    v_mfma_f32_16x16x32_bf16 v[96:99], a[24:27], a[124:127], v[96:99]
    ds_read_b64_tr_b16 a[22:23], v241 offset:17568
    v_mfma_f32_16x16x32_bf16 v[100:103], a[24:27], a[128:131], v[100:103]
    v_mfma_f32_16x16x32_bf16 v[104:107], a[24:27], a[132:135], v[104:107]
    v_mfma_f32_16x16x32_bf16 v[108:111], a[24:27], a[136:139], v[108:111]
    ds_read_b64_tr_b16 a[24:25], v241 offset:17088
    s_waitcnt lgkmcnt(9)
    v_mfma_f32_16x16x32_bf16 v[124:127], a[28:31], a[136:139], v[124:127]
    ds_read_b64_tr_b16 a[26:27], v241 offset:17600
    v_mfma_f32_16x16x32_bf16 v[120:123], a[28:31], a[132:135], v[120:123]
    v_mfma_f32_16x16x32_bf16 v[116:119], a[28:31], a[128:131], v[116:119]
    buffer_load_dwordx4 a[172:175], v244, s[24:27], s36 offen offset:0 sc1
    v_mfma_f32_16x16x32_bf16 v[112:115], a[28:31], a[124:127], v[112:115]
    ds_read_b64_tr_b16 a[28:29], v241 offset:17120
    v_mfma_f32_16x16x32_bf16 v[128:131], a[32:35], a[124:127], v[128:131]
    ds_read_b64_tr_b16 a[30:31], v241 offset:17632
    v_mfma_f32_16x16x32_bf16 v[132:135], a[32:35], a[128:131], v[132:135]
    v_mfma_f32_16x16x32_bf16 v[136:139], a[32:35], a[132:135], v[136:139]
    buffer_load_dwordx4 a[176:179], v244, s[24:27], s36 offen offset:1024 sc1
    v_mfma_f32_16x16x32_bf16 v[140:143], a[32:35], a[136:139], v[140:143]
    ds_read_b64_tr_b16 a[32:33], v241 offset:25344
    v_mfma_f32_16x16x32_bf16 v[156:159], a[36:39], a[136:139], v[156:159]
    ds_read_b64_tr_b16 a[34:35], v241 offset:25856
    v_mfma_f32_16x16x32_bf16 v[152:155], a[36:39], a[132:135], v[152:155]
    v_mfma_f32_16x16x32_bf16 v[148:151], a[36:39], a[128:131], v[148:151]
    buffer_load_dwordx4 a[180:183], v244, s[24:27], s36 offen offset:2048 sc1
    v_mfma_f32_16x16x32_bf16 v[144:147], a[36:39], a[124:127], v[144:147]
    ds_read_b64_tr_b16 a[36:37], v241 offset:25376
    v_mfma_f32_16x16x32_bf16 v[160:163], a[40:43], a[124:127], v[160:163]
    ds_read_b64_tr_b16 a[38:39], v241 offset:25888
    v_mfma_f32_16x16x32_bf16 v[164:167], a[40:43], a[128:131], v[164:167]
    v_mfma_f32_16x16x32_bf16 v[168:171], a[40:43], a[132:135], v[168:171]
    buffer_load_dwordx4 a[184:187], v244, s[24:27], s36 offen offset:3072 sc1
    v_mfma_f32_16x16x32_bf16 v[172:175], a[40:43], a[136:139], v[172:175]
    ds_read_b64_tr_b16 a[40:41], v241 offset:25408
    v_mfma_f32_16x16x32_bf16 v[188:191], a[44:47], a[136:139], v[188:191]
    ds_read_b64_tr_b16 a[42:43], v241 offset:25920
    v_mfma_f32_16x16x32_bf16 v[184:187], a[44:47], a[132:135], v[184:187]
    v_mfma_f32_16x16x32_bf16 v[180:183], a[44:47], a[128:131], v[180:183]
    s_add_u32 s36, s36, 4096
    v_mfma_f32_16x16x32_bf16 v[176:179], a[44:47], a[124:127], v[176:179]
    ds_read_b64_tr_b16 a[44:45], v241 offset:25440
    v_mfma_f32_16x16x32_bf16 v[192:195], a[48:51], a[124:127], v[192:195]
    ds_read_b64_tr_b16 a[46:47], v241 offset:25952
    v_mfma_f32_16x16x32_bf16 v[196:199], a[48:51], a[128:131], v[196:199]
    v_mfma_f32_16x16x32_bf16 v[200:203], a[48:51], a[132:135], v[200:203]
    v_mfma_f32_16x16x32_bf16 v[204:207], a[48:51], a[136:139], v[204:207]
    ds_read_b64_tr_b16 a[48:49], v241 offset:25472
    v_mfma_f32_16x16x32_bf16 v[220:223], a[52:55], a[136:139], v[220:223]
    ds_read_b64_tr_b16 a[50:51], v241 offset:25984
    v_mfma_f32_16x16x32_bf16 v[216:219], a[52:55], a[132:135], v[216:219]
    v_mfma_f32_16x16x32_bf16 v[212:215], a[52:55], a[128:131], v[212:215]
    v_mfma_f32_16x16x32_bf16 v[208:211], a[52:55], a[124:127], v[208:211]
    ds_read_b64_tr_b16 a[52:53], v241 offset:25504
    v_mfma_f32_16x16x32_bf16 v[224:227], a[56:59], a[124:127], v[224:227]
    ds_read_b64_tr_b16 a[54:55], v241 offset:26016
    v_mfma_f32_16x16x32_bf16 v[228:231], a[56:59], a[128:131], v[228:231]
    v_mfma_f32_16x16x32_bf16 v[232:235], a[56:59], a[132:135], v[232:235]
    v_mfma_f32_16x16x32_bf16 v[236:239], a[56:59], a[136:139], v[236:239]
    ds_read_b64_tr_b16 a[56:57], v241 offset:25536
    ds_read_b64_tr_b16 a[58:59], v241 offset:26048
    s_waitcnt vmcnt(12)
    s_barrier
    s_cmp_eq_u32 s44, s47
    s_cbranch_scc0 pa_kvl
    buffer_load_dword v252, v248, s[16:19], s48 offen sc1
pa_kvl:
    v_mfma_f32_16x16x32_bf16 v[0:3], a[0:3], a[140:143], v[0:3]
    s_add_u32 m0, s39, 0
    v_mfma_f32_16x16x32_bf16 v[4:7], a[0:3], a[144:147], v[4:7]
    buffer_load_dwordx4 v242, s[8:11], s37 offen nt lds
    v_mfma_f32_16x16x32_bf16 v[8:11], a[0:3], a[148:151], v[8:11]
    v_mfma_f32_16x16x32_bf16 v[12:15], a[0:3], a[152:155], v[12:15]
    ds_read_b64_tr_b16 a[0:1], v241 offset:33792
    v_mfma_f32_16x16x32_bf16 v[28:31], a[4:7], a[152:155], v[28:31]
    ds_read_b64_tr_b16 a[2:3], v241 offset:34304
    v_mfma_f32_16x16x32_bf16 v[24:27], a[4:7], a[148:151], v[24:27]
    buffer_load_dwordx4 v249, s[8:11], s37 offen offset:1056 nt lds
    v_mfma_f32_16x16x32_bf16 v[20:23], a[4:7], a[144:147], v[20:23]
    v_mfma_f32_16x16x32_bf16 v[16:19], a[4:7], a[140:143], v[16:19]
    ds_read_b64_tr_b16 a[4:5], v241 offset:33824
    s_waitcnt lgkmcnt(9)
    v_mfma_f32_16x16x32_bf16 v[32:35], a[8:11], a[140:143], v[32:35]
    ds_read_b64_tr_b16 a[6:7], v241 offset:34336
    s_add_u32 m0, s39, 8448
    v_mfma_f32_16x16x32_bf16 v[36:39], a[8:11], a[144:147], v[36:39]
    buffer_load_dwordx4 v243, s[12:15], s38 offen nt lds
    v_mfma_f32_16x16x32_bf16 v[40:43], a[8:11], a[148:151], v[40:43]
    v_mfma_f32_16x16x32_bf16 v[44:47], a[8:11], a[152:155], v[44:47]
    ds_read_b64_tr_b16 a[8:9], v241 offset:33856
    v_mfma_f32_16x16x32_bf16 v[60:63], a[12:15], a[152:155], v[60:63]
    ds_read_b64_tr_b16 a[10:11], v241 offset:34368
    v_mfma_f32_16x16x32_bf16 v[56:59], a[12:15], a[148:151], v[56:59]
    buffer_load_dwordx4 v250, s[12:15], s38 offen offset:1056 nt lds
    v_mfma_f32_16x16x32_bf16 v[52:55], a[12:15], a[144:147], v[52:55]
    v_mfma_f32_16x16x32_bf16 v[48:51], a[12:15], a[140:143], v[48:51]
    ds_read_b64_tr_b16 a[12:13], v241 offset:33888
    v_mfma_f32_16x16x32_bf16 v[64:67], a[16:19], a[140:143], v[64:67]
    ds_read_b64_tr_b16 a[14:15], v241 offset:34400
    v_mfma_f32_16x16x32_bf16 v[68:71], a[16:19], a[144:147], v[68:71]
    s_add_u32 s37, s37, 262144
    v_mfma_f32_16x16x32_bf16 v[72:75], a[16:19], a[148:151], v[72:75]
    s_add_u32 s38, s38, 229376
    v_mfma_f32_16x16x32_bf16 v[76:79], a[16:19], a[152:155], v[76:79]
    ds_read_b64_tr_b16 a[16:17], v241 offset:33920
    v_mfma_f32_16x16x32_bf16 v[92:95], a[20:23], a[152:155], v[92:95]
    ds_read_b64_tr_b16 a[18:19], v241 offset:34432
    v_mfma_f32_16x16x32_bf16 v[88:91], a[20:23], a[148:151], v[88:91]
    v_mfma_f32_16x16x32_bf16 v[84:87], a[20:23], a[144:147], v[84:87]
    v_mfma_f32_16x16x32_bf16 v[80:83], a[20:23], a[140:143], v[80:83]
    ds_read_b64_tr_b16 a[20:21], v241 offset:33952
    v_mfma_f32_16x16x32_bf16 v[96:99], a[24:27], a[140:143], v[96:99]
    ds_read_b64_tr_b16 a[22:23], v241 offset:34464
    v_mfma_f32_16x16x32_bf16 v[100:103], a[24:27], a[144:147], v[100:103]
    v_mfma_f32_16x16x32_bf16 v[104:107], a[24:27], a[148:151], v[104:107]
    v_mfma_f32_16x16x32_bf16 v[108:111], a[24:27], a[152:155], v[108:111]
    ds_read_b64_tr_b16 a[24:25], v241 offset:33984
    v_mfma_f32_16x16x32_bf16 v[124:127], a[28:31], a[152:155], v[124:127]
    ds_read_b64_tr_b16 a[26:27], v241 offset:34496
    v_mfma_f32_16x16x32_bf16 v[120:123], a[28:31], a[148:151], v[120:123]
    v_mfma_f32_16x16x32_bf16 v[116:119], a[28:31], a[144:147], v[116:119]
    buffer_load_dwordx4 a[60:63], v244, s[24:27], s36 offen offset:0 sc1
    v_mfma_f32_16x16x32_bf16 v[112:115], a[28:31], a[140:143], v[112:115]
    ds_read_b64_tr_b16 a[28:29], v241 offset:34016
    v_mfma_f32_16x16x32_bf16 v[128:131], a[32:35], a[140:143], v[128:131]
    ds_read_b64_tr_b16 a[30:31], v241 offset:34528
    v_mfma_f32_16x16x32_bf16 v[132:135], a[32:35], a[144:147], v[132:135]
    v_mfma_f32_16x16x32_bf16 v[136:139], a[32:35], a[148:151], v[136:139]
    buffer_load_dwordx4 a[64:67], v244, s[24:27], s36 offen offset:1024 sc1
    v_mfma_f32_16x16x32_bf16 v[140:143], a[32:35], a[152:155], v[140:143]
    ds_read_b64_tr_b16 a[32:33], v241 offset:42240
    v_mfma_f32_16x16x32_bf16 v[156:159], a[36:39], a[152:155], v[156:159]
    ds_read_b64_tr_b16 a[34:35], v241 offset:42752
    v_mfma_f32_16x16x32_bf16 v[152:155], a[36:39], a[148:151], v[152:155]
    v_mfma_f32_16x16x32_bf16 v[148:151], a[36:39], a[144:147], v[148:151]
    buffer_load_dwordx4 a[68:71], v244, s[24:27], s36 offen offset:2048 sc1
    v_mfma_f32_16x16x32_bf16 v[144:147], a[36:39], a[140:143], v[144:147]
    ds_read_b64_tr_b16 a[36:37], v241 offset:42272
    v_mfma_f32_16x16x32_bf16 v[160:163], a[40:43], a[140:143], v[160:163]
    ds_read_b64_tr_b16 a[38:39], v241 offset:42784
    v_mfma_f32_16x16x32_bf16 v[164:167], a[40:43], a[144:147], v[164:167]
    v_mfma_f32_16x16x32_bf16 v[168:171], a[40:43], a[148:151], v[168:171]
    buffer_load_dwordx4 a[72:75], v244, s[24:27], s36 offen offset:3072 sc1
    v_mfma_f32_16x16x32_bf16 v[172:175], a[40:43], a[152:155], v[172:175]
    ds_read_b64_tr_b16 a[40:41], v241 offset:42304
    v_mfma_f32_16x16x32_bf16 v[188:191], a[44:47], a[152:155], v[188:191]
    ds_read_b64_tr_b16 a[42:43], v241 offset:42816
    v_mfma_f32_16x16x32_bf16 v[184:187], a[44:47], a[148:151], v[184:187]
    v_mfma_f32_16x16x32_bf16 v[180:183], a[44:47], a[144:147], v[180:183]
    s_add_u32 s36, s36, 4096
    v_mfma_f32_16x16x32_bf16 v[176:179], a[44:47], a[140:143], v[176:179]
    ds_read_b64_tr_b16 a[44:45], v241 offset:42336
    s_waitcnt lgkmcnt(9)
    v_mfma_f32_16x16x32_bf16 v[192:195], a[48:51], a[140:143], v[192:195]
    ds_read_b64_tr_b16 a[46:47], v241 offset:42848
    v_mfma_f32_16x16x32_bf16 v[196:199], a[48:51], a[144:147], v[196:199]
    v_mfma_f32_16x16x32_bf16 v[200:203], a[48:51], a[148:151], v[200:203]
    v_mfma_f32_16x16x32_bf16 v[204:207], a[48:51], a[152:155], v[204:207]
    ds_read_b64_tr_b16 a[48:49], v241 offset:42368
    v_mfma_f32_16x16x32_bf16 v[220:223], a[52:55], a[152:155], v[220:223]
    ds_read_b64_tr_b16 a[50:51], v241 offset:42880
    v_mfma_f32_16x16x32_bf16 v[216:219], a[52:55], a[148:151], v[216:219]
    v_mfma_f32_16x16x32_bf16 v[212:215], a[52:55], a[144:147], v[212:215]
    v_mfma_f32_16x16x32_bf16 v[208:211], a[52:55], a[140:143], v[208:211]
    ds_read_b64_tr_b16 a[52:53], v241 offset:42400
    v_mfma_f32_16x16x32_bf16 v[224:227], a[56:59], a[140:143], v[224:227]
    ds_read_b64_tr_b16 a[54:55], v241 offset:42912
    v_mfma_f32_16x16x32_bf16 v[228:231], a[56:59], a[144:147], v[228:231]
    v_mfma_f32_16x16x32_bf16 v[232:235], a[56:59], a[148:151], v[232:235]
    v_mfma_f32_16x16x32_bf16 v[236:239], a[56:59], a[152:155], v[236:239]
    ds_read_b64_tr_b16 a[56:57], v241 offset:42432
    ds_read_b64_tr_b16 a[58:59], v241 offset:42944
    s_waitcnt vmcnt(12)
    s_barrier
    v_mfma_f32_16x16x32_bf16 v[0:3], a[0:3], a[156:159], v[0:3]
    s_add_u32 m0, s39, 16896
    v_mfma_f32_16x16x32_bf16 v[4:7], a[0:3], a[160:163], v[4:7]
    buffer_load_dwordx4 v242, s[8:11], s37 offen nt lds
    v_mfma_f32_16x16x32_bf16 v[8:11], a[0:3], a[164:167], v[8:11]
    v_mfma_f32_16x16x32_bf16 v[12:15], a[0:3], a[168:171], v[12:15]
    ds_read_b64_tr_b16 a[0:1], v241 offset:50688
    v_mfma_f32_16x16x32_bf16 v[28:31], a[4:7], a[168:171], v[28:31]
    ds_read_b64_tr_b16 a[2:3], v241 offset:51200
    v_mfma_f32_16x16x32_bf16 v[24:27], a[4:7], a[164:167], v[24:27]
    buffer_load_dwordx4 v249, s[8:11], s37 offen offset:1056 nt lds
    v_mfma_f32_16x16x32_bf16 v[20:23], a[4:7], a[160:163], v[20:23]
    v_mfma_f32_16x16x32_bf16 v[16:19], a[4:7], a[156:159], v[16:19]
    ds_read_b64_tr_b16 a[4:5], v241 offset:50720
    v_mfma_f32_16x16x32_bf16 v[32:35], a[8:11], a[156:159], v[32:35]
    ds_read_b64_tr_b16 a[6:7], v241 offset:51232
    s_add_u32 m0, s39, 25344
    v_mfma_f32_16x16x32_bf16 v[36:39], a[8:11], a[160:163], v[36:39]
    buffer_load_dwordx4 v243, s[12:15], s38 offen nt lds
    v_mfma_f32_16x16x32_bf16 v[40:43], a[8:11], a[164:167], v[40:43]
    v_mfma_f32_16x16x32_bf16 v[44:47], a[8:11], a[168:171], v[44:47]
    ds_read_b64_tr_b16 a[8:9], v241 offset:50752
    v_mfma_f32_16x16x32_bf16 v[60:63], a[12:15], a[168:171], v[60:63]
    ds_read_b64_tr_b16 a[10:11], v241 offset:51264
    v_mfma_f32_16x16x32_bf16 v[56:59], a[12:15], a[164:167], v[56:59]
    buffer_load_dwordx4 v250, s[12:15], s38 offen offset:1056 nt lds
    v_mfma_f32_16x16x32_bf16 v[52:55], a[12:15], a[160:163], v[52:55]
    v_mfma_f32_16x16x32_bf16 v[48:51], a[12:15], a[156:159], v[48:51]
    ds_read_b64_tr_b16 a[12:13], v241 offset:50784
    v_mfma_f32_16x16x32_bf16 v[64:67], a[16:19], a[156:159], v[64:67]
    ds_read_b64_tr_b16 a[14:15], v241 offset:51296
    v_mfma_f32_16x16x32_bf16 v[68:71], a[16:19], a[160:163], v[68:71]
    s_add_u32 s37, s37, 262144
    v_mfma_f32_16x16x32_bf16 v[72:75], a[16:19], a[164:167], v[72:75]
    s_add_u32 s38, s38, 229376
    v_mfma_f32_16x16x32_bf16 v[76:79], a[16:19], a[168:171], v[76:79]
    ds_read_b64_tr_b16 a[16:17], v241 offset:50816
    v_mfma_f32_16x16x32_bf16 v[92:95], a[20:23], a[168:171], v[92:95]
    ds_read_b64_tr_b16 a[18:19], v241 offset:51328
    v_mfma_f32_16x16x32_bf16 v[88:91], a[20:23], a[164:167], v[88:91]
    v_mfma_f32_16x16x32_bf16 v[84:87], a[20:23], a[160:163], v[84:87]
    v_mfma_f32_16x16x32_bf16 v[80:83], a[20:23], a[156:159], v[80:83]
    ds_read_b64_tr_b16 a[20:21], v241 offset:50848
    v_mfma_f32_16x16x32_bf16 v[96:99], a[24:27], a[156:159], v[96:99]
    ds_read_b64_tr_b16 a[22:23], v241 offset:51360
    v_mfma_f32_16x16x32_bf16 v[100:103], a[24:27], a[160:163], v[100:103]
    v_mfma_f32_16x16x32_bf16 v[104:107], a[24:27], a[164:167], v[104:107]
    v_mfma_f32_16x16x32_bf16 v[108:111], a[24:27], a[168:171], v[108:111]
    ds_read_b64_tr_b16 a[24:25], v241 offset:50880
    s_waitcnt lgkmcnt(9)
    v_mfma_f32_16x16x32_bf16 v[124:127], a[28:31], a[168:171], v[124:127]
    ds_read_b64_tr_b16 a[26:27], v241 offset:51392
    v_mfma_f32_16x16x32_bf16 v[120:123], a[28:31], a[164:167], v[120:123]
    v_mfma_f32_16x16x32_bf16 v[116:119], a[28:31], a[160:163], v[116:119]
    buffer_load_dwordx4 a[76:79], v244, s[24:27], s36 offen offset:0 sc1
    v_mfma_f32_16x16x32_bf16 v[112:115], a[28:31], a[156:159], v[112:115]
    ds_read_b64_tr_b16 a[28:29], v241 offset:50912
    v_mfma_f32_16x16x32_bf16 v[128:131], a[32:35], a[156:159], v[128:131]
    ds_read_b64_tr_b16 a[30:31], v241 offset:51424
    v_mfma_f32_16x16x32_bf16 v[132:135], a[32:35], a[160:163], v[132:135]
    v_mfma_f32_16x16x32_bf16 v[136:139], a[32:35], a[164:167], v[136:139]
    buffer_load_dwordx4 a[80:83], v244, s[24:27], s36 offen offset:1024 sc1
    v_mfma_f32_16x16x32_bf16 v[140:143], a[32:35], a[168:171], v[140:143]
    ds_read_b64_tr_b16 a[32:33], v241 offset:59136
    v_mfma_f32_16x16x32_bf16 v[156:159], a[36:39], a[168:171], v[156:159]
    ds_read_b64_tr_b16 a[34:35], v241 offset:59648
    v_mfma_f32_16x16x32_bf16 v[152:155], a[36:39], a[164:167], v[152:155]
    v_mfma_f32_16x16x32_bf16 v[148:151], a[36:39], a[160:163], v[148:151]
    buffer_load_dwordx4 a[84:87], v244, s[24:27], s36 offen offset:2048 sc1
    v_mfma_f32_16x16x32_bf16 v[144:147], a[36:39], a[156:159], v[144:147]
    ds_read_b64_tr_b16 a[36:37], v241 offset:59168
    v_mfma_f32_16x16x32_bf16 v[160:163], a[40:43], a[156:159], v[160:163]
    ds_read_b64_tr_b16 a[38:39], v241 offset:59680
    v_mfma_f32_16x16x32_bf16 v[164:167], a[40:43], a[160:163], v[164:167]
    v_mfma_f32_16x16x32_bf16 v[168:171], a[40:43], a[164:167], v[168:171]
    buffer_load_dwordx4 a[88:91], v244, s[24:27], s36 offen offset:3072 sc1
    v_mfma_f32_16x16x32_bf16 v[172:175], a[40:43], a[168:171], v[172:175]
    ds_read_b64_tr_b16 a[40:41], v241 offset:59200
    v_mfma_f32_16x16x32_bf16 v[188:191], a[44:47], a[168:171], v[188:191]
    ds_read_b64_tr_b16 a[42:43], v241 offset:59712
    v_mfma_f32_16x16x32_bf16 v[184:187], a[44:47], a[164:167], v[184:187]
    v_mfma_f32_16x16x32_bf16 v[180:183], a[44:47], a[160:163], v[180:183]
    s_add_u32 s36, s36, 4096
    v_mfma_f32_16x16x32_bf16 v[176:179], a[44:47], a[156:159], v[176:179]
    ds_read_b64_tr_b16 a[44:45], v241 offset:59232
    v_mfma_f32_16x16x32_bf16 v[192:195], a[48:51], a[156:159], v[192:195]
    ds_read_b64_tr_b16 a[46:47], v241 offset:59744
    v_mfma_f32_16x16x32_bf16 v[196:199], a[48:51], a[160:163], v[196:199]
    v_mfma_f32_16x16x32_bf16 v[200:203], a[48:51], a[164:167], v[200:203]
    v_mfma_f32_16x16x32_bf16 v[204:207], a[48:51], a[168:171], v[204:207]
    ds_read_b64_tr_b16 a[48:49], v241 offset:59264
    v_mfma_f32_16x16x32_bf16 v[220:223], a[52:55], a[168:171], v[220:223]
    ds_read_b64_tr_b16 a[50:51], v241 offset:59776
    v_mfma_f32_16x16x32_bf16 v[216:219], a[52:55], a[164:167], v[216:219]
    v_mfma_f32_16x16x32_bf16 v[212:215], a[52:55], a[160:163], v[212:215]
    v_mfma_f32_16x16x32_bf16 v[208:211], a[52:55], a[156:159], v[208:211]
    ds_read_b64_tr_b16 a[52:53], v241 offset:59296
    v_mfma_f32_16x16x32_bf16 v[224:227], a[56:59], a[156:159], v[224:227]
    ds_read_b64_tr_b16 a[54:55], v241 offset:59808
    v_mfma_f32_16x16x32_bf16 v[228:231], a[56:59], a[160:163], v[228:231]
    v_mfma_f32_16x16x32_bf16 v[232:235], a[56:59], a[164:167], v[232:235]
    v_mfma_f32_16x16x32_bf16 v[236:239], a[56:59], a[168:171], v[236:239]
    ds_read_b64_tr_b16 a[56:57], v241 offset:59328
    ds_read_b64_tr_b16 a[58:59], v241 offset:59840
    s_waitcnt vmcnt(12)
    s_barrier
    v_mfma_f32_16x16x32_bf16 v[0:3], a[0:3], a[172:175], v[0:3]
    v_subrev_u32 v241, 67584, v241
    s_add_u32 m0, s39, 33792
    v_mfma_f32_16x16x32_bf16 v[4:7], a[0:3], a[176:179], v[4:7]
    buffer_load_dwordx4 v242, s[8:11], s37 offen nt lds
    v_mfma_f32_16x16x32_bf16 v[8:11], a[0:3], a[180:183], v[8:11]
    v_mfma_f32_16x16x32_bf16 v[12:15], a[0:3], a[184:187], v[12:15]
    ds_read_b64_tr_b16 a[0:1], v241 offset:0
    v_mfma_f32_16x16x32_bf16 v[28:31], a[4:7], a[184:187], v[28:31]
    ds_read_b64_tr_b16 a[2:3], v241 offset:512
    v_mfma_f32_16x16x32_bf16 v[24:27], a[4:7], a[180:183], v[24:27]
    buffer_load_dwordx4 v249, s[8:11], s37 offen offset:1056 nt lds
    v_mfma_f32_16x16x32_bf16 v[20:23], a[4:7], a[176:179], v[20:23]
    v_mfma_f32_16x16x32_bf16 v[16:19], a[4:7], a[172:175], v[16:19]
    ds_read_b64_tr_b16 a[4:5], v241 offset:32
    s_waitcnt lgkmcnt(9)
    v_mfma_f32_16x16x32_bf16 v[32:35], a[8:11], a[172:175], v[32:35]
    ds_read_b64_tr_b16 a[6:7], v241 offset:544
    s_add_u32 m0, s39, 42240
    v_mfma_f32_16x16x32_bf16 v[36:39], a[8:11], a[176:179], v[36:39]
    buffer_load_dwordx4 v243, s[12:15], s38 offen nt lds
    v_mfma_f32_16x16x32_bf16 v[40:43], a[8:11], a[180:183], v[40:43]
    v_mfma_f32_16x16x32_bf16 v[44:47], a[8:11], a[184:187], v[44:47]
    ds_read_b64_tr_b16 a[8:9], v241 offset:64
    v_mfma_f32_16x16x32_bf16 v[60:63], a[12:15], a[184:187], v[60:63]
    ds_read_b64_tr_b16 a[10:11], v241 offset:576
    v_mfma_f32_16x16x32_bf16 v[56:59], a[12:15], a[180:183], v[56:59]
    buffer_load_dwordx4 v250, s[12:15], s38 offen offset:1056 nt lds
    v_mfma_f32_16x16x32_bf16 v[52:55], a[12:15], a[176:179], v[52:55]
    v_mfma_f32_16x16x32_bf16 v[48:51], a[12:15], a[172:175], v[48:51]
    ds_read_b64_tr_b16 a[12:13], v241 offset:96
    v_mfma_f32_16x16x32_bf16 v[64:67], a[16:19], a[172:175], v[64:67]
    ds_read_b64_tr_b16 a[14:15], v241 offset:608
    v_mfma_f32_16x16x32_bf16 v[68:71], a[16:19], a[176:179], v[68:71]
    s_add_u32 s37, s37, 262144
    v_mfma_f32_16x16x32_bf16 v[72:75], a[16:19], a[180:183], v[72:75]
    s_add_u32 s38, s38, 229376
    v_mfma_f32_16x16x32_bf16 v[76:79], a[16:19], a[184:187], v[76:79]
    ds_read_b64_tr_b16 a[16:17], v241 offset:128
    v_mfma_f32_16x16x32_bf16 v[92:95], a[20:23], a[184:187], v[92:95]
    ds_read_b64_tr_b16 a[18:19], v241 offset:640
    v_mfma_f32_16x16x32_bf16 v[88:91], a[20:23], a[180:183], v[88:91]
    v_mfma_f32_16x16x32_bf16 v[84:87], a[20:23], a[176:179], v[84:87]
    v_mfma_f32_16x16x32_bf16 v[80:83], a[20:23], a[172:175], v[80:83]
    ds_read_b64_tr_b16 a[20:21], v241 offset:160
    v_mfma_f32_16x16x32_bf16 v[96:99], a[24:27], a[172:175], v[96:99]
    ds_read_b64_tr_b16 a[22:23], v241 offset:672
    v_mfma_f32_16x16x32_bf16 v[100:103], a[24:27], a[176:179], v[100:103]
    v_mfma_f32_16x16x32_bf16 v[104:107], a[24:27], a[180:183], v[104:107]
    v_mfma_f32_16x16x32_bf16 v[108:111], a[24:27], a[184:187], v[108:111]
    ds_read_b64_tr_b16 a[24:25], v241 offset:192
    v_mfma_f32_16x16x32_bf16 v[124:127], a[28:31], a[184:187], v[124:127]
    ds_read_b64_tr_b16 a[26:27], v241 offset:704
    v_mfma_f32_16x16x32_bf16 v[120:123], a[28:31], a[180:183], v[120:123]
    v_mfma_f32_16x16x32_bf16 v[116:119], a[28:31], a[176:179], v[116:119]
    buffer_load_dwordx4 a[92:95], v244, s[24:27], s36 offen offset:0 sc1
    v_mfma_f32_16x16x32_bf16 v[112:115], a[28:31], a[172:175], v[112:115]
    ds_read_b64_tr_b16 a[28:29], v241 offset:224
    v_mfma_f32_16x16x32_bf16 v[128:131], a[32:35], a[172:175], v[128:131]
    ds_read_b64_tr_b16 a[30:31], v241 offset:736
    v_mfma_f32_16x16x32_bf16 v[132:135], a[32:35], a[176:179], v[132:135]
    v_mfma_f32_16x16x32_bf16 v[136:139], a[32:35], a[180:183], v[136:139]
    buffer_load_dwordx4 a[96:99], v244, s[24:27], s36 offen offset:1024 sc1
    v_mfma_f32_16x16x32_bf16 v[140:143], a[32:35], a[184:187], v[140:143]
    ds_read_b64_tr_b16 a[32:33], v241 offset:8448
    v_mfma_f32_16x16x32_bf16 v[156:159], a[36:39], a[184:187], v[156:159]
    ds_read_b64_tr_b16 a[34:35], v241 offset:8960
    v_mfma_f32_16x16x32_bf16 v[152:155], a[36:39], a[180:183], v[152:155]
    v_mfma_f32_16x16x32_bf16 v[148:151], a[36:39], a[176:179], v[148:151]
    buffer_load_dwordx4 a[100:103], v244, s[24:27], s36 offen offset:2048 sc1
    v_mfma_f32_16x16x32_bf16 v[144:147], a[36:39], a[172:175], v[144:147]
    ds_read_b64_tr_b16 a[36:37], v241 offset:8480
    v_mfma_f32_16x16x32_bf16 v[160:163], a[40:43], a[172:175], v[160:163]
    ds_read_b64_tr_b16 a[38:39], v241 offset:8992
    v_mfma_f32_16x16x32_bf16 v[164:167], a[40:43], a[176:179], v[164:167]
    v_mfma_f32_16x16x32_bf16 v[168:171], a[40:43], a[180:183], v[168:171]
    buffer_load_dwordx4 a[104:107], v244, s[24:27], s36 offen offset:3072 sc1
    v_mfma_f32_16x16x32_bf16 v[172:175], a[40:43], a[184:187], v[172:175]
    ds_read_b64_tr_b16 a[40:41], v241 offset:8512
    v_mfma_f32_16x16x32_bf16 v[188:191], a[44:47], a[184:187], v[188:191]
    ds_read_b64_tr_b16 a[42:43], v241 offset:9024
    v_mfma_f32_16x16x32_bf16 v[184:187], a[44:47], a[180:183], v[184:187]
    v_mfma_f32_16x16x32_bf16 v[180:183], a[44:47], a[176:179], v[180:183]
    s_add_u32 s36, s36, 4096
    v_mfma_f32_16x16x32_bf16 v[176:179], a[44:47], a[172:175], v[176:179]
    ds_read_b64_tr_b16 a[44:45], v241 offset:8544
    s_waitcnt lgkmcnt(9)
    v_mfma_f32_16x16x32_bf16 v[192:195], a[48:51], a[172:175], v[192:195]
    ds_read_b64_tr_b16 a[46:47], v241 offset:9056
    v_mfma_f32_16x16x32_bf16 v[196:199], a[48:51], a[176:179], v[196:199]
    v_mfma_f32_16x16x32_bf16 v[200:203], a[48:51], a[180:183], v[200:203]
    v_mfma_f32_16x16x32_bf16 v[204:207], a[48:51], a[184:187], v[204:207]
    ds_read_b64_tr_b16 a[48:49], v241 offset:8576
    v_mfma_f32_16x16x32_bf16 v[220:223], a[52:55], a[184:187], v[220:223]
    ds_read_b64_tr_b16 a[50:51], v241 offset:9088
    v_mfma_f32_16x16x32_bf16 v[216:219], a[52:55], a[180:183], v[216:219]
    v_mfma_f32_16x16x32_bf16 v[212:215], a[52:55], a[176:179], v[212:215]
    v_mfma_f32_16x16x32_bf16 v[208:211], a[52:55], a[172:175], v[208:211]
    ds_read_b64_tr_b16 a[52:53], v241 offset:8608
    v_mfma_f32_16x16x32_bf16 v[224:227], a[56:59], a[172:175], v[224:227]
    ds_read_b64_tr_b16 a[54:55], v241 offset:9120
    v_mfma_f32_16x16x32_bf16 v[228:231], a[56:59], a[176:179], v[228:231]
    v_mfma_f32_16x16x32_bf16 v[232:235], a[56:59], a[180:183], v[232:235]
    v_mfma_f32_16x16x32_bf16 v[236:239], a[56:59], a[184:187], v[236:239]
    ds_read_b64_tr_b16 a[56:57], v241 offset:8640
    ds_read_b64_tr_b16 a[58:59], v241 offset:9152
    s_sub_u32 s44, s44, 1
    s_cmp_lg_u32 s44, 0
    s_cbranch_scc1 pa_g1
    s_lshr_b32 s101, s2, 5
    s_lshl_b32 s101, s101, 5
    s_add_u32 s101, s101, s42
    s_lshl_b32 s101, s101, 7
    s_add_u32 s101, s101, 0x2f08000
    s_waitcnt vmcnt(12)
    s_waitcnt vmcnt(4)
    s_cmp_lg_u32 s3, 0
    s_cbranch_scc1 pa_kvok
    s_mov_b32 s49, 0x80000
pa_kvp:
    v_cmp_ne_u32 vcc, s100, v252
    s_nop 4
    s_cbranch_vccz pa_kvok
    s_sleep 1
    buffer_load_dword v252, v248, s[16:19], s48 offen sc1
    s_waitcnt vmcnt(0)
    s_sub_u32 s49, s49, 1
    s_cmp_lg_u32 s49, 0
    s_cbranch_scc1 pa_kvp
pa_kvok:
    s_barrier
    s_cmp_lg_u32 s3, 99
    s_cbranch_scc1 pa_clr
    s_mov_b64 exec, 127
    v_lshlrev_b32 v245, 15, v240
    v_mov_b32 v246, 0
    s_lshl_b32 s40, s2, 7
    s_add_u32 s40, s40, 0x2f10000
    buffer_store_dword v246, v245, s[16:19], s40 offen
    s_mov_b64 exec, -1
pa_clr:
    s_lshr_b32 s40, s42, 3
    s_lshl_b32 s50, s40, 17
    s_lshl_b32 s41, s3, 11
    s_add_u32 s40, s50, s41
    s_add_u32 s41, s40, 5242880
    s_add_u32 s28, s6, s41
    s_addc_u32 s29, s7, 0
    s_mov_b32 s30, 131072
    s_mov_b32 s31, 0x20000
    s_add_u32 s41, s40, 5748736
    s_add_u32 s32, s6, s41
    s_addc_u32 s33, s7, 0
    s_mov_b32 s34, 149504
    s_mov_b32 s35, 0x20000
    s_mov_b32 s47, 0
    s_lshl_b32 s48, s3, 12
    s_mov_b32 m0, s48
    s_nop 0
    buffer_load_dwordx4 v244, s[28:31], s47 offen sc1 lds
    v_cvt_pk_bf16_f32 v0, v0, v1
    v_cvt_pk_bf16_f32 v1, v2, v3
    v_cvt_pk_bf16_f32 v2, v16, v17
    v_cvt_pk_bf16_f32 v3, v18, v19
    v_accvgpr_write_b32 a0, v0
    v_accvgpr_write_b32 a1, v1
    v_accvgpr_write_b32 a2, v2
    v_accvgpr_write_b32 a3, v3
    v_cvt_pk_bf16_f32 v32, v32, v33
    v_cvt_pk_bf16_f32 v33, v34, v35
    v_cvt_pk_bf16_f32 v34, v48, v49
    v_cvt_pk_bf16_f32 v35, v50, v51
    v_accvgpr_write_b32 a4, v32
    v_accvgpr_write_b32 a5, v33
    v_accvgpr_write_b32 a6, v34
    buffer_load_dwordx4 v244, s[28:31], s47 offen offset:1024 sc1 lds
    v_accvgpr_write_b32 a7, v35
    v_cvt_pk_bf16_f32 v64, v64, v65
    v_cvt_pk_bf16_f32 v65, v66, v67
    v_cvt_pk_bf16_f32 v66, v80, v81
    v_cvt_pk_bf16_f32 v67, v82, v83
    v_accvgpr_write_b32 a8, v64
    v_accvgpr_write_b32 a9, v65
    v_accvgpr_write_b32 a10, v66
    v_accvgpr_write_b32 a11, v67
    v_cvt_pk_bf16_f32 v96, v96, v97
    v_cvt_pk_bf16_f32 v97, v98, v99
    v_cvt_pk_bf16_f32 v98, v112, v113
    v_cvt_pk_bf16_f32 v99, v114, v115
    v_accvgpr_write_b32 a12, v96
    v_accvgpr_write_b32 a13, v97
    buffer_load_dwordx4 v244, s[32:35], s47 offen offset:2048 sc1 lds
    v_accvgpr_write_b32 a14, v98
    v_accvgpr_write_b32 a15, v99
    v_cvt_pk_bf16_f32 v4, v4, v5
    v_cvt_pk_bf16_f32 v5, v6, v7
    v_cvt_pk_bf16_f32 v6, v20, v21
    v_cvt_pk_bf16_f32 v7, v22, v23
    v_accvgpr_write_b32 a16, v4
    v_accvgpr_write_b32 a17, v5
    v_accvgpr_write_b32 a18, v6
    v_accvgpr_write_b32 a19, v7
    v_cvt_pk_bf16_f32 v36, v36, v37
    v_cvt_pk_bf16_f32 v37, v38, v39
    v_cvt_pk_bf16_f32 v38, v52, v53
    v_cvt_pk_bf16_f32 v39, v54, v55
    v_accvgpr_write_b32 a20, v36
    buffer_load_dwordx4 v244, s[32:35], s47 offen offset:3072 sc1 lds
    v_accvgpr_write_b32 a21, v37
    v_accvgpr_write_b32 a22, v38
    v_accvgpr_write_b32 a23, v39
    v_cvt_pk_bf16_f32 v68, v68, v69
    v_cvt_pk_bf16_f32 v69, v70, v71
    v_cvt_pk_bf16_f32 v70, v84, v85
    v_cvt_pk_bf16_f32 v71, v86, v87
    v_accvgpr_write_b32 a24, v68
    v_accvgpr_write_b32 a25, v69
    v_accvgpr_write_b32 a26, v70
    v_accvgpr_write_b32 a27, v71
    v_cvt_pk_bf16_f32 v100, v100, v101
    v_cvt_pk_bf16_f32 v101, v102, v103
    v_cvt_pk_bf16_f32 v102, v116, v117
    v_cvt_pk_bf16_f32 v103, v118, v119
    s_add_u32 s47, s47, 8192
    s_add_u32 s48, s48, 16384
    s_and_b32 s48, s48, 0x1ffff
    s_mov_b32 m0, s48
    s_nop 0
    buffer_load_dwordx4 v244, s[28:31], s47 offen sc1 lds
    s_waitcnt lgkmcnt(15)
    v_accvgpr_write_b32 a28, v100
    v_accvgpr_write_b32 a29, v101
    s_waitcnt lgkmcnt(14)
    v_accvgpr_write_b32 a30, v102
    v_accvgpr_write_b32 a31, v103
    v_cvt_pk_bf16_f32 v8, v8, v9
    v_cvt_pk_bf16_f32 v9, v10, v11
    v_cvt_pk_bf16_f32 v10, v24, v25
    v_cvt_pk_bf16_f32 v11, v26, v27
    s_waitcnt lgkmcnt(13)
    v_accvgpr_write_b32 a32, v8
    v_accvgpr_write_b32 a33, v9
    s_waitcnt lgkmcnt(12)
    v_accvgpr_write_b32 a34, v10
    v_accvgpr_write_b32 a35, v11
    v_cvt_pk_bf16_f32 v40, v40, v41
    v_cvt_pk_bf16_f32 v41, v42, v43
    v_cvt_pk_bf16_f32 v42, v56, v57
    buffer_load_dwordx4 v244, s[28:31], s47 offen offset:1024 sc1 lds
    v_cvt_pk_bf16_f32 v43, v58, v59
    s_waitcnt lgkmcnt(11)
    v_accvgpr_write_b32 a36, v40
    v_accvgpr_write_b32 a37, v41
    s_waitcnt lgkmcnt(10)
    v_accvgpr_write_b32 a38, v42
    v_accvgpr_write_b32 a39, v43
    v_cvt_pk_bf16_f32 v72, v72, v73
    v_cvt_pk_bf16_f32 v73, v74, v75
    v_cvt_pk_bf16_f32 v74, v88, v89
    v_cvt_pk_bf16_f32 v75, v90, v91
    s_waitcnt lgkmcnt(9)
    v_accvgpr_write_b32 a40, v72
    v_accvgpr_write_b32 a41, v73
    s_waitcnt lgkmcnt(8)
    v_accvgpr_write_b32 a42, v74
    v_accvgpr_write_b32 a43, v75
    v_cvt_pk_bf16_f32 v104, v104, v105
    v_cvt_pk_bf16_f32 v105, v106, v107
    buffer_load_dwordx4 v244, s[32:35], s47 offen offset:2048 sc1 lds
    v_cvt_pk_bf16_f32 v106, v120, v121
    v_cvt_pk_bf16_f32 v107, v122, v123
    s_waitcnt lgkmcnt(7)
    v_accvgpr_write_b32 a44, v104
    v_accvgpr_write_b32 a45, v105
    s_waitcnt lgkmcnt(6)
    v_accvgpr_write_b32 a46, v106
    v_accvgpr_write_b32 a47, v107
    v_cvt_pk_bf16_f32 v12, v12, v13
    v_cvt_pk_bf16_f32 v13, v14, v15
    v_cvt_pk_bf16_f32 v14, v28, v29
    v_cvt_pk_bf16_f32 v15, v30, v31
    s_waitcnt lgkmcnt(5)
    v_accvgpr_write_b32 a48, v12
    v_accvgpr_write_b32 a49, v13
    s_waitcnt lgkmcnt(4)
    v_accvgpr_write_b32 a50, v14
    v_accvgpr_write_b32 a51, v15
    v_cvt_pk_bf16_f32 v44, v44, v45
    buffer_load_dwordx4 v244, s[32:35], s47 offen offset:3072 sc1 lds
    v_cvt_pk_bf16_f32 v45, v46, v47
    v_cvt_pk_bf16_f32 v46, v60, v61
    v_cvt_pk_bf16_f32 v47, v62, v63
    s_waitcnt lgkmcnt(3)
    v_accvgpr_write_b32 a52, v44
    v_accvgpr_write_b32 a53, v45
    s_waitcnt lgkmcnt(2)
    v_accvgpr_write_b32 a54, v46
    v_accvgpr_write_b32 a55, v47
    v_cvt_pk_bf16_f32 v76, v76, v77
    v_cvt_pk_bf16_f32 v77, v78, v79
    v_cvt_pk_bf16_f32 v78, v92, v93
    v_cvt_pk_bf16_f32 v79, v94, v95
    s_waitcnt lgkmcnt(1)
    v_accvgpr_write_b32 a56, v76
    v_accvgpr_write_b32 a57, v77
    s_waitcnt lgkmcnt(0)
    v_accvgpr_write_b32 a58, v78
    v_accvgpr_write_b32 a59, v79
    s_add_u32 s47, s47, 8192
    s_add_u32 s48, s48, 16384
    s_and_b32 s48, s48, 0x1ffff
    s_mov_b32 m0, s48
    s_nop 0
    buffer_load_dwordx4 v244, s[28:31], s47 offen sc1 lds
    v_cvt_pk_bf16_f32 v108, v108, v109
    v_cvt_pk_bf16_f32 v109, v110, v111
    v_cvt_pk_bf16_f32 v110, v124, v125
    v_cvt_pk_bf16_f32 v111, v126, v127
    v_accvgpr_write_b32 a60, v108
    v_accvgpr_write_b32 a61, v109
    v_accvgpr_write_b32 a62, v110
    v_accvgpr_write_b32 a63, v111
    s_lshr_b32 s40, s42, 1
    s_mul_i32 s40, s40, 7
    s_and_b32 s41, s42, 1
    s_lshl_b32 s45, s41, 2
    s_add_u32 s45, s45, s40
    s_lshl_b32 s45, s45, 11
    s_add_u32 s46, s40, 3
    buffer_load_dwordx4 v244, s[28:31], s47 offen offset:1024 sc1 lds
    s_lshl_b32 s46, s46, 11
    s_lshl_b32 s41, s41, 3
    s_add_u32 s46, s46, s41
    s_mul_i32 s40, s43, 475136
    s_add_u32 s40, s40, 26214400
    s_add_u32 s45, s45, s40
    s_add_u32 s46, s46, s40
    s_mul_i32 s40, s43, 540672
    s_lshl_b32 s41, s42, 13
    s_add_u32 s40, s40, s41
    s_add_u32 s49, s40, 8388608
    v_max_f32 v128, 0, v128
    v_max_f32 v129, 0, v129
    v_max_f32 v130, 0, v130
    v_max_f32 v131, 0, v131
    buffer_load_dwordx4 v244, s[32:35], s47 offen offset:2048 sc1 lds
    v_pk_mul_f32 v[128:129], v[128:129], v[128:129]
    v_pk_mul_f32 v[130:131], v[130:131], v[130:131]
    v_max_f32 v144, 0, v144
    v_max_f32 v145, 0, v145
    v_max_f32 v146, 0, v146
    v_max_f32 v147, 0, v147
    v_pk_mul_f32 v[144:145], v[144:145], v[144:145]
    v_pk_mul_f32 v[146:147], v[146:147], v[146:147]
    v_max_f32 v160, 0, v160
    v_max_f32 v161, 0, v161
    v_max_f32 v162, 0, v162
    v_max_f32 v163, 0, v163
    v_pk_mul_f32 v[160:161], v[160:161], v[160:161]
    v_pk_mul_f32 v[162:163], v[162:163], v[162:163]
    v_max_f32 v176, 0, v176
    buffer_load_dwordx4 v244, s[32:35], s47 offen offset:3072 sc1 lds
    v_max_f32 v177, 0, v177
    v_max_f32 v178, 0, v178
    v_max_f32 v179, 0, v179
    v_pk_mul_f32 v[176:177], v[176:177], v[176:177]
    v_pk_mul_f32 v[178:179], v[178:179], v[178:179]
    v_max_f32 v192, 0, v192
    v_max_f32 v193, 0, v193
    v_max_f32 v194, 0, v194
    v_max_f32 v195, 0, v195
    v_pk_mul_f32 v[192:193], v[192:193], v[192:193]
    v_pk_mul_f32 v[194:195], v[194:195], v[194:195]
    v_max_f32 v208, 0, v208
    v_max_f32 v209, 0, v209
    v_max_f32 v210, 0, v210
    v_max_f32 v211, 0, v211
    s_add_u32 s47, s47, 8192
    s_add_u32 s48, s48, 16384
    s_and_b32 s48, s48, 0x1ffff
    s_mov_b32 m0, s48
    s_nop 0
    buffer_load_dwordx4 v244, s[28:31], s47 offen sc1 lds
    v_pk_mul_f32 v[208:209], v[208:209], v[208:209]
    v_pk_mul_f32 v[210:211], v[210:211], v[210:211]
    v_max_f32 v224, 0, v224
    v_max_f32 v225, 0, v225
    v_max_f32 v226, 0, v226
    v_max_f32 v227, 0, v227
    v_pk_mul_f32 v[224:225], v[224:225], v[224:225]
    v_pk_mul_f32 v[226:227], v[226:227], v[226:227]
    v_cvt_pk_bf16_f32 v128, v128, v129
    v_cvt_pk_bf16_f32 v129, v130, v131
    v_cvt_pk_bf16_f32 v130, v144, v145
    v_cvt_pk_bf16_f32 v131, v146, v147
    v_accvgpr_write_b32 a152, v128
    v_accvgpr_write_b32 a153, v129
    v_accvgpr_write_b32 a154, v130
    buffer_load_dwordx4 v244, s[28:31], s47 offen offset:1024 sc1 lds
    v_accvgpr_write_b32 a155, v131
    v_cvt_pk_bf16_f32 v160, v160, v161
    v_cvt_pk_bf16_f32 v161, v162, v163
    v_cvt_pk_bf16_f32 v162, v176, v177
    v_cvt_pk_bf16_f32 v163, v178, v179
    v_accvgpr_write_b32 a156, v160
    v_accvgpr_write_b32 a157, v161
    v_accvgpr_write_b32 a158, v162
    v_accvgpr_write_b32 a159, v163
    v_cvt_pk_bf16_f32 v192, v192, v193
    v_cvt_pk_bf16_f32 v193, v194, v195
    v_cvt_pk_bf16_f32 v194, v208, v209
    v_cvt_pk_bf16_f32 v195, v210, v211
    v_accvgpr_write_b32 a160, v192
    v_accvgpr_write_b32 a161, v193
    buffer_load_dwordx4 v244, s[32:35], s47 offen offset:2048 sc1 lds
    v_accvgpr_write_b32 a162, v194
    v_accvgpr_write_b32 a163, v195
    v_cvt_pk_bf16_f32 v224, v224, v225
    v_cvt_pk_bf16_f32 v225, v226, v227
    v_accvgpr_write_b32 a164, v224
    v_accvgpr_write_b32 a165, v225
    v_max_f32 v132, 0, v132
    v_max_f32 v133, 0, v133
    v_max_f32 v134, 0, v134
    v_max_f32 v135, 0, v135
    v_pk_mul_f32 v[132:133], v[132:133], v[132:133]
    v_pk_mul_f32 v[134:135], v[134:135], v[134:135]
    v_max_f32 v148, 0, v148
    v_max_f32 v149, 0, v149
    v_max_f32 v150, 0, v150
    buffer_load_dwordx4 v244, s[32:35], s47 offen offset:3072 sc1 lds
    v_max_f32 v151, 0, v151
    v_pk_mul_f32 v[148:149], v[148:149], v[148:149]
    v_pk_mul_f32 v[150:151], v[150:151], v[150:151]
    v_max_f32 v164, 0, v164
    v_max_f32 v165, 0, v165
    v_max_f32 v166, 0, v166
    v_max_f32 v167, 0, v167
    v_pk_mul_f32 v[164:165], v[164:165], v[164:165]
    v_pk_mul_f32 v[166:167], v[166:167], v[166:167]
    v_max_f32 v180, 0, v180
    v_max_f32 v181, 0, v181
    v_max_f32 v182, 0, v182
    v_max_f32 v183, 0, v183
    v_pk_mul_f32 v[180:181], v[180:181], v[180:181]
    v_pk_mul_f32 v[182:183], v[182:183], v[182:183]
    s_add_u32 s47, s47, 8192
    s_add_u32 s48, s48, 16384
    s_and_b32 s48, s48, 0x1ffff
    s_mov_b32 m0, s48
    s_nop 0
    buffer_load_dwordx4 v244, s[28:31], s47 offen sc1 lds
    v_max_f32 v196, 0, v196
    v_max_f32 v197, 0, v197
    v_max_f32 v198, 0, v198
    v_max_f32 v199, 0, v199
    v_pk_mul_f32 v[196:197], v[196:197], v[196:197]
    v_pk_mul_f32 v[198:199], v[198:199], v[198:199]
    v_max_f32 v212, 0, v212
    v_max_f32 v213, 0, v213
    v_max_f32 v214, 0, v214
    v_max_f32 v215, 0, v215
    v_pk_mul_f32 v[212:213], v[212:213], v[212:213]
    v_pk_mul_f32 v[214:215], v[214:215], v[214:215]
    v_max_f32 v228, 0, v228
    v_max_f32 v229, 0, v229
    v_max_f32 v230, 0, v230
    buffer_load_dwordx4 v244, s[28:31], s47 offen offset:1024 sc1 lds
    v_max_f32 v231, 0, v231
    v_pk_mul_f32 v[228:229], v[228:229], v[228:229]
    v_pk_mul_f32 v[230:231], v[230:231], v[230:231]
    v_cvt_pk_bf16_f32 v132, v132, v133
    v_cvt_pk_bf16_f32 v133, v134, v135
    v_cvt_pk_bf16_f32 v134, v148, v149
    v_cvt_pk_bf16_f32 v135, v150, v151
    v_accvgpr_write_b32 a168, v132
    v_accvgpr_write_b32 a169, v133
    v_accvgpr_write_b32 a170, v134
    v_accvgpr_write_b32 a171, v135
    v_cvt_pk_bf16_f32 v164, v164, v165
    v_cvt_pk_bf16_f32 v165, v166, v167
    v_cvt_pk_bf16_f32 v166, v180, v181
    v_cvt_pk_bf16_f32 v167, v182, v183
    buffer_load_dwordx4 v244, s[32:35], s47 offen offset:2048 sc1 lds
    v_accvgpr_write_b32 a172, v164
    v_accvgpr_write_b32 a173, v165
    v_accvgpr_write_b32 a174, v166
    v_accvgpr_write_b32 a175, v167
    v_cvt_pk_bf16_f32 v196, v196, v197
    v_cvt_pk_bf16_f32 v197, v198, v199
    v_cvt_pk_bf16_f32 v198, v212, v213
    v_cvt_pk_bf16_f32 v199, v214, v215
    v_accvgpr_write_b32 a176, v196
    v_accvgpr_write_b32 a177, v197
    v_accvgpr_write_b32 a178, v198
    v_accvgpr_write_b32 a179, v199
    v_cvt_pk_bf16_f32 v228, v228, v229
    v_cvt_pk_bf16_f32 v229, v230, v231
    v_accvgpr_write_b32 a180, v228
    buffer_load_dwordx4 v244, s[32:35], s47 offen offset:3072 sc1 lds
    v_accvgpr_write_b32 a181, v229
    v_max_f32 v136, 0, v136
    v_max_f32 v137, 0, v137
    v_max_f32 v138, 0, v138
    v_max_f32 v139, 0, v139
    v_pk_mul_f32 v[136:137], v[136:137], v[136:137]
    v_pk_mul_f32 v[138:139], v[138:139], v[138:139]
    v_max_f32 v152, 0, v152
    v_max_f32 v153, 0, v153
    v_max_f32 v154, 0, v154
    v_max_f32 v155, 0, v155
    v_pk_mul_f32 v[152:153], v[152:153], v[152:153]
    v_pk_mul_f32 v[154:155], v[154:155], v[154:155]
    v_max_f32 v168, 0, v168
    v_max_f32 v169, 0, v169
    s_add_u32 s47, s47, 8192
    s_add_u32 s48, s48, 16384
    s_and_b32 s48, s48, 0x1ffff
    s_mov_b32 m0, s48
    s_nop 0
    buffer_load_dwordx4 v244, s[28:31], s47 offen sc1 lds
    v_max_f32 v170, 0, v170
    v_max_f32 v171, 0, v171
    v_pk_mul_f32 v[168:169], v[168:169], v[168:169]
    v_pk_mul_f32 v[170:171], v[170:171], v[170:171]
    v_max_f32 v184, 0, v184
    v_max_f32 v185, 0, v185
    v_max_f32 v186, 0, v186
    v_max_f32 v187, 0, v187
    v_pk_mul_f32 v[184:185], v[184:185], v[184:185]
    v_pk_mul_f32 v[186:187], v[186:187], v[186:187]
    v_max_f32 v200, 0, v200
    v_max_f32 v201, 0, v201
    v_max_f32 v202, 0, v202
    v_max_f32 v203, 0, v203
    v_pk_mul_f32 v[200:201], v[200:201], v[200:201]
    buffer_load_dwordx4 v244, s[28:31], s47 offen offset:1024 sc1 lds
    v_pk_mul_f32 v[202:203], v[202:203], v[202:203]
    v_max_f32 v216, 0, v216
    v_max_f32 v217, 0, v217
    v_max_f32 v218, 0, v218
    v_max_f32 v219, 0, v219
    v_pk_mul_f32 v[216:217], v[216:217], v[216:217]
    v_pk_mul_f32 v[218:219], v[218:219], v[218:219]
    v_max_f32 v232, 0, v232
    v_max_f32 v233, 0, v233
    v_max_f32 v234, 0, v234
    v_max_f32 v235, 0, v235
    v_pk_mul_f32 v[232:233], v[232:233], v[232:233]
    v_pk_mul_f32 v[234:235], v[234:235], v[234:235]
    v_cvt_pk_bf16_f32 v136, v136, v137
    v_cvt_pk_bf16_f32 v137, v138, v139
    buffer_load_dwordx4 v244, s[32:35], s47 offen offset:2048 sc1 lds
    v_cvt_pk_bf16_f32 v138, v152, v153
    v_cvt_pk_bf16_f32 v139, v154, v155
    v_accvgpr_write_b32 a184, v136
    v_accvgpr_write_b32 a185, v137
    v_accvgpr_write_b32 a186, v138
    v_accvgpr_write_b32 a187, v139
    v_cvt_pk_bf16_f32 v168, v168, v169
    v_cvt_pk_bf16_f32 v169, v170, v171
    v_cvt_pk_bf16_f32 v170, v184, v185
    v_cvt_pk_bf16_f32 v171, v186, v187
    v_accvgpr_write_b32 a188, v168
    v_accvgpr_write_b32 a189, v169
    v_accvgpr_write_b32 a190, v170
    v_accvgpr_write_b32 a191, v171
    v_cvt_pk_bf16_f32 v200, v200, v201
    buffer_load_dwordx4 v244, s[32:35], s47 offen offset:3072 sc1 lds
    v_cvt_pk_bf16_f32 v201, v202, v203
    v_cvt_pk_bf16_f32 v202, v216, v217
    v_cvt_pk_bf16_f32 v203, v218, v219
    v_accvgpr_write_b32 a192, v200
    v_accvgpr_write_b32 a193, v201
    v_accvgpr_write_b32 a194, v202
    v_accvgpr_write_b32 a195, v203
    v_cvt_pk_bf16_f32 v232, v232, v233
    v_cvt_pk_bf16_f32 v233, v234, v235
    v_accvgpr_write_b32 a196, v232
    v_accvgpr_write_b32 a197, v233
    v_max_f32 v140, 0, v140
    v_max_f32 v141, 0, v141
    v_max_f32 v142, 0, v142
    v_max_f32 v143, 0, v143
    s_add_u32 s47, s47, 8192
    s_add_u32 s48, s48, 16384
    s_and_b32 s48, s48, 0x1ffff
    s_mov_b32 m0, s48
    s_nop 0
    buffer_load_dwordx4 v244, s[28:31], s47 offen sc1 lds
    v_pk_mul_f32 v[140:141], v[140:141], v[140:141]
    v_pk_mul_f32 v[142:143], v[142:143], v[142:143]
    v_max_f32 v156, 0, v156
    v_max_f32 v157, 0, v157
    v_max_f32 v158, 0, v158
    v_max_f32 v159, 0, v159
    v_pk_mul_f32 v[156:157], v[156:157], v[156:157]
    v_pk_mul_f32 v[158:159], v[158:159], v[158:159]
    v_max_f32 v172, 0, v172
    v_max_f32 v173, 0, v173
    v_max_f32 v174, 0, v174
    v_max_f32 v175, 0, v175
    v_pk_mul_f32 v[172:173], v[172:173], v[172:173]
    v_pk_mul_f32 v[174:175], v[174:175], v[174:175]
    v_max_f32 v188, 0, v188
    buffer_load_dwordx4 v244, s[28:31], s47 offen offset:1024 sc1 lds
    v_max_f32 v189, 0, v189
    v_max_f32 v190, 0, v190
    v_max_f32 v191, 0, v191
    v_pk_mul_f32 v[188:189], v[188:189], v[188:189]
    v_pk_mul_f32 v[190:191], v[190:191], v[190:191]
    v_max_f32 v204, 0, v204
    v_max_f32 v205, 0, v205
    v_max_f32 v206, 0, v206
    v_max_f32 v207, 0, v207
    v_pk_mul_f32 v[204:205], v[204:205], v[204:205]
    v_pk_mul_f32 v[206:207], v[206:207], v[206:207]
    v_max_f32 v220, 0, v220
    v_max_f32 v221, 0, v221
    v_max_f32 v222, 0, v222
    v_max_f32 v223, 0, v223
    buffer_load_dwordx4 v244, s[32:35], s47 offen offset:2048 sc1 lds
    v_pk_mul_f32 v[220:221], v[220:221], v[220:221]
    v_pk_mul_f32 v[222:223], v[222:223], v[222:223]
    v_max_f32 v236, 0, v236
    v_max_f32 v237, 0, v237
    v_max_f32 v238, 0, v238
    v_max_f32 v239, 0, v239
    v_pk_mul_f32 v[236:237], v[236:237], v[236:237]
    v_pk_mul_f32 v[238:239], v[238:239], v[238:239]
    v_cvt_pk_bf16_f32 v140, v140, v141
    v_cvt_pk_bf16_f32 v141, v142, v143
    v_cvt_pk_bf16_f32 v142, v156, v157
    v_cvt_pk_bf16_f32 v143, v158, v159
    v_accvgpr_write_b32 a200, v140
    v_accvgpr_write_b32 a201, v141
    v_accvgpr_write_b32 a202, v142
    buffer_load_dwordx4 v244, s[32:35], s47 offen offset:3072 sc1 lds
    v_accvgpr_write_b32 a203, v143
    v_cvt_pk_bf16_f32 v172, v172, v173
    v_cvt_pk_bf16_f32 v173, v174, v175
    v_cvt_pk_bf16_f32 v174, v188, v189
    v_cvt_pk_bf16_f32 v175, v190, v191
    v_accvgpr_write_b32 a204, v172
    v_accvgpr_write_b32 a205, v173
    v_accvgpr_write_b32 a206, v174
    v_accvgpr_write_b32 a207, v175
    v_cvt_pk_bf16_f32 v204, v204, v205
    v_cvt_pk_bf16_f32 v205, v206, v207
    v_cvt_pk_bf16_f32 v206, v220, v221
    v_cvt_pk_bf16_f32 v207, v222, v223
    v_accvgpr_write_b32 a208, v204
    v_accvgpr_write_b32 a209, v205
    s_add_u32 s47, s47, 8192
    s_add_u32 s48, s48, 16384
    s_and_b32 s48, s48, 0x1ffff
    v_accvgpr_write_b32 a210, v206
    v_accvgpr_write_b32 a211, v207
    v_cvt_pk_bf16_f32 v236, v236, v237
    v_cvt_pk_bf16_f32 v237, v238, v239
    v_accvgpr_write_b32 a212, v236
    v_accvgpr_write_b32 a213, v237
    s_mov_b32 s52, s92
    s_mov_b32 s53, s93
    s_mov_b32 s54, 0x800000
    s_mov_b32 s55, 0x20000
    s_mov_b32 s56, s94
    s_mov_b32 s57, s95
    s_mov_b32 s58, 0x700000
    s_mov_b32 s59, 0x20000
    s_lshl_b32 s51, s2, 15
    s_lshl_b32 s40, s3, 13
    s_add_u32 s51, s51, s40
    s_mul_i32 s60, s2, 28672
    s_mul_i32 s40, s3, 7168
    s_add_u32 s60, s60, s40
    v_mov_b32 v241, v244
    v_mov_b32 v245, 0x3f803f80
    v_accvgpr_write_b32 a144, v245
    v_accvgpr_write_b32 a145, v245
    v_accvgpr_write_b32 a146, v245
    v_accvgpr_write_b32 a147, v245
    s_waitcnt vmcnt(16)
    s_barrier
    ds_read_b128 a[64:67], v241 offset:0
    ds_read_b128 a[68:71], v241 offset:1024
    ds_read_b128 a[72:75], v241 offset:4096
    ds_read_b128 a[76:79], v241 offset:5120
    ds_read_b128 a[80:83], v241 offset:8192
    ds_read_b128 a[84:87], v241 offset:9216
    ds_read_b128 a[88:91], v241 offset:12288
    ds_read_b128 a[92:95], v241 offset:13312
    s_waitcnt lgkmcnt(1)
    v_mfma_f32_16x16x32_bf16 v[128:131], a[64:67], a[0:3], 0
    v_mfma_f32_16x16x32_bf16 v[132:135], a[64:67], a[16:19], 0
    v_mfma_f32_16x16x32_bf16 v[136:139], a[64:67], a[32:35], 0
    v_mfma_f32_16x16x32_bf16 v[140:143], a[64:67], a[48:51], 0
    ds_read_b128 a[64:67], v241 offset:16384
    v_mfma_f32_16x16x32_bf16 v[128:131], a[68:71], a[4:7], v[128:131]
    v_mfma_f32_16x16x32_bf16 v[132:135], a[68:71], a[20:23], v[132:135]
    v_mfma_f32_16x16x32_bf16 v[136:139], a[68:71], a[36:39], v[136:139]
    v_mfma_f32_16x16x32_bf16 v[140:143], a[68:71], a[52:55], v[140:143]
    ds_read_b128 a[68:71], v241 offset:17408
    v_mfma_f32_16x16x32_bf16 v[128:131], a[72:75], a[8:11], v[128:131]
    v_mfma_f32_16x16x32_bf16 v[132:135], a[72:75], a[24:27], v[132:135]
    v_mfma_f32_16x16x32_bf16 v[136:139], a[72:75], a[40:43], v[136:139]
    v_mfma_f32_16x16x32_bf16 v[140:143], a[72:75], a[56:59], v[140:143]
    ds_read_b128 a[72:75], v241 offset:20480
    v_mfma_f32_16x16x32_bf16 v[128:131], a[76:79], a[12:15], v[128:131]
    v_mfma_f32_16x16x32_bf16 v[132:135], a[76:79], a[28:31], v[132:135]
    v_mfma_f32_16x16x32_bf16 v[136:139], a[76:79], a[44:47], v[136:139]
    v_mfma_f32_16x16x32_bf16 v[140:143], a[76:79], a[60:63], v[140:143]
    ds_read_b128 a[76:79], v241 offset:21504
    v_mfma_f32_16x16x32_bf16 v[144:147], a[80:83], a[0:3], 0
    v_mfma_f32_16x16x32_bf16 v[148:151], a[80:83], a[16:19], 0
    v_mfma_f32_16x16x32_bf16 v[152:155], a[80:83], a[32:35], 0
    v_mfma_f32_16x16x32_bf16 v[156:159], a[80:83], a[48:51], 0
    ds_read_b128 a[80:83], v241 offset:24576
    v_mfma_f32_16x16x32_bf16 v[144:147], a[84:87], a[4:7], v[144:147]
    v_mfma_f32_16x16x32_bf16 v[148:151], a[84:87], a[20:23], v[148:151]
    v_mfma_f32_16x16x32_bf16 v[152:155], a[84:87], a[36:39], v[152:155]
    v_mfma_f32_16x16x32_bf16 v[156:159], a[84:87], a[52:55], v[156:159]
    ds_read_b128 a[84:87], v241 offset:25600
    v_mfma_f32_16x16x32_bf16 v[144:147], a[88:91], a[8:11], v[144:147]
    v_mfma_f32_16x16x32_bf16 v[148:151], a[88:91], a[24:27], v[148:151]
    v_mfma_f32_16x16x32_bf16 v[152:155], a[88:91], a[40:43], v[152:155]
    v_mfma_f32_16x16x32_bf16 v[156:159], a[88:91], a[56:59], v[156:159]
    ds_read_b128 a[88:91], v241 offset:28672
    s_waitcnt lgkmcnt(1)
    v_mfma_f32_16x16x32_bf16 v[144:147], a[92:95], a[12:15], v[144:147]
    v_mfma_f32_16x16x32_bf16 v[148:151], a[92:95], a[28:31], v[148:151]
    v_mfma_f32_16x16x32_bf16 v[152:155], a[92:95], a[44:47], v[152:155]
    v_mfma_f32_16x16x32_bf16 v[156:159], a[92:95], a[60:63], v[156:159]
    ds_read_b128 a[92:95], v241 offset:29696
    v_add_u32 v241, 32768, v241
    v_max3_f32 v245, v128, v129, v130
    s_nop 1
    v_max3_f32 v251, v131, v144, v145
    v_max3_f32 v245, v245, v146, v147
    v_max_f32 v245, v245, v251
    v_max3_f32 v246, v132, v133, v134
    v_max3_f32 v252, v135, v148, v149
    v_max3_f32 v246, v246, v150, v151
    v_max_f32 v246, v246, v252
    v_max3_f32 v247, v136, v137, v138
    v_max3_f32 v253, v139, v152, v153
    v_max3_f32 v247, v247, v154, v155
    v_max_f32 v247, v247, v253
    v_max3_f32 v248, v140, v141, v142
    v_max3_f32 v254, v143, v156, v157
    v_max3_f32 v248, v248, v158, v159
    v_max_f32 v248, v248, v254
    v_mov_b32 v251, v245
    v_mov_b32 v252, v246
    v_mov_b32 v253, v247
    v_mov_b32 v254, v248
    v_permlane32_swap_b32 v245, v251
    v_permlane32_swap_b32 v246, v252
    v_permlane32_swap_b32 v247, v253
    v_permlane32_swap_b32 v248, v254
    v_max_f32 v245, v245, v251
    v_max_f32 v246, v246, v252
    v_max_f32 v247, v247, v253
    v_max_f32 v248, v248, v254
    v_mov_b32 v251, v245
    v_mov_b32 v252, v246
    v_mov_b32 v253, v247
    v_mov_b32 v254, v248
    v_permlane16_swap_b32 v245, v251
    v_permlane16_swap_b32 v246, v252
    v_permlane16_swap_b32 v247, v253
    v_permlane16_swap_b32 v248, v254
    v_max_f32 v245, v245, v251
    v_max_f32 v246, v246, v252
    v_max_f32 v247, v247, v253
    v_max_f32 v248, v248, v254
    v_sub_f32 v224, 0, v245
    v_sub_f32 v225, 0, v245
    v_sub_f32 v226, 0, v245
    v_sub_f32 v227, 0, v245
    v_sub_f32 v228, 0, v246
    v_sub_f32 v229, 0, v246
    v_sub_f32 v230, 0, v246
    v_sub_f32 v231, 0, v246
    v_sub_f32 v232, 0, v247
    v_sub_f32 v233, 0, v247
    v_sub_f32 v234, 0, v247
    v_sub_f32 v235, 0, v247
    v_sub_f32 v236, 0, v248
    v_sub_f32 v237, 0, v248
    v_sub_f32 v238, 0, v248
    v_sub_f32 v239, 0, v248
    v_sub_f32 v128, v128, v245
    v_sub_f32 v144, v144, v245
    v_sub_f32 v129, v129, v245
    v_sub_f32 v145, v145, v245
    v_sub_f32 v130, v130, v245
    v_sub_f32 v146, v146, v245
    v_sub_f32 v131, v131, v245
    v_sub_f32 v147, v147, v245
    v_sub_f32 v132, v132, v246
    v_sub_f32 v148, v148, v246
    v_sub_f32 v133, v133, v246
    v_sub_f32 v149, v149, v246
    v_sub_f32 v134, v134, v246
    v_sub_f32 v150, v150, v246
    v_sub_f32 v135, v135, v246
    v_sub_f32 v151, v151, v246
    v_sub_f32 v136, v136, v247
    v_sub_f32 v152, v152, v247
    v_sub_f32 v137, v137, v247
    v_sub_f32 v153, v153, v247
    v_sub_f32 v138, v138, v247
    v_sub_f32 v154, v154, v247
    v_sub_f32 v139, v139, v247
    v_sub_f32 v155, v155, v247
    v_sub_f32 v140, v140, v248
    v_sub_f32 v156, v156, v248
    v_sub_f32 v141, v141, v248
    v_sub_f32 v157, v157, v248
    v_sub_f32 v142, v142, v248
    v_sub_f32 v158, v158, v248
    v_sub_f32 v143, v143, v248
    v_sub_f32 v159, v159, v248
    s_getpc_b64 s[8:9]
pa_start_pc2:
    s_sub_u32 s8, s8, pa_start_pc2-pa_start
    s_subb_u32 s9, s9, 0
    s_mov_b32 s10, code_end_label-pa_start
    s_mov_b32 s11, 0x20000
    s_lshr_b32 s37, s2, 3
    s_lshl_b32 s37, s37, 2
    s_add_u32 s37, s37, s3
    s_lshl_b32 s37, s37, 10
    v_mfma_f32_16x16x32_bf16 v[160:163], a[64:67], a[0:3], v[224:227]
    v_exp_f32 v128, v128
    v_mfma_f32_16x16x32_bf16 v[164:167], a[64:67], a[16:19], v[228:231]
    ds_read_b128 a[96:99], v241 offset:2048
    s_mov_b32 m0, s48
    v_mfma_f32_16x16x32_bf16 v[168:171], a[64:67], a[32:35], v[232:235]
    buffer_load_dwordx4 v244, s[28:31], s47 offen sc1 lds
    v_mfma_f32_16x16x32_bf16 v[172:175], a[64:67], a[48:51], v[236:239]
    ds_read_b128 a[64:67], v241 offset:0
    v_mfma_f32_16x16x32_bf16 v[160:163], a[68:71], a[4:7], v[160:163]
    v_exp_f32 v129, v129
    v_mfma_f32_16x16x32_bf16 v[164:167], a[68:71], a[20:23], v[164:167]
    ds_read_b128 a[100:103], v241 offset:3072
    v_mfma_f32_16x16x32_bf16 v[168:171], a[68:71], a[36:39], v[168:171]
    v_cvt_pk_bf16_f32 v192, v128, v129
    v_mfma_f32_16x16x32_bf16 v[172:175], a[68:71], a[52:55], v[172:175]
    ds_read_b128 a[68:71], v241 offset:1024
    v_mfma_f32_16x16x32_bf16 v[160:163], a[72:75], a[8:11], v[160:163]
    buffer_load_dwordx4 a[148:151], v244, s[52:55], s51 offen
    s_add_u32 s51, s51, 1024
    v_mfma_f32_16x16x32_bf16 v[164:167], a[72:75], a[24:27], v[164:167]
    ds_read_b128 a[104:107], v241 offset:6144
    v_mfma_f32_16x16x32_bf16 v[168:171], a[72:75], a[40:43], v[168:171]
    v_exp_f32 v130, v130
    v_mfma_f32_16x16x32_bf16 v[172:175], a[72:75], a[56:59], v[172:175]
    ds_read_b128 a[72:75], v241 offset:4096
    v_mfma_f32_16x16x32_bf16 v[160:163], a[76:79], a[12:15], v[160:163]
    v_exp_f32 v131, v131
    v_mfma_f32_16x16x32_bf16 v[164:167], a[76:79], a[28:31], v[164:167]
    ds_read_b128 a[108:111], v241 offset:7168
    v_mfma_f32_16x16x32_bf16 v[168:171], a[76:79], a[44:47], v[168:171]
    buffer_load_dwordx4 v244, s[28:31], s47 offen offset:1024 sc1 lds
    v_mfma_f32_16x16x32_bf16 v[172:175], a[76:79], a[60:63], v[172:175]
    ds_read_b128 a[76:79], v241 offset:5120
    v_mfma_f32_16x16x32_bf16 v[176:179], a[80:83], a[0:3], v[224:227]
    v_cvt_pk_bf16_f32 v193, v130, v131
    v_mfma_f32_16x16x32_bf16 v[180:183], a[80:83], a[16:19], v[228:231]
    ds_read_b128 a[112:115], v241 offset:10240
    v_mfma_f32_16x16x32_bf16 v[184:187], a[80:83], a[32:35], v[232:235]
    v_exp_f32 v144, v144
    v_mfma_f32_16x16x32_bf16 v[188:191], a[80:83], a[48:51], v[236:239]
    ds_read_b128 a[80:83], v241 offset:8192
    s_add_u32 s41, s45, 0
    v_mfma_f32_16x16x32_bf16 v[176:179], a[84:87], a[4:7], v[176:179]
    buffer_store_dwordx4 a[152:155], v244, s[16:19], s41 offen sc1
    v_mfma_f32_16x16x32_bf16 v[180:183], a[84:87], a[20:23], v[180:183]
    ds_read_b128 a[116:119], v241 offset:11264
    v_mfma_f32_16x16x32_bf16 v[184:187], a[84:87], a[36:39], v[184:187]
    v_exp_f32 v145, v145
    v_mfma_f32_16x16x32_bf16 v[188:191], a[84:87], a[52:55], v[188:191]
    ds_read_b128 a[84:87], v241 offset:9216
    s_waitcnt lgkmcnt(7)
    v_mfma_f32_16x16x32_bf16 v[176:179], a[88:91], a[8:11], v[176:179]
    v_cvt_pk_bf16_f32 v194, v144, v145
    v_mfma_f32_16x16x32_bf16 v[180:183], a[88:91], a[24:27], v[180:183]
    ds_read_b128 a[120:123], v241 offset:14336
    v_mfma_f32_16x16x32_bf16 v[184:187], a[88:91], a[40:43], v[184:187]
    buffer_load_dwordx4 v244, s[32:35], s47 offen offset:2048 sc1 lds
    v_mfma_f32_16x16x32_bf16 v[188:191], a[88:91], a[56:59], v[188:191]
    ds_read_b128 a[88:91], v241 offset:12288
    v_mfma_f32_16x16x32_bf16 v[176:179], a[92:95], a[12:15], v[176:179]
    v_exp_f32 v146, v146
    v_mfma_f32_16x16x32_bf16 v[180:183], a[92:95], a[28:31], v[180:183]
    ds_read_b128 a[124:127], v241 offset:15360
    v_mfma_f32_16x16x32_bf16 v[184:187], a[92:95], a[44:47], v[184:187]
    v_exp_f32 v147, v147
    s_add_u32 s41, s45, 2048
    v_mfma_f32_16x16x32_bf16 v[188:191], a[92:95], a[60:63], v[188:191]
    ds_read_b128 a[92:95], v241 offset:13312
    buffer_load_dwordx4 v244, s[32:35], s47 offen offset:3072 sc1 lds
    buffer_store_dwordx4 a[156:159], v244, s[16:19], s41 offen sc1
    v_cvt_pk_bf16_f32 v195, v146, v147
    v_exp_f32 v132, v132
    v_exp_f32 v133, v133
    s_nop 0
    v_cvt_pk_bf16_f32 v196, v132, v133
    v_exp_f32 v134, v134
    v_exp_f32 v135, v135
    s_nop 0
    v_cvt_pk_bf16_f32 v197, v134, v135
    v_exp_f32 v148, v148
    v_exp_f32 v149, v149
    s_nop 0
    v_cvt_pk_bf16_f32 v198, v148, v149
    v_exp_f32 v150, v150
    v_exp_f32 v151, v151
    s_nop 0
    v_cvt_pk_bf16_f32 v199, v150, v151
    v_exp_f32 v136, v136
    v_exp_f32 v137, v137
    s_nop 0
    v_cvt_pk_bf16_f32 v200, v136, v137
    v_exp_f32 v138, v138
    v_exp_f32 v139, v139
    s_nop 0
    v_cvt_pk_bf16_f32 v201, v138, v139
    v_exp_f32 v152, v152
    v_exp_f32 v153, v153
    s_nop 0
    v_cvt_pk_bf16_f32 v202, v152, v153
    v_exp_f32 v154, v154
    v_exp_f32 v155, v155
    s_nop 0
    v_cvt_pk_bf16_f32 v203, v154, v155
    v_exp_f32 v140, v140
    v_exp_f32 v141, v141
    s_nop 0
    v_cvt_pk_bf16_f32 v204, v140, v141
    v_exp_f32 v142, v142
    v_exp_f32 v143, v143
    s_nop 0
    v_cvt_pk_bf16_f32 v205, v142, v143
    v_exp_f32 v156, v156
    v_exp_f32 v157, v157
    s_nop 0
    v_cvt_pk_bf16_f32 v206, v156, v157
    v_exp_f32 v158, v158
    v_exp_f32 v159, v159
    s_nop 0
    v_cvt_pk_bf16_f32 v207, v158, v159
    s_add_u32 s47, s47, 8192
    s_add_u32 s48, s48, 16384
    s_and_b32 s48, s48, 0x1ffff
    s_waitcnt vmcnt(15)
    s_barrier
    v_mfma_f32_16x16x32_bf16 v[128:131], a[64:67], a[0:3], v[224:227]
    v_exp_f32 v160, v160
    s_mov_b32 m0, s48
    v_mfma_f32_16x16x32_bf16 v[132:135], a[64:67], a[16:19], v[228:231]
    buffer_load_dwordx4 v244, s[28:31], s47 offen sc1 lds
    v_mfma_f32_16x16x32_bf16 v[136:139], a[64:67], a[32:35], v[232:235]
    v_exp_f32 v161, v161
    v_mfma_f32_16x16x32_bf16 v[140:143], a[64:67], a[48:51], v[236:239]
    ds_read_b128 a[64:67], v241 offset:16384
    v_mfma_f32_16x16x32_bf16 v[128:131], a[68:71], a[4:7], v[128:131]
    v_cvt_pk_bf16_f32 v208, v160, v161
    v_mfma_f32_16x16x32_bf16 v[132:135], a[68:71], a[20:23], v[132:135]
    v_exp_f32 v162, v162
    v_mfma_f32_16x16x32_bf16 v[136:139], a[68:71], a[36:39], v[136:139]
    v_exp_f32 v163, v163
    v_mfma_f32_16x16x32_bf16 v[140:143], a[68:71], a[52:55], v[140:143]
    ds_read_b128 a[68:71], v241 offset:17408
    s_waitcnt lgkmcnt(6)
    v_mfma_f32_16x16x32_bf16 v[128:131], a[72:75], a[8:11], v[128:131]
    buffer_load_dwordx4 a[148:151], v244, s[56:59], s60 offen
    s_add_u32 s60, s60, 1024
    v_mfma_f32_16x16x32_bf16 v[132:135], a[72:75], a[24:27], v[132:135]
    v_cvt_pk_bf16_f32 v209, v162, v163
    v_mfma_f32_16x16x32_bf16 v[136:139], a[72:75], a[40:43], v[136:139]
    v_exp_f32 v176, v176
    v_mfma_f32_16x16x32_bf16 v[140:143], a[72:75], a[56:59], v[140:143]
    ds_read_b128 a[72:75], v241 offset:20480
    v_mfma_f32_16x16x32_bf16 v[128:131], a[76:79], a[12:15], v[128:131]
    v_exp_f32 v177, v177
    v_mfma_f32_16x16x32_bf16 v[132:135], a[76:79], a[28:31], v[132:135]
    buffer_load_dwordx4 v244, s[28:31], s47 offen offset:1024 sc1 lds
    v_mfma_f32_16x16x32_bf16 v[136:139], a[76:79], a[44:47], v[136:139]
    v_cvt_pk_bf16_f32 v210, v176, v177
    v_mfma_f32_16x16x32_bf16 v[140:143], a[76:79], a[60:63], v[140:143]
    ds_read_b128 a[76:79], v241 offset:21504
    v_mfma_f32_16x16x32_bf16 v[144:147], a[80:83], a[0:3], v[224:227]
    v_exp_f32 v178, v178
    v_mfma_f32_16x16x32_bf16 v[148:151], a[80:83], a[16:19], v[228:231]
    v_exp_f32 v179, v179
    v_mfma_f32_16x16x32_bf16 v[152:155], a[80:83], a[32:35], v[232:235]
    v_cvt_pk_bf16_f32 v211, v178, v179
    v_mfma_f32_16x16x32_bf16 v[156:159], a[80:83], a[48:51], v[236:239]
    ds_read_b128 a[80:83], v241 offset:24576
    s_add_u32 s41, s45, 4096
    v_mfma_f32_16x16x32_bf16 v[144:147], a[84:87], a[4:7], v[144:147]
    buffer_store_dwordx4 a[160:163], v244, s[16:19], s41 offen sc1
    v_mfma_f32_16x16x32_bf16 v[148:151], a[84:87], a[20:23], v[148:151]
    v_exp_f32 v164, v164
    v_mfma_f32_16x16x32_bf16 v[152:155], a[84:87], a[36:39], v[152:155]
    v_exp_f32 v165, v165
    v_mfma_f32_16x16x32_bf16 v[156:159], a[84:87], a[52:55], v[156:159]
    ds_read_b128 a[84:87], v241 offset:25600
    s_waitcnt lgkmcnt(2)
    v_mfma_f32_16x16x32_bf16 v[144:147], a[88:91], a[8:11], v[144:147]
    v_cvt_pk_bf16_f32 v212, v164, v165
    v_mfma_f32_16x16x32_bf16 v[148:151], a[88:91], a[24:27], v[148:151]
    buffer_load_dwordx4 v244, s[32:35], s47 offen offset:2048 sc1 lds
    v_mfma_f32_16x16x32_bf16 v[152:155], a[88:91], a[40:43], v[152:155]
    v_exp_f32 v166, v166
    v_mfma_f32_16x16x32_bf16 v[156:159], a[88:91], a[56:59], v[156:159]
    ds_read_b128 a[88:91], v241 offset:28672
    v_mfma_f32_16x16x32_bf16 v[144:147], a[92:95], a[12:15], v[144:147]
    v_exp_f32 v167, v167
    v_mfma_f32_16x16x32_bf16 v[148:151], a[92:95], a[28:31], v[148:151]
    v_cvt_pk_bf16_f32 v213, v166, v167
    v_mfma_f32_16x16x32_bf16 v[152:155], a[92:95], a[44:47], v[152:155]
    v_exp_f32 v180, v180
    v_mfma_f32_16x16x32_bf16 v[156:159], a[92:95], a[60:63], v[156:159]
    ds_read_b128 a[92:95], v241 offset:29696
    v_mfma_f32_16x16x32_bf16 v[0:3], a[96:99], v[192:195], 0
    v_exp_f32 v181, v181
    v_mfma_f32_16x16x32_bf16 v[4:7], a[96:99], v[196:199], 0
    v_cvt_pk_bf16_f32 v214, v180, v181
    v_mfma_f32_16x16x32_bf16 v[8:11], a[96:99], v[200:203], 0
    v_exp_f32 v182, v182
    v_mfma_f32_16x16x32_bf16 v[12:15], a[96:99], v[204:207], 0
    ds_read_b128 a[96:99], v241 offset:18432
    v_mfma_f32_16x16x32_bf16 v[28:31], a[100:103], v[204:207], 0
    v_exp_f32 v183, v183
    v_mfma_f32_16x16x32_bf16 v[24:27], a[100:103], v[200:203], 0
    buffer_load_dwordx4 v244, s[32:35], s47 offen offset:3072 sc1 lds
    v_mfma_f32_16x16x32_bf16 v[20:23], a[100:103], v[196:199], 0
    v_cvt_pk_bf16_f32 v215, v182, v183
    v_mfma_f32_16x16x32_bf16 v[16:19], a[100:103], v[192:195], 0
    ds_read_b128 a[100:103], v241 offset:19456
    s_add_u32 s47, s47, 8192
    v_mfma_f32_16x16x32_bf16 v[32:35], a[104:107], v[192:195], 0
    v_exp_f32 v168, v168
    v_mfma_f32_16x16x32_bf16 v[36:39], a[104:107], v[196:199], 0
    v_exp_f32 v169, v169
    s_add_u32 s48, s48, 16384
    v_mfma_f32_16x16x32_bf16 v[40:43], a[104:107], v[200:203], 0
    v_cvt_pk_bf16_f32 v216, v168, v169
    v_mfma_f32_16x16x32_bf16 v[44:47], a[104:107], v[204:207], 0
    ds_read_b128 a[104:107], v241 offset:22528
    s_and_b32 s48, s48, 0x1ffff
    v_mfma_f32_16x16x32_bf16 v[60:63], a[108:111], v[204:207], 0
    v_exp_f32 v170, v170
    v_mfma_f32_16x16x32_bf16 v[56:59], a[108:111], v[200:203], 0
    v_exp_f32 v171, v171
    s_add_u32 s41, s46, 0
    v_mfma_f32_16x16x32_bf16 v[52:55], a[108:111], v[196:199], 0
    buffer_store_dwordx2 a[164:165], v244, s[16:19], s41 offen sc1
    v_mfma_f32_16x16x32_bf16 v[48:51], a[108:111], v[192:195], 0
    ds_read_b128 a[108:111], v241 offset:23552
    v_mfma_f32_16x16x32_bf16 v[64:67], a[112:115], v[192:195], 0
    v_cvt_pk_bf16_f32 v217, v170, v171
    v_mfma_f32_16x16x32_bf16 v[68:71], a[112:115], v[196:199], 0
    v_exp_f32 v184, v184
    v_mfma_f32_16x16x32_bf16 v[72:75], a[112:115], v[200:203], 0
    v_exp_f32 v185, v185
    v_mfma_f32_16x16x32_bf16 v[76:79], a[112:115], v[204:207], 0
    ds_read_b128 a[112:115], v241 offset:26624
    v_mfma_f32_16x16x32_bf16 v[92:95], a[116:119], v[204:207], 0
    v_cvt_pk_bf16_f32 v218, v184, v185
    v_mfma_f32_16x16x32_bf16 v[88:91], a[116:119], v[200:203], 0
    v_exp_f32 v186, v186
    v_mfma_f32_16x16x32_bf16 v[84:87], a[116:119], v[196:199], 0
    v_exp_f32 v187, v187
    v_mfma_f32_16x16x32_bf16 v[80:83], a[116:119], v[192:195], 0
    ds_read_b128 a[116:119], v241 offset:27648
    v_mfma_f32_16x16x32_bf16 v[96:99], a[120:123], v[192:195], 0
    v_cvt_pk_bf16_f32 v219, v186, v187
    v_mfma_f32_16x16x32_bf16 v[100:103], a[120:123], v[196:199], 0
    v_exp_f32 v172, v172
    v_mfma_f32_16x16x32_bf16 v[104:107], a[120:123], v[200:203], 0
    v_exp_f32 v173, v173
    v_mfma_f32_16x16x32_bf16 v[108:111], a[120:123], v[204:207], 0
    ds_read_b128 a[120:123], v241 offset:30720
    v_mfma_f32_16x16x32_bf16 v[124:127], a[124:127], v[204:207], 0
    v_cvt_pk_bf16_f32 v220, v172, v173
    v_mfma_f32_16x16x32_bf16 v[120:123], a[124:127], v[200:203], 0
    v_exp_f32 v174, v174
    v_mfma_f32_16x16x32_bf16 v[116:119], a[124:127], v[196:199], 0
    v_exp_f32 v175, v175
    v_mfma_f32_16x16x32_bf16 v[112:115], a[124:127], v[192:195], 0
    ds_read_b128 a[124:127], v241 offset:31744
    v_mfma_f32_16x16x32_bf16 a[128:131], a[144:147], v[192:195], 0
    v_add_u32 v241, 32768, v241
    v_mfma_f32_16x16x32_bf16 a[132:135], a[144:147], v[196:199], 0
    v_and_b32 v241, 0x1ffff, v241
    v_mfma_f32_16x16x32_bf16 a[136:139], a[144:147], v[200:203], 0
    v_cvt_pk_bf16_f32 v221, v174, v175
    v_mfma_f32_16x16x32_bf16 a[140:143], a[144:147], v[204:207], 0
    v_exp_f32 v188, v188
    v_exp_f32 v189, v189
    s_nop 0
    v_cvt_pk_bf16_f32 v222, v188, v189
    v_exp_f32 v190, v190
    v_exp_f32 v191, v191
    s_nop 0
    v_cvt_pk_bf16_f32 v223, v190, v191
    v_mfma_f32_16x16x32_bf16 v[160:163], a[64:67], a[0:3], v[224:227]
    v_exp_f32 v128, v128
    s_mov_b32 m0, s48
    v_mfma_f32_16x16x32_bf16 v[164:167], a[64:67], a[16:19], v[228:231]
    buffer_load_dwordx4 v244, s[28:31], s47 offen sc1 lds
    v_mfma_f32_16x16x32_bf16 v[168:171], a[64:67], a[32:35], v[232:235]
    v_exp_f32 v129, v129
    v_mfma_f32_16x16x32_bf16 v[172:175], a[64:67], a[48:51], v[236:239]
    ds_read_b128 a[64:67], v241 offset:0
    v_mfma_f32_16x16x32_bf16 v[160:163], a[68:71], a[4:7], v[160:163]
    v_cvt_pk_bf16_f32 v192, v128, v129
    v_mfma_f32_16x16x32_bf16 v[164:167], a[68:71], a[20:23], v[164:167]
    v_exp_f32 v130, v130
    v_mfma_f32_16x16x32_bf16 v[168:171], a[68:71], a[36:39], v[168:171]
    v_exp_f32 v131, v131
    v_mfma_f32_16x16x32_bf16 v[172:175], a[68:71], a[52:55], v[172:175]
    ds_read_b128 a[68:71], v241 offset:1024
    v_mfma_f32_16x16x32_bf16 v[160:163], a[72:75], a[8:11], v[160:163]
    buffer_load_dwordx4 a[148:151], v244, s[52:55], s51 offen
    s_add_u32 s51, s51, 1024
    v_mfma_f32_16x16x32_bf16 v[164:167], a[72:75], a[24:27], v[164:167]
    v_cvt_pk_bf16_f32 v193, v130, v131
    v_mfma_f32_16x16x32_bf16 v[168:171], a[72:75], a[40:43], v[168:171]
    v_exp_f32 v144, v144
    v_mfma_f32_16x16x32_bf16 v[172:175], a[72:75], a[56:59], v[172:175]
    ds_read_b128 a[72:75], v241 offset:4096
    v_mfma_f32_16x16x32_bf16 v[160:163], a[76:79], a[12:15], v[160:163]
    v_exp_f32 v145, v145
    v_mfma_f32_16x16x32_bf16 v[164:167], a[76:79], a[28:31], v[164:167]
    buffer_load_dwordx4 v244, s[28:31], s47 offen offset:1024 sc1 lds
    v_mfma_f32_16x16x32_bf16 v[168:171], a[76:79], a[44:47], v[168:171]
    v_cvt_pk_bf16_f32 v194, v144, v145
    v_mfma_f32_16x16x32_bf16 v[172:175], a[76:79], a[60:63], v[172:175]
    ds_read_b128 a[76:79], v241 offset:5120
    s_waitcnt lgkmcnt(9)
    v_mfma_f32_16x16x32_bf16 v[176:179], a[80:83], a[0:3], v[224:227]
    v_exp_f32 v146, v146
    v_mfma_f32_16x16x32_bf16 v[180:183], a[80:83], a[16:19], v[228:231]
    v_exp_f32 v147, v147
    v_mfma_f32_16x16x32_bf16 v[184:187], a[80:83], a[32:35], v[232:235]
    v_cvt_pk_bf16_f32 v195, v146, v147
    v_mfma_f32_16x16x32_bf16 v[188:191], a[80:83], a[48:51], v[236:239]
    ds_read_b128 a[80:83], v241 offset:8192
    s_add_u32 s41, s45, 1024
    v_mfma_f32_16x16x32_bf16 v[176:179], a[84:87], a[4:7], v[176:179]
    buffer_store_dwordx4 a[168:171], v244, s[16:19], s41 offen sc1
    v_mfma_f32_16x16x32_bf16 v[180:183], a[84:87], a[20:23], v[180:183]
    v_exp_f32 v132, v132
    v_mfma_f32_16x16x32_bf16 v[184:187], a[84:87], a[36:39], v[184:187]
    v_exp_f32 v133, v133
    v_mfma_f32_16x16x32_bf16 v[188:191], a[84:87], a[52:55], v[188:191]
    ds_read_b128 a[84:87], v241 offset:9216
    v_mfma_f32_16x16x32_bf16 v[176:179], a[88:91], a[8:11], v[176:179]
    v_cvt_pk_bf16_f32 v196, v132, v133
    v_mfma_f32_16x16x32_bf16 v[180:183], a[88:91], a[24:27], v[180:183]
    buffer_load_dwordx4 v244, s[32:35], s47 offen offset:2048 sc1 lds
    v_mfma_f32_16x16x32_bf16 v[184:187], a[88:91], a[40:43], v[184:187]
    v_exp_f32 v134, v134
    v_mfma_f32_16x16x32_bf16 v[188:191], a[88:91], a[56:59], v[188:191]
    ds_read_b128 a[88:91], v241 offset:12288
    v_mfma_f32_16x16x32_bf16 v[176:179], a[92:95], a[12:15], v[176:179]
    v_exp_f32 v135, v135
    v_mfma_f32_16x16x32_bf16 v[180:183], a[92:95], a[28:31], v[180:183]
    v_cvt_pk_bf16_f32 v197, v134, v135
    v_mfma_f32_16x16x32_bf16 v[184:187], a[92:95], a[44:47], v[184:187]
    v_exp_f32 v148, v148
    v_mfma_f32_16x16x32_bf16 v[188:191], a[92:95], a[60:63], v[188:191]
    ds_read_b128 a[92:95], v241 offset:13312
    v_mfma_f32_16x16x32_bf16 v[0:3], a[96:99], v[208:211], v[0:3]
    v_exp_f32 v149, v149
    v_mfma_f32_16x16x32_bf16 v[4:7], a[96:99], v[212:215], v[4:7]
    v_cvt_pk_bf16_f32 v198, v148, v149
    v_mfma_f32_16x16x32_bf16 v[8:11], a[96:99], v[216:219], v[8:11]
    v_exp_f32 v150, v150
    v_mfma_f32_16x16x32_bf16 v[12:15], a[96:99], v[220:223], v[12:15]
    ds_read_b128 a[96:99], v241 offset:2048
    v_mfma_f32_16x16x32_bf16 v[28:31], a[100:103], v[220:223], v[28:31]
    v_exp_f32 v151, v151
    v_mfma_f32_16x16x32_bf16 v[24:27], a[100:103], v[216:219], v[24:27]
    buffer_load_dwordx4 v244, s[32:35], s47 offen offset:3072 sc1 lds
    v_mfma_f32_16x16x32_bf16 v[20:23], a[100:103], v[212:215], v[20:23]
    v_cvt_pk_bf16_f32 v199, v150, v151
    v_mfma_f32_16x16x32_bf16 v[16:19], a[100:103], v[208:211], v[16:19]
    ds_read_b128 a[100:103], v241 offset:3072
    s_add_u32 s47, s47, 8192
    v_mfma_f32_16x16x32_bf16 v[32:35], a[104:107], v[208:211], v[32:35]
    v_exp_f32 v136, v136
    v_mfma_f32_16x16x32_bf16 v[36:39], a[104:107], v[212:215], v[36:39]
    v_exp_f32 v137, v137
    s_add_u32 s48, s48, 16384
    v_mfma_f32_16x16x32_bf16 v[40:43], a[104:107], v[216:219], v[40:43]
    v_cvt_pk_bf16_f32 v200, v136, v137
    v_mfma_f32_16x16x32_bf16 v[44:47], a[104:107], v[220:223], v[44:47]
    ds_read_b128 a[104:107], v241 offset:6144
    s_and_b32 s48, s48, 0x1ffff
    s_waitcnt lgkmcnt(9)
    v_mfma_f32_16x16x32_bf16 v[60:63], a[108:111], v[220:223], v[60:63]
    v_exp_f32 v138, v138
    v_mfma_f32_16x16x32_bf16 v[56:59], a[108:111], v[216:219], v[56:59]
    v_exp_f32 v139, v139
    s_add_u32 s41, s45, 3072
    v_mfma_f32_16x16x32_bf16 v[52:55], a[108:111], v[212:215], v[52:55]
    buffer_store_dwordx4 a[172:175], v244, s[16:19], s41 offen sc1
    v_mfma_f32_16x16x32_bf16 v[48:51], a[108:111], v[208:211], v[48:51]
    ds_read_b128 a[108:111], v241 offset:7168
    v_mfma_f32_16x16x32_bf16 v[64:67], a[112:115], v[208:211], v[64:67]
    v_cvt_pk_bf16_f32 v201, v138, v139
    v_mfma_f32_16x16x32_bf16 v[68:71], a[112:115], v[212:215], v[68:71]
    v_exp_f32 v152, v152
    v_mfma_f32_16x16x32_bf16 v[72:75], a[112:115], v[216:219], v[72:75]
    v_exp_f32 v153, v153
    v_mfma_f32_16x16x32_bf16 v[76:79], a[112:115], v[220:223], v[76:79]
    ds_read_b128 a[112:115], v241 offset:10240
    v_mfma_f32_16x16x32_bf16 v[92:95], a[116:119], v[220:223], v[92:95]
    v_cvt_pk_bf16_f32 v202, v152, v153
    v_mfma_f32_16x16x32_bf16 v[88:91], a[116:119], v[216:219], v[88:91]
    v_exp_f32 v154, v154
    v_mfma_f32_16x16x32_bf16 v[84:87], a[116:119], v[212:215], v[84:87]
    v_exp_f32 v155, v155
    v_mfma_f32_16x16x32_bf16 v[80:83], a[116:119], v[208:211], v[80:83]
    ds_read_b128 a[116:119], v241 offset:11264
    v_mfma_f32_16x16x32_bf16 v[96:99], a[120:123], v[208:211], v[96:99]
    v_cvt_pk_bf16_f32 v203, v154, v155
    v_mfma_f32_16x16x32_bf16 v[100:103], a[120:123], v[212:215], v[100:103]
    v_exp_f32 v140, v140
    v_mfma_f32_16x16x32_bf16 v[104:107], a[120:123], v[216:219], v[104:107]
    v_exp_f32 v141, v141
    v_mfma_f32_16x16x32_bf16 v[108:111], a[120:123], v[220:223], v[108:111]
    ds_read_b128 a[120:123], v241 offset:14336
    v_mfma_f32_16x16x32_bf16 v[124:127], a[124:127], v[220:223], v[124:127]
    v_cvt_pk_bf16_f32 v204, v140, v141
    v_mfma_f32_16x16x32_bf16 v[120:123], a[124:127], v[216:219], v[120:123]
    v_exp_f32 v142, v142
    v_mfma_f32_16x16x32_bf16 v[116:119], a[124:127], v[212:215], v[116:119]
    v_exp_f32 v143, v143
    v_mfma_f32_16x16x32_bf16 v[112:115], a[124:127], v[208:211], v[112:115]
    ds_read_b128 a[124:127], v241 offset:15360
    v_mfma_f32_16x16x32_bf16 a[128:131], a[144:147], v[208:211], a[128:131]
    v_cvt_pk_bf16_f32 v205, v142, v143
    v_mfma_f32_16x16x32_bf16 a[132:135], a[144:147], v[212:215], a[132:135]
    v_exp_f32 v156, v156
    v_mfma_f32_16x16x32_bf16 a[136:139], a[144:147], v[216:219], a[136:139]
    v_exp_f32 v157, v157
    v_mfma_f32_16x16x32_bf16 a[140:143], a[144:147], v[220:223], a[140:143]
    v_cvt_pk_bf16_f32 v206, v156, v157
    v_exp_f32 v158, v158
    v_exp_f32 v159, v159
    s_nop 0
    v_cvt_pk_bf16_f32 v207, v158, v159
    s_waitcnt vmcnt(21)
    s_barrier
    v_mfma_f32_16x16x32_bf16 v[128:131], a[64:67], a[0:3], v[224:227]
    v_exp_f32 v160, v160
    s_mov_b32 m0, s48
    v_mfma_f32_16x16x32_bf16 v[132:135], a[64:67], a[16:19], v[228:231]
    buffer_load_dwordx4 v244, s[28:31], s47 offen sc1 lds
    v_mfma_f32_16x16x32_bf16 v[136:139], a[64:67], a[32:35], v[232:235]
    v_exp_f32 v161, v161
    v_mfma_f32_16x16x32_bf16 v[140:143], a[64:67], a[48:51], v[236:239]
    ds_read_b128 a[64:67], v241 offset:16384
    v_mfma_f32_16x16x32_bf16 v[128:131], a[68:71], a[4:7], v[128:131]
    v_cvt_pk_bf16_f32 v208, v160, v161
    v_mfma_f32_16x16x32_bf16 v[132:135], a[68:71], a[20:23], v[132:135]
    v_exp_f32 v162, v162
    v_mfma_f32_16x16x32_bf16 v[136:139], a[68:71], a[36:39], v[136:139]
    v_exp_f32 v163, v163
    v_mfma_f32_16x16x32_bf16 v[140:143], a[68:71], a[52:55], v[140:143]
    ds_read_b128 a[68:71], v241 offset:17408
    s_waitcnt lgkmcnt(9)
    v_mfma_f32_16x16x32_bf16 v[128:131], a[72:75], a[8:11], v[128:131]
    buffer_load_dwordx4 a[148:151], v244, s[56:59], s60 offen
    s_add_u32 s60, s60, 1024
    v_mfma_f32_16x16x32_bf16 v[132:135], a[72:75], a[24:27], v[132:135]
    v_cvt_pk_bf16_f32 v209, v162, v163
    v_mfma_f32_16x16x32_bf16 v[136:139], a[72:75], a[40:43], v[136:139]
    v_exp_f32 v176, v176
    v_mfma_f32_16x16x32_bf16 v[140:143], a[72:75], a[56:59], v[140:143]
    ds_read_b128 a[72:75], v241 offset:20480
    v_mfma_f32_16x16x32_bf16 v[128:131], a[76:79], a[12:15], v[128:131]
    v_exp_f32 v177, v177
    v_mfma_f32_16x16x32_bf16 v[132:135], a[76:79], a[28:31], v[132:135]
    buffer_load_dwordx4 v244, s[28:31], s47 offen offset:1024 sc1 lds
    v_mfma_f32_16x16x32_bf16 v[136:139], a[76:79], a[44:47], v[136:139]
    v_cvt_pk_bf16_f32 v210, v176, v177
    v_mfma_f32_16x16x32_bf16 v[140:143], a[76:79], a[60:63], v[140:143]
    ds_read_b128 a[76:79], v241 offset:21504
    v_mfma_f32_16x16x32_bf16 v[144:147], a[80:83], a[0:3], v[224:227]
    v_exp_f32 v178, v178
    v_mfma_f32_16x16x32_bf16 v[148:151], a[80:83], a[16:19], v[228:231]
    v_exp_f32 v179, v179
    v_mfma_f32_16x16x32_bf16 v[152:155], a[80:83], a[32:35], v[232:235]
    v_cvt_pk_bf16_f32 v211, v178, v179
    v_mfma_f32_16x16x32_bf16 v[156:159], a[80:83], a[48:51], v[236:239]
    ds_read_b128 a[80:83], v241 offset:24576
    s_add_u32 s41, s45, 5120
    v_mfma_f32_16x16x32_bf16 v[144:147], a[84:87], a[4:7], v[144:147]
    buffer_store_dwordx4 a[176:179], v244, s[16:19], s41 offen sc1
    v_mfma_f32_16x16x32_bf16 v[148:151], a[84:87], a[20:23], v[148:151]
    v_exp_f32 v164, v164
    v_mfma_f32_16x16x32_bf16 v[152:155], a[84:87], a[36:39], v[152:155]
    v_exp_f32 v165, v165
    v_mfma_f32_16x16x32_bf16 v[156:159], a[84:87], a[52:55], v[156:159]
    ds_read_b128 a[84:87], v241 offset:25600
    v_mfma_f32_16x16x32_bf16 v[144:147], a[88:91], a[8:11], v[144:147]
    v_cvt_pk_bf16_f32 v212, v164, v165
    v_mfma_f32_16x16x32_bf16 v[148:151], a[88:91], a[24:27], v[148:151]
    buffer_load_dwordx4 v244, s[32:35], s47 offen offset:2048 sc1 lds
    v_mfma_f32_16x16x32_bf16 v[152:155], a[88:91], a[40:43], v[152:155]
    v_exp_f32 v166, v166
    v_mfma_f32_16x16x32_bf16 v[156:159], a[88:91], a[56:59], v[156:159]
    ds_read_b128 a[88:91], v241 offset:28672
    v_mfma_f32_16x16x32_bf16 v[144:147], a[92:95], a[12:15], v[144:147]
    v_exp_f32 v167, v167
    v_mfma_f32_16x16x32_bf16 v[148:151], a[92:95], a[28:31], v[148:151]
    v_cvt_pk_bf16_f32 v213, v166, v167
    v_mfma_f32_16x16x32_bf16 v[152:155], a[92:95], a[44:47], v[152:155]
    v_exp_f32 v180, v180
    v_mfma_f32_16x16x32_bf16 v[156:159], a[92:95], a[60:63], v[156:159]
    ds_read_b128 a[92:95], v241 offset:29696
    v_mfma_f32_16x16x32_bf16 v[0:3], a[96:99], v[192:195], v[0:3]
    v_exp_f32 v181, v181
    v_mfma_f32_16x16x32_bf16 v[4:7], a[96:99], v[196:199], v[4:7]
    v_cvt_pk_bf16_f32 v214, v180, v181
    v_mfma_f32_16x16x32_bf16 v[8:11], a[96:99], v[200:203], v[8:11]
    v_exp_f32 v182, v182
    v_mfma_f32_16x16x32_bf16 v[12:15], a[96:99], v[204:207], v[12:15]
    ds_read_b128 a[96:99], v241 offset:18432
    s_waitcnt lgkmcnt(9)
    v_mfma_f32_16x16x32_bf16 v[28:31], a[100:103], v[204:207], v[28:31]
    v_exp_f32 v183, v183
    v_mfma_f32_16x16x32_bf16 v[24:27], a[100:103], v[200:203], v[24:27]
    buffer_load_dwordx4 v244, s[32:35], s47 offen offset:3072 sc1 lds
    v_mfma_f32_16x16x32_bf16 v[20:23], a[100:103], v[196:199], v[20:23]
    v_cvt_pk_bf16_f32 v215, v182, v183
    v_mfma_f32_16x16x32_bf16 v[16:19], a[100:103], v[192:195], v[16:19]
    ds_read_b128 a[100:103], v241 offset:19456
    s_add_u32 s47, s47, 8192
    v_mfma_f32_16x16x32_bf16 v[32:35], a[104:107], v[192:195], v[32:35]
    v_exp_f32 v168, v168
    v_mfma_f32_16x16x32_bf16 v[36:39], a[104:107], v[196:199], v[36:39]
    v_exp_f32 v169, v169
    s_add_u32 s48, s48, 16384
    v_mfma_f32_16x16x32_bf16 v[40:43], a[104:107], v[200:203], v[40:43]
    v_cvt_pk_bf16_f32 v216, v168, v169
    v_mfma_f32_16x16x32_bf16 v[44:47], a[104:107], v[204:207], v[44:47]
    ds_read_b128 a[104:107], v241 offset:22528
    s_and_b32 s48, s48, 0x1ffff
    v_mfma_f32_16x16x32_bf16 v[60:63], a[108:111], v[204:207], v[60:63]
    v_exp_f32 v170, v170
    v_mfma_f32_16x16x32_bf16 v[56:59], a[108:111], v[200:203], v[56:59]
    v_exp_f32 v171, v171
    s_add_u32 s41, s46, 1024
    v_mfma_f32_16x16x32_bf16 v[52:55], a[108:111], v[196:199], v[52:55]
    buffer_store_dwordx2 a[180:181], v244, s[16:19], s41 offen sc1
    v_mfma_f32_16x16x32_bf16 v[48:51], a[108:111], v[192:195], v[48:51]
    ds_read_b128 a[108:111], v241 offset:23552
    v_mfma_f32_16x16x32_bf16 v[64:67], a[112:115], v[192:195], v[64:67]
    v_cvt_pk_bf16_f32 v217, v170, v171
    v_mfma_f32_16x16x32_bf16 v[68:71], a[112:115], v[196:199], v[68:71]
    v_exp_f32 v184, v184
    v_mfma_f32_16x16x32_bf16 v[72:75], a[112:115], v[200:203], v[72:75]
    v_exp_f32 v185, v185
    v_mfma_f32_16x16x32_bf16 v[76:79], a[112:115], v[204:207], v[76:79]
    ds_read_b128 a[112:115], v241 offset:26624
    v_mfma_f32_16x16x32_bf16 v[92:95], a[116:119], v[204:207], v[92:95]
    v_cvt_pk_bf16_f32 v218, v184, v185
    v_mfma_f32_16x16x32_bf16 v[88:91], a[116:119], v[200:203], v[88:91]
    v_exp_f32 v186, v186
    v_mfma_f32_16x16x32_bf16 v[84:87], a[116:119], v[196:199], v[84:87]
    v_exp_f32 v187, v187
    v_mfma_f32_16x16x32_bf16 v[80:83], a[116:119], v[192:195], v[80:83]
    ds_read_b128 a[116:119], v241 offset:27648
    v_mfma_f32_16x16x32_bf16 v[96:99], a[120:123], v[192:195], v[96:99]
    v_cvt_pk_bf16_f32 v219, v186, v187
    v_mfma_f32_16x16x32_bf16 v[100:103], a[120:123], v[196:199], v[100:103]
    v_exp_f32 v172, v172
    v_mfma_f32_16x16x32_bf16 v[104:107], a[120:123], v[200:203], v[104:107]
    v_exp_f32 v173, v173
    v_mfma_f32_16x16x32_bf16 v[108:111], a[120:123], v[204:207], v[108:111]
    ds_read_b128 a[120:123], v241 offset:30720
    v_mfma_f32_16x16x32_bf16 v[124:127], a[124:127], v[204:207], v[124:127]
    v_cvt_pk_bf16_f32 v220, v172, v173
    v_mfma_f32_16x16x32_bf16 v[120:123], a[124:127], v[200:203], v[120:123]
    v_exp_f32 v174, v174
    v_mfma_f32_16x16x32_bf16 v[116:119], a[124:127], v[196:199], v[116:119]
    v_exp_f32 v175, v175
    v_mfma_f32_16x16x32_bf16 v[112:115], a[124:127], v[192:195], v[112:115]
    ds_read_b128 a[124:127], v241 offset:31744
    v_mfma_f32_16x16x32_bf16 a[128:131], a[144:147], v[192:195], a[128:131]
    v_add_u32 v241, 32768, v241
    v_mfma_f32_16x16x32_bf16 a[132:135], a[144:147], v[196:199], a[132:135]
    v_and_b32 v241, 0x1ffff, v241
    v_mfma_f32_16x16x32_bf16 a[136:139], a[144:147], v[200:203], a[136:139]
    v_cvt_pk_bf16_f32 v221, v174, v175
    v_mfma_f32_16x16x32_bf16 a[140:143], a[144:147], v[204:207], a[140:143]
    v_exp_f32 v188, v188
    v_exp_f32 v189, v189
    s_nop 0
    v_cvt_pk_bf16_f32 v222, v188, v189
    v_exp_f32 v190, v190
    v_exp_f32 v191, v191
    s_nop 0
    v_cvt_pk_bf16_f32 v223, v190, v191
    s_waitcnt lgkmcnt(9)
    v_mfma_f32_16x16x32_bf16 v[160:163], a[64:67], a[0:3], v[224:227]
    v_exp_f32 v128, v128
    s_mov_b32 m0, s48
    v_mfma_f32_16x16x32_bf16 v[164:167], a[64:67], a[16:19], v[228:231]
    buffer_load_dwordx4 v244, s[28:31], s47 offen sc1 lds
    v_mfma_f32_16x16x32_bf16 v[168:171], a[64:67], a[32:35], v[232:235]
    v_exp_f32 v129, v129
    v_mfma_f32_16x16x32_bf16 v[172:175], a[64:67], a[48:51], v[236:239]
    ds_read_b128 a[64:67], v241 offset:0
    v_mfma_f32_16x16x32_bf16 v[160:163], a[68:71], a[4:7], v[160:163]
    v_cvt_pk_bf16_f32 v192, v128, v129
    v_mfma_f32_16x16x32_bf16 v[164:167], a[68:71], a[20:23], v[164:167]
    v_exp_f32 v130, v130
    v_mfma_f32_16x16x32_bf16 v[168:171], a[68:71], a[36:39], v[168:171]
    v_exp_f32 v131, v131
    v_mfma_f32_16x16x32_bf16 v[172:175], a[68:71], a[52:55], v[172:175]
    ds_read_b128 a[68:71], v241 offset:1024
    v_mfma_f32_16x16x32_bf16 v[160:163], a[72:75], a[8:11], v[160:163]
    buffer_load_dwordx4 a[148:151], v244, s[52:55], s51 offen
    s_add_u32 s51, s51, 1024
    v_mfma_f32_16x16x32_bf16 v[164:167], a[72:75], a[24:27], v[164:167]
    v_cvt_pk_bf16_f32 v193, v130, v131
    v_mfma_f32_16x16x32_bf16 v[168:171], a[72:75], a[40:43], v[168:171]
    v_exp_f32 v144, v144
    v_mfma_f32_16x16x32_bf16 v[172:175], a[72:75], a[56:59], v[172:175]
    ds_read_b128 a[72:75], v241 offset:4096
    v_mfma_f32_16x16x32_bf16 v[160:163], a[76:79], a[12:15], v[160:163]
    v_exp_f32 v145, v145
    v_mfma_f32_16x16x32_bf16 v[164:167], a[76:79], a[28:31], v[164:167]
    buffer_load_dwordx4 v244, s[28:31], s47 offen offset:1024 sc1 lds
    v_mfma_f32_16x16x32_bf16 v[168:171], a[76:79], a[44:47], v[168:171]
    v_cvt_pk_bf16_f32 v194, v144, v145
    v_mfma_f32_16x16x32_bf16 v[172:175], a[76:79], a[60:63], v[172:175]
    ds_read_b128 a[76:79], v241 offset:5120
    v_mfma_f32_16x16x32_bf16 v[176:179], a[80:83], a[0:3], v[224:227]
    v_exp_f32 v146, v146
    v_mfma_f32_16x16x32_bf16 v[180:183], a[80:83], a[16:19], v[228:231]
    v_exp_f32 v147, v147
    v_mfma_f32_16x16x32_bf16 v[184:187], a[80:83], a[32:35], v[232:235]
    v_cvt_pk_bf16_f32 v195, v146, v147
    v_mfma_f32_16x16x32_bf16 v[188:191], a[80:83], a[48:51], v[236:239]
    ds_read_b128 a[80:83], v241 offset:8192
    s_add_u32 s41, s45, 237568
    v_mfma_f32_16x16x32_bf16 v[176:179], a[84:87], a[4:7], v[176:179]
    buffer_store_dwordx4 a[184:187], v244, s[16:19], s41 offen sc1
    v_mfma_f32_16x16x32_bf16 v[180:183], a[84:87], a[20:23], v[180:183]
    v_exp_f32 v132, v132
    v_mfma_f32_16x16x32_bf16 v[184:187], a[84:87], a[36:39], v[184:187]
    v_exp_f32 v133, v133
    v_mfma_f32_16x16x32_bf16 v[188:191], a[84:87], a[52:55], v[188:191]
    ds_read_b128 a[84:87], v241 offset:9216
    v_mfma_f32_16x16x32_bf16 v[176:179], a[88:91], a[8:11], v[176:179]
    v_cvt_pk_bf16_f32 v196, v132, v133
    v_mfma_f32_16x16x32_bf16 v[180:183], a[88:91], a[24:27], v[180:183]
    buffer_load_dwordx4 v244, s[32:35], s47 offen offset:2048 sc1 lds
    v_mfma_f32_16x16x32_bf16 v[184:187], a[88:91], a[40:43], v[184:187]
    v_exp_f32 v134, v134
    v_mfma_f32_16x16x32_bf16 v[188:191], a[88:91], a[56:59], v[188:191]
    ds_read_b128 a[88:91], v241 offset:12288
    s_waitcnt lgkmcnt(9)
    v_mfma_f32_16x16x32_bf16 v[176:179], a[92:95], a[12:15], v[176:179]
    v_exp_f32 v135, v135
    v_mfma_f32_16x16x32_bf16 v[180:183], a[92:95], a[28:31], v[180:183]
    v_cvt_pk_bf16_f32 v197, v134, v135
    v_mfma_f32_16x16x32_bf16 v[184:187], a[92:95], a[44:47], v[184:187]
    v_exp_f32 v148, v148
    v_mfma_f32_16x16x32_bf16 v[188:191], a[92:95], a[60:63], v[188:191]
    ds_read_b128 a[92:95], v241 offset:13312
    v_mfma_f32_16x16x32_bf16 v[0:3], a[96:99], v[208:211], v[0:3]
    v_exp_f32 v149, v149
    v_mfma_f32_16x16x32_bf16 v[4:7], a[96:99], v[212:215], v[4:7]
    v_cvt_pk_bf16_f32 v198, v148, v149
    v_mfma_f32_16x16x32_bf16 v[8:11], a[96:99], v[216:219], v[8:11]
    v_exp_f32 v150, v150
    v_mfma_f32_16x16x32_bf16 v[12:15], a[96:99], v[220:223], v[12:15]
    ds_read_b128 a[96:99], v241 offset:2048
    v_mfma_f32_16x16x32_bf16 v[28:31], a[100:103], v[220:223], v[28:31]
    v_exp_f32 v151, v151
    v_mfma_f32_16x16x32_bf16 v[24:27], a[100:103], v[216:219], v[24:27]
    buffer_load_dwordx4 v244, s[32:35], s47 offen offset:3072 sc1 lds
    v_mfma_f32_16x16x32_bf16 v[20:23], a[100:103], v[212:215], v[20:23]
    buffer_load_dwordx4 a[148:151], v244, s[8:11], s37 offen
    v_mfma_f32_16x16x32_bf16 v[16:19], a[100:103], v[208:211], v[16:19]
    ds_read_b128 a[100:103], v241 offset:3072
    s_add_u32 s47, s47, 8192
    v_mfma_f32_16x16x32_bf16 v[32:35], a[104:107], v[208:211], v[32:35]
    v_cvt_pk_bf16_f32 v199, v150, v151
    v_mfma_f32_16x16x32_bf16 v[36:39], a[104:107], v[212:215], v[36:39]
    v_exp_f32 v136, v136
    s_add_u32 s48, s48, 16384
    v_mfma_f32_16x16x32_bf16 v[40:43], a[104:107], v[216:219], v[40:43]
    v_exp_f32 v137, v137
    v_mfma_f32_16x16x32_bf16 v[44:47], a[104:107], v[220:223], v[44:47]
    ds_read_b128 a[104:107], v241 offset:6144
    s_and_b32 s48, s48, 0x1ffff
    v_mfma_f32_16x16x32_bf16 v[60:63], a[108:111], v[220:223], v[60:63]
    v_cvt_pk_bf16_f32 v200, v136, v137
    v_mfma_f32_16x16x32_bf16 v[56:59], a[108:111], v[216:219], v[56:59]
    v_exp_f32 v138, v138
    s_add_u32 s41, s45, 239616
    v_mfma_f32_16x16x32_bf16 v[52:55], a[108:111], v[212:215], v[52:55]
    buffer_store_dwordx4 a[188:191], v244, s[16:19], s41 offen sc1
    v_mfma_f32_16x16x32_bf16 v[48:51], a[108:111], v[208:211], v[48:51]
    ds_read_b128 a[108:111], v241 offset:7168
    v_mfma_f32_16x16x32_bf16 v[64:67], a[112:115], v[208:211], v[64:67]
    v_exp_f32 v139, v139
    v_mfma_f32_16x16x32_bf16 v[68:71], a[112:115], v[212:215], v[68:71]
    v_cvt_pk_bf16_f32 v201, v138, v139
    v_mfma_f32_16x16x32_bf16 v[72:75], a[112:115], v[216:219], v[72:75]
    v_exp_f32 v152, v152
    v_mfma_f32_16x16x32_bf16 v[76:79], a[112:115], v[220:223], v[76:79]
    ds_read_b128 a[112:115], v241 offset:10240
    v_mfma_f32_16x16x32_bf16 v[92:95], a[116:119], v[220:223], v[92:95]
    v_exp_f32 v153, v153
    v_mfma_f32_16x16x32_bf16 v[88:91], a[116:119], v[216:219], v[88:91]
    v_cvt_pk_bf16_f32 v202, v152, v153
    v_mfma_f32_16x16x32_bf16 v[84:87], a[116:119], v[212:215], v[84:87]
    v_exp_f32 v154, v154
    v_mfma_f32_16x16x32_bf16 v[80:83], a[116:119], v[208:211], v[80:83]
    ds_read_b128 a[116:119], v241 offset:11264
    s_waitcnt lgkmcnt(9)
    v_mfma_f32_16x16x32_bf16 v[96:99], a[120:123], v[208:211], v[96:99]
    v_exp_f32 v155, v155
    v_mfma_f32_16x16x32_bf16 v[100:103], a[120:123], v[212:215], v[100:103]
    v_cvt_pk_bf16_f32 v203, v154, v155
    v_mfma_f32_16x16x32_bf16 v[104:107], a[120:123], v[216:219], v[104:107]
    v_exp_f32 v140, v140
    v_mfma_f32_16x16x32_bf16 v[108:111], a[120:123], v[220:223], v[108:111]
    ds_read_b128 a[120:123], v241 offset:14336
    v_mfma_f32_16x16x32_bf16 v[124:127], a[124:127], v[220:223], v[124:127]
    v_exp_f32 v141, v141
    v_mfma_f32_16x16x32_bf16 v[120:123], a[124:127], v[216:219], v[120:123]
    v_cvt_pk_bf16_f32 v204, v140, v141
    v_mfma_f32_16x16x32_bf16 v[116:119], a[124:127], v[212:215], v[116:119]
    v_exp_f32 v142, v142
    v_mfma_f32_16x16x32_bf16 v[112:115], a[124:127], v[208:211], v[112:115]
    ds_read_b128 a[124:127], v241 offset:15360
    v_mfma_f32_16x16x32_bf16 a[128:131], a[144:147], v[208:211], a[128:131]
    v_exp_f32 v143, v143
    v_mfma_f32_16x16x32_bf16 a[132:135], a[144:147], v[212:215], a[132:135]
    v_cvt_pk_bf16_f32 v205, v142, v143
    v_mfma_f32_16x16x32_bf16 a[136:139], a[144:147], v[216:219], a[136:139]
    v_exp_f32 v156, v156
    v_mfma_f32_16x16x32_bf16 a[140:143], a[144:147], v[220:223], a[140:143]
    v_exp_f32 v157, v157
    s_nop 0
    v_cvt_pk_bf16_f32 v206, v156, v157
    v_exp_f32 v158, v158
    v_exp_f32 v159, v159
    s_nop 0
    v_cvt_pk_bf16_f32 v207, v158, v159
    s_waitcnt vmcnt(21)
    s_barrier
    v_mfma_f32_16x16x32_bf16 v[128:131], a[64:67], a[0:3], v[224:227]
    v_exp_f32 v160, v160
    s_mov_b32 m0, s48
    v_mfma_f32_16x16x32_bf16 v[132:135], a[64:67], a[16:19], v[228:231]
    buffer_load_dwordx4 v244, s[28:31], s47 offen sc1 lds
    v_mfma_f32_16x16x32_bf16 v[136:139], a[64:67], a[32:35], v[232:235]
    v_exp_f32 v161, v161
    v_mfma_f32_16x16x32_bf16 v[140:143], a[64:67], a[48:51], v[236:239]
    ds_read_b128 a[64:67], v241 offset:16384
    v_mfma_f32_16x16x32_bf16 v[128:131], a[68:71], a[4:7], v[128:131]
    v_cvt_pk_bf16_f32 v208, v160, v161
    v_mfma_f32_16x16x32_bf16 v[132:135], a[68:71], a[20:23], v[132:135]
    v_exp_f32 v162, v162
    v_mfma_f32_16x16x32_bf16 v[136:139], a[68:71], a[36:39], v[136:139]
    v_exp_f32 v163, v163
    v_mfma_f32_16x16x32_bf16 v[140:143], a[68:71], a[52:55], v[140:143]
    ds_read_b128 a[68:71], v241 offset:17408
    v_mfma_f32_16x16x32_bf16 v[128:131], a[72:75], a[8:11], v[128:131]
    buffer_load_dwordx4 a[148:151], v244, s[56:59], s60 offen
    s_add_u32 s60, s60, 1024
    v_mfma_f32_16x16x32_bf16 v[132:135], a[72:75], a[24:27], v[132:135]
    v_cvt_pk_bf16_f32 v209, v162, v163
    v_mfma_f32_16x16x32_bf16 v[136:139], a[72:75], a[40:43], v[136:139]
    v_exp_f32 v176, v176
    v_mfma_f32_16x16x32_bf16 v[140:143], a[72:75], a[56:59], v[140:143]
    ds_read_b128 a[72:75], v241 offset:20480
    v_mfma_f32_16x16x32_bf16 v[128:131], a[76:79], a[12:15], v[128:131]
    v_exp_f32 v177, v177
    v_mfma_f32_16x16x32_bf16 v[132:135], a[76:79], a[28:31], v[132:135]
    buffer_load_dwordx4 v244, s[28:31], s47 offen offset:1024 sc1 lds
    v_mfma_f32_16x16x32_bf16 v[136:139], a[76:79], a[44:47], v[136:139]
    v_cvt_pk_bf16_f32 v210, v176, v177
    v_mfma_f32_16x16x32_bf16 v[140:143], a[76:79], a[60:63], v[140:143]
    ds_read_b128 a[76:79], v241 offset:21504
    v_mfma_f32_16x16x32_bf16 v[144:147], a[80:83], a[0:3], v[224:227]
    v_exp_f32 v178, v178
    v_mfma_f32_16x16x32_bf16 v[148:151], a[80:83], a[16:19], v[228:231]
    v_exp_f32 v179, v179
    v_mfma_f32_16x16x32_bf16 v[152:155], a[80:83], a[32:35], v[232:235]
    v_cvt_pk_bf16_f32 v211, v178, v179
    v_mfma_f32_16x16x32_bf16 v[156:159], a[80:83], a[48:51], v[236:239]
    ds_read_b128 a[80:83], v241 offset:24576
    s_add_u32 s41, s45, 241664
    s_waitcnt lgkmcnt(9)
    v_mfma_f32_16x16x32_bf16 v[144:147], a[84:87], a[4:7], v[144:147]
    buffer_store_dwordx4 a[192:195], v244, s[16:19], s41 offen sc1
    v_mfma_f32_16x16x32_bf16 v[148:151], a[84:87], a[20:23], v[148:151]
    v_exp_f32 v164, v164
    v_mfma_f32_16x16x32_bf16 v[152:155], a[84:87], a[36:39], v[152:155]
    v_exp_f32 v165, v165
    v_mfma_f32_16x16x32_bf16 v[156:159], a[84:87], a[52:55], v[156:159]
    ds_read_b128 a[84:87], v241 offset:25600
    v_mfma_f32_16x16x32_bf16 v[144:147], a[88:91], a[8:11], v[144:147]
    v_cvt_pk_bf16_f32 v212, v164, v165
    v_mfma_f32_16x16x32_bf16 v[148:151], a[88:91], a[24:27], v[148:151]
    buffer_load_dwordx4 v244, s[32:35], s47 offen offset:2048 sc1 lds
    v_mfma_f32_16x16x32_bf16 v[152:155], a[88:91], a[40:43], v[152:155]
    v_exp_f32 v166, v166
    v_mfma_f32_16x16x32_bf16 v[156:159], a[88:91], a[56:59], v[156:159]
    ds_read_b128 a[88:91], v241 offset:28672
    v_mfma_f32_16x16x32_bf16 v[144:147], a[92:95], a[12:15], v[144:147]
    v_exp_f32 v167, v167
    v_mfma_f32_16x16x32_bf16 v[148:151], a[92:95], a[28:31], v[148:151]
    v_cvt_pk_bf16_f32 v213, v166, v167
    v_mfma_f32_16x16x32_bf16 v[152:155], a[92:95], a[44:47], v[152:155]
    v_exp_f32 v180, v180
    v_mfma_f32_16x16x32_bf16 v[156:159], a[92:95], a[60:63], v[156:159]
    ds_read_b128 a[92:95], v241 offset:29696
    v_mfma_f32_16x16x32_bf16 v[0:3], a[96:99], v[192:195], v[0:3]
    v_exp_f32 v181, v181
    v_mfma_f32_16x16x32_bf16 v[4:7], a[96:99], v[196:199], v[4:7]
    v_cvt_pk_bf16_f32 v214, v180, v181
    v_mfma_f32_16x16x32_bf16 v[8:11], a[96:99], v[200:203], v[8:11]
    v_exp_f32 v182, v182
    v_mfma_f32_16x16x32_bf16 v[12:15], a[96:99], v[204:207], v[12:15]
    ds_read_b128 a[96:99], v241 offset:18432
    v_mfma_f32_16x16x32_bf16 v[28:31], a[100:103], v[204:207], v[28:31]
    v_exp_f32 v183, v183
    v_mfma_f32_16x16x32_bf16 v[24:27], a[100:103], v[200:203], v[24:27]
    buffer_load_dwordx4 v244, s[32:35], s47 offen offset:3072 sc1 lds
    v_mfma_f32_16x16x32_bf16 v[20:23], a[100:103], v[196:199], v[20:23]
    v_cvt_pk_bf16_f32 v215, v182, v183
    v_mfma_f32_16x16x32_bf16 v[16:19], a[100:103], v[192:195], v[16:19]
    ds_read_b128 a[100:103], v241 offset:19456
    s_add_u32 s47, s47, 8192
    v_mfma_f32_16x16x32_bf16 v[32:35], a[104:107], v[192:195], v[32:35]
    v_exp_f32 v168, v168
    v_mfma_f32_16x16x32_bf16 v[36:39], a[104:107], v[196:199], v[36:39]
    v_exp_f32 v169, v169
    s_add_u32 s48, s48, 16384
    v_mfma_f32_16x16x32_bf16 v[40:43], a[104:107], v[200:203], v[40:43]
    v_cvt_pk_bf16_f32 v216, v168, v169
    v_mfma_f32_16x16x32_bf16 v[44:47], a[104:107], v[204:207], v[44:47]
    ds_read_b128 a[104:107], v241 offset:22528
    s_and_b32 s48, s48, 0x1ffff
    v_mfma_f32_16x16x32_bf16 v[60:63], a[108:111], v[204:207], v[60:63]
    v_exp_f32 v170, v170
    v_mfma_f32_16x16x32_bf16 v[56:59], a[108:111], v[200:203], v[56:59]
    v_exp_f32 v171, v171
    s_add_u32 s41, s46, 237568
    v_mfma_f32_16x16x32_bf16 v[52:55], a[108:111], v[196:199], v[52:55]
    buffer_store_dwordx2 a[196:197], v244, s[16:19], s41 offen sc1
    v_mfma_f32_16x16x32_bf16 v[48:51], a[108:111], v[192:195], v[48:51]
    ds_read_b128 a[108:111], v241 offset:23552
    s_waitcnt lgkmcnt(9)
    v_mfma_f32_16x16x32_bf16 v[64:67], a[112:115], v[192:195], v[64:67]
    v_cvt_pk_bf16_f32 v217, v170, v171
    v_mfma_f32_16x16x32_bf16 v[68:71], a[112:115], v[196:199], v[68:71]
    v_exp_f32 v184, v184
    v_mfma_f32_16x16x32_bf16 v[72:75], a[112:115], v[200:203], v[72:75]
    v_exp_f32 v185, v185
    v_mfma_f32_16x16x32_bf16 v[76:79], a[112:115], v[204:207], v[76:79]
    ds_read_b128 a[112:115], v241 offset:26624
    v_mfma_f32_16x16x32_bf16 v[92:95], a[116:119], v[204:207], v[92:95]
    v_cvt_pk_bf16_f32 v218, v184, v185
    v_mfma_f32_16x16x32_bf16 v[88:91], a[116:119], v[200:203], v[88:91]
    v_exp_f32 v186, v186
    v_mfma_f32_16x16x32_bf16 v[84:87], a[116:119], v[196:199], v[84:87]
    v_exp_f32 v187, v187
    v_mfma_f32_16x16x32_bf16 v[80:83], a[116:119], v[192:195], v[80:83]
    ds_read_b128 a[116:119], v241 offset:27648
    v_mfma_f32_16x16x32_bf16 v[96:99], a[120:123], v[192:195], v[96:99]
    v_cvt_pk_bf16_f32 v219, v186, v187
    v_mfma_f32_16x16x32_bf16 v[100:103], a[120:123], v[196:199], v[100:103]
    v_exp_f32 v172, v172
    v_mfma_f32_16x16x32_bf16 v[104:107], a[120:123], v[200:203], v[104:107]
    v_exp_f32 v173, v173
    v_mfma_f32_16x16x32_bf16 v[108:111], a[120:123], v[204:207], v[108:111]
    ds_read_b128 a[120:123], v241 offset:30720
    v_mfma_f32_16x16x32_bf16 v[124:127], a[124:127], v[204:207], v[124:127]
    v_cvt_pk_bf16_f32 v220, v172, v173
    v_mfma_f32_16x16x32_bf16 v[120:123], a[124:127], v[200:203], v[120:123]
    v_exp_f32 v174, v174
    v_mfma_f32_16x16x32_bf16 v[116:119], a[124:127], v[196:199], v[116:119]
    v_exp_f32 v175, v175
    v_mfma_f32_16x16x32_bf16 v[112:115], a[124:127], v[192:195], v[112:115]
    ds_read_b128 a[124:127], v241 offset:31744
    v_mfma_f32_16x16x32_bf16 a[128:131], a[144:147], v[192:195], a[128:131]
    v_add_u32 v241, 32768, v241
    v_mfma_f32_16x16x32_bf16 a[132:135], a[144:147], v[196:199], a[132:135]
    v_and_b32 v241, 0x1ffff, v241
    v_mfma_f32_16x16x32_bf16 a[136:139], a[144:147], v[200:203], a[136:139]
    v_cvt_pk_bf16_f32 v221, v174, v175
    v_mfma_f32_16x16x32_bf16 a[140:143], a[144:147], v[204:207], a[140:143]
    v_exp_f32 v188, v188
    v_exp_f32 v189, v189
    s_nop 0
    v_cvt_pk_bf16_f32 v222, v188, v189
    v_exp_f32 v190, v190
    v_exp_f32 v191, v191
    s_nop 0
    v_cvt_pk_bf16_f32 v223, v190, v191
    v_mfma_f32_16x16x32_bf16 v[160:163], a[64:67], a[0:3], v[224:227]
    v_exp_f32 v128, v128
    s_mov_b32 m0, s48
    v_mfma_f32_16x16x32_bf16 v[164:167], a[64:67], a[16:19], v[228:231]
    buffer_load_dwordx4 v244, s[28:31], s47 offen sc1 lds
    v_mfma_f32_16x16x32_bf16 v[168:171], a[64:67], a[32:35], v[232:235]
    v_exp_f32 v129, v129
    v_mfma_f32_16x16x32_bf16 v[172:175], a[64:67], a[48:51], v[236:239]
    ds_read_b128 a[64:67], v241 offset:0
    v_mfma_f32_16x16x32_bf16 v[160:163], a[68:71], a[4:7], v[160:163]
    v_cvt_pk_bf16_f32 v192, v128, v129
    v_mfma_f32_16x16x32_bf16 v[164:167], a[68:71], a[20:23], v[164:167]
    v_exp_f32 v130, v130
    v_mfma_f32_16x16x32_bf16 v[168:171], a[68:71], a[36:39], v[168:171]
    v_exp_f32 v131, v131
    v_mfma_f32_16x16x32_bf16 v[172:175], a[68:71], a[52:55], v[172:175]
    ds_read_b128 a[68:71], v241 offset:1024
    v_mfma_f32_16x16x32_bf16 v[160:163], a[72:75], a[8:11], v[160:163]
    buffer_load_dwordx4 a[148:151], v244, s[52:55], s51 offen
    s_add_u32 s51, s51, 1024
    v_mfma_f32_16x16x32_bf16 v[164:167], a[72:75], a[24:27], v[164:167]
    v_cvt_pk_bf16_f32 v193, v130, v131
    v_mfma_f32_16x16x32_bf16 v[168:171], a[72:75], a[40:43], v[168:171]
    v_exp_f32 v144, v144
    v_mfma_f32_16x16x32_bf16 v[172:175], a[72:75], a[56:59], v[172:175]
    ds_read_b128 a[72:75], v241 offset:4096
    s_waitcnt lgkmcnt(9)
    v_mfma_f32_16x16x32_bf16 v[160:163], a[76:79], a[12:15], v[160:163]
    v_exp_f32 v145, v145
    v_mfma_f32_16x16x32_bf16 v[164:167], a[76:79], a[28:31], v[164:167]
    buffer_load_dwordx4 v244, s[28:31], s47 offen offset:1024 sc1 lds
    v_mfma_f32_16x16x32_bf16 v[168:171], a[76:79], a[44:47], v[168:171]
    v_cvt_pk_bf16_f32 v194, v144, v145
    v_mfma_f32_16x16x32_bf16 v[172:175], a[76:79], a[60:63], v[172:175]
    ds_read_b128 a[76:79], v241 offset:5120
    v_mfma_f32_16x16x32_bf16 v[176:179], a[80:83], a[0:3], v[224:227]
    v_exp_f32 v146, v146
    v_mfma_f32_16x16x32_bf16 v[180:183], a[80:83], a[16:19], v[228:231]
    v_exp_f32 v147, v147
    v_mfma_f32_16x16x32_bf16 v[184:187], a[80:83], a[32:35], v[232:235]
    v_cvt_pk_bf16_f32 v195, v146, v147
    v_mfma_f32_16x16x32_bf16 v[188:191], a[80:83], a[48:51], v[236:239]
    ds_read_b128 a[80:83], v241 offset:8192
    s_add_u32 s41, s45, 238592
    v_mfma_f32_16x16x32_bf16 v[176:179], a[84:87], a[4:7], v[176:179]
    buffer_store_dwordx4 a[200:203], v244, s[16:19], s41 offen sc1
    v_mfma_f32_16x16x32_bf16 v[180:183], a[84:87], a[20:23], v[180:183]
    v_exp_f32 v132, v132
    v_mfma_f32_16x16x32_bf16 v[184:187], a[84:87], a[36:39], v[184:187]
    v_exp_f32 v133, v133
    v_mfma_f32_16x16x32_bf16 v[188:191], a[84:87], a[52:55], v[188:191]
    ds_read_b128 a[84:87], v241 offset:9216
    v_mfma_f32_16x16x32_bf16 v[176:179], a[88:91], a[8:11], v[176:179]
    v_cvt_pk_bf16_f32 v196, v132, v133
    v_mfma_f32_16x16x32_bf16 v[180:183], a[88:91], a[24:27], v[180:183]
    buffer_load_dwordx4 v244, s[32:35], s47 offen offset:2048 sc1 lds
    v_mfma_f32_16x16x32_bf16 v[184:187], a[88:91], a[40:43], v[184:187]
    v_exp_f32 v134, v134
    v_mfma_f32_16x16x32_bf16 v[188:191], a[88:91], a[56:59], v[188:191]
    ds_read_b128 a[88:91], v241 offset:12288
    v_mfma_f32_16x16x32_bf16 v[176:179], a[92:95], a[12:15], v[176:179]
    v_exp_f32 v135, v135
    v_mfma_f32_16x16x32_bf16 v[180:183], a[92:95], a[28:31], v[180:183]
    v_cvt_pk_bf16_f32 v197, v134, v135
    v_mfma_f32_16x16x32_bf16 v[184:187], a[92:95], a[44:47], v[184:187]
    v_exp_f32 v148, v148
    v_mfma_f32_16x16x32_bf16 v[188:191], a[92:95], a[60:63], v[188:191]
    ds_read_b128 a[92:95], v241 offset:13312
    v_mfma_f32_16x16x32_bf16 v[0:3], a[96:99], v[208:211], v[0:3]
    v_exp_f32 v149, v149
    v_mfma_f32_16x16x32_bf16 v[4:7], a[96:99], v[212:215], v[4:7]
    v_cvt_pk_bf16_f32 v198, v148, v149
    v_mfma_f32_16x16x32_bf16 v[8:11], a[96:99], v[216:219], v[8:11]
    v_exp_f32 v150, v150
    v_mfma_f32_16x16x32_bf16 v[12:15], a[96:99], v[220:223], v[12:15]
    ds_read_b128 a[96:99], v241 offset:2048
    v_mfma_f32_16x16x32_bf16 v[28:31], a[100:103], v[220:223], v[28:31]
    v_exp_f32 v151, v151
    v_mfma_f32_16x16x32_bf16 v[24:27], a[100:103], v[216:219], v[24:27]
    buffer_load_dwordx4 v244, s[32:35], s47 offen offset:3072 sc1 lds
    v_mfma_f32_16x16x32_bf16 v[20:23], a[100:103], v[212:215], v[20:23]
    v_cvt_pk_bf16_f32 v199, v150, v151
    v_mfma_f32_16x16x32_bf16 v[16:19], a[100:103], v[208:211], v[16:19]
    ds_read_b128 a[100:103], v241 offset:3072
    s_add_u32 s47, s47, 8192
    s_waitcnt lgkmcnt(9)
    v_mfma_f32_16x16x32_bf16 v[32:35], a[104:107], v[208:211], v[32:35]
    v_exp_f32 v136, v136
    v_mfma_f32_16x16x32_bf16 v[36:39], a[104:107], v[212:215], v[36:39]
    v_exp_f32 v137, v137
    s_add_u32 s48, s48, 16384
    v_mfma_f32_16x16x32_bf16 v[40:43], a[104:107], v[216:219], v[40:43]
    v_cvt_pk_bf16_f32 v200, v136, v137
    v_mfma_f32_16x16x32_bf16 v[44:47], a[104:107], v[220:223], v[44:47]
    ds_read_b128 a[104:107], v241 offset:6144
    s_and_b32 s48, s48, 0x1ffff
    v_mfma_f32_16x16x32_bf16 v[60:63], a[108:111], v[220:223], v[60:63]
    v_exp_f32 v138, v138
    v_mfma_f32_16x16x32_bf16 v[56:59], a[108:111], v[216:219], v[56:59]
    v_exp_f32 v139, v139
    s_add_u32 s41, s45, 240640
    v_mfma_f32_16x16x32_bf16 v[52:55], a[108:111], v[212:215], v[52:55]
    buffer_store_dwordx4 a[204:207], v244, s[16:19], s41 offen sc1
    v_mfma_f32_16x16x32_bf16 v[48:51], a[108:111], v[208:211], v[48:51]
    ds_read_b128 a[108:111], v241 offset:7168
    v_mfma_f32_16x16x32_bf16 v[64:67], a[112:115], v[208:211], v[64:67]
    v_cvt_pk_bf16_f32 v201, v138, v139
    v_mfma_f32_16x16x32_bf16 v[68:71], a[112:115], v[212:215], v[68:71]
    v_exp_f32 v152, v152
    v_mfma_f32_16x16x32_bf16 v[72:75], a[112:115], v[216:219], v[72:75]
    v_exp_f32 v153, v153
    v_mfma_f32_16x16x32_bf16 v[76:79], a[112:115], v[220:223], v[76:79]
    ds_read_b128 a[112:115], v241 offset:10240
    v_mfma_f32_16x16x32_bf16 v[92:95], a[116:119], v[220:223], v[92:95]
    v_cvt_pk_bf16_f32 v202, v152, v153
    v_mfma_f32_16x16x32_bf16 v[88:91], a[116:119], v[216:219], v[88:91]
    v_exp_f32 v154, v154
    v_mfma_f32_16x16x32_bf16 v[84:87], a[116:119], v[212:215], v[84:87]
    v_exp_f32 v155, v155
    v_mfma_f32_16x16x32_bf16 v[80:83], a[116:119], v[208:211], v[80:83]
    ds_read_b128 a[116:119], v241 offset:11264
    v_mfma_f32_16x16x32_bf16 v[96:99], a[120:123], v[208:211], v[96:99]
    v_cvt_pk_bf16_f32 v203, v154, v155
    v_mfma_f32_16x16x32_bf16 v[100:103], a[120:123], v[212:215], v[100:103]
    v_exp_f32 v140, v140
    v_mfma_f32_16x16x32_bf16 v[104:107], a[120:123], v[216:219], v[104:107]
    v_exp_f32 v141, v141
    v_mfma_f32_16x16x32_bf16 v[108:111], a[120:123], v[220:223], v[108:111]
    ds_read_b128 a[120:123], v241 offset:14336
    v_mfma_f32_16x16x32_bf16 v[124:127], a[124:127], v[220:223], v[124:127]
    v_cvt_pk_bf16_f32 v204, v140, v141
    v_mfma_f32_16x16x32_bf16 v[120:123], a[124:127], v[216:219], v[120:123]
    v_exp_f32 v142, v142
    v_mfma_f32_16x16x32_bf16 v[116:119], a[124:127], v[212:215], v[116:119]
    v_exp_f32 v143, v143
    v_mfma_f32_16x16x32_bf16 v[112:115], a[124:127], v[208:211], v[112:115]
    ds_read_b128 a[124:127], v241 offset:15360
    v_mfma_f32_16x16x32_bf16 a[128:131], a[144:147], v[208:211], a[128:131]
    v_cvt_pk_bf16_f32 v205, v142, v143
    v_mfma_f32_16x16x32_bf16 a[132:135], a[144:147], v[212:215], a[132:135]
    v_exp_f32 v156, v156
    v_mfma_f32_16x16x32_bf16 a[136:139], a[144:147], v[216:219], a[136:139]
    v_exp_f32 v157, v157
    v_mfma_f32_16x16x32_bf16 a[140:143], a[144:147], v[220:223], a[140:143]
    v_cvt_pk_bf16_f32 v206, v156, v157
    v_exp_f32 v158, v158
    v_exp_f32 v159, v159
    s_nop 0
    v_cvt_pk_bf16_f32 v207, v158, v159
    s_waitcnt vmcnt(21)
    s_barrier
    v_mfma_f32_16x16x32_bf16 v[128:131], a[64:67], a[0:3], v[224:227]
    v_exp_f32 v160, v160
    s_mov_b32 m0, s48
    v_mfma_f32_16x16x32_bf16 v[132:135], a[64:67], a[16:19], v[228:231]
    buffer_load_dwordx4 v244, s[28:31], s47 offen sc1 lds
    v_mfma_f32_16x16x32_bf16 v[136:139], a[64:67], a[32:35], v[232:235]
    v_exp_f32 v161, v161
    v_mfma_f32_16x16x32_bf16 v[140:143], a[64:67], a[48:51], v[236:239]
    ds_read_b128 a[64:67], v241 offset:16384
    s_waitcnt lgkmcnt(9)
    v_mfma_f32_16x16x32_bf16 v[128:131], a[68:71], a[4:7], v[128:131]
    v_cvt_pk_bf16_f32 v208, v160, v161
    v_mfma_f32_16x16x32_bf16 v[132:135], a[68:71], a[20:23], v[132:135]
    v_exp_f32 v162, v162
    v_mfma_f32_16x16x32_bf16 v[136:139], a[68:71], a[36:39], v[136:139]
    v_exp_f32 v163, v163
    v_mfma_f32_16x16x32_bf16 v[140:143], a[68:71], a[52:55], v[140:143]
    ds_read_b128 a[68:71], v241 offset:17408
    v_mfma_f32_16x16x32_bf16 v[128:131], a[72:75], a[8:11], v[128:131]
    buffer_load_dwordx4 a[148:151], v244, s[56:59], s60 offen
    s_add_u32 s60, s60, 1024
    v_mfma_f32_16x16x32_bf16 v[132:135], a[72:75], a[24:27], v[132:135]
    v_cvt_pk_bf16_f32 v209, v162, v163
    v_mfma_f32_16x16x32_bf16 v[136:139], a[72:75], a[40:43], v[136:139]
    v_exp_f32 v176, v176
    v_mfma_f32_16x16x32_bf16 v[140:143], a[72:75], a[56:59], v[140:143]
    ds_read_b128 a[72:75], v241 offset:20480
    v_mfma_f32_16x16x32_bf16 v[128:131], a[76:79], a[12:15], v[128:131]
    v_exp_f32 v177, v177
    v_mfma_f32_16x16x32_bf16 v[132:135], a[76:79], a[28:31], v[132:135]
    buffer_load_dwordx4 v244, s[28:31], s47 offen offset:1024 sc1 lds
    v_mfma_f32_16x16x32_bf16 v[136:139], a[76:79], a[44:47], v[136:139]
    v_cvt_pk_bf16_f32 v210, v176, v177
    v_mfma_f32_16x16x32_bf16 v[140:143], a[76:79], a[60:63], v[140:143]
    ds_read_b128 a[76:79], v241 offset:21504
    v_mfma_f32_16x16x32_bf16 v[144:147], a[80:83], a[0:3], v[224:227]
    v_exp_f32 v178, v178
    v_mfma_f32_16x16x32_bf16 v[148:151], a[80:83], a[16:19], v[228:231]
    v_exp_f32 v179, v179
    v_mfma_f32_16x16x32_bf16 v[152:155], a[80:83], a[32:35], v[232:235]
    v_cvt_pk_bf16_f32 v211, v178, v179
    v_mfma_f32_16x16x32_bf16 v[156:159], a[80:83], a[48:51], v[236:239]
    ds_read_b128 a[80:83], v241 offset:24576
    s_add_u32 s41, s45, 242688
    v_mfma_f32_16x16x32_bf16 v[144:147], a[84:87], a[4:7], v[144:147]
    buffer_store_dwordx4 a[208:211], v244, s[16:19], s41 offen sc1
    v_mfma_f32_16x16x32_bf16 v[148:151], a[84:87], a[20:23], v[148:151]
    v_exp_f32 v164, v164
    v_mfma_f32_16x16x32_bf16 v[152:155], a[84:87], a[36:39], v[152:155]
    v_exp_f32 v165, v165
    v_mfma_f32_16x16x32_bf16 v[156:159], a[84:87], a[52:55], v[156:159]
    ds_read_b128 a[84:87], v241 offset:25600
    v_mfma_f32_16x16x32_bf16 v[144:147], a[88:91], a[8:11], v[144:147]
    v_cvt_pk_bf16_f32 v212, v164, v165
    v_mfma_f32_16x16x32_bf16 v[148:151], a[88:91], a[24:27], v[148:151]
    buffer_load_dwordx4 v244, s[32:35], s47 offen offset:2048 sc1 lds
    v_mfma_f32_16x16x32_bf16 v[152:155], a[88:91], a[40:43], v[152:155]
    v_exp_f32 v166, v166
    v_mfma_f32_16x16x32_bf16 v[156:159], a[88:91], a[56:59], v[156:159]
    ds_read_b128 a[88:91], v241 offset:28672
    v_mfma_f32_16x16x32_bf16 v[144:147], a[92:95], a[12:15], v[144:147]
    v_exp_f32 v167, v167
    v_mfma_f32_16x16x32_bf16 v[148:151], a[92:95], a[28:31], v[148:151]
    v_cvt_pk_bf16_f32 v213, v166, v167
    v_mfma_f32_16x16x32_bf16 v[152:155], a[92:95], a[44:47], v[152:155]
    v_exp_f32 v180, v180
    v_mfma_f32_16x16x32_bf16 v[156:159], a[92:95], a[60:63], v[156:159]
    ds_read_b128 a[92:95], v241 offset:29696
    s_waitcnt lgkmcnt(9)
    v_mfma_f32_16x16x32_bf16 v[0:3], a[96:99], v[192:195], v[0:3]
    v_exp_f32 v181, v181
    v_mfma_f32_16x16x32_bf16 v[4:7], a[96:99], v[196:199], v[4:7]
    v_cvt_pk_bf16_f32 v214, v180, v181
    v_mfma_f32_16x16x32_bf16 v[8:11], a[96:99], v[200:203], v[8:11]
    v_exp_f32 v182, v182
    v_mfma_f32_16x16x32_bf16 v[12:15], a[96:99], v[204:207], v[12:15]
    ds_read_b128 a[96:99], v241 offset:18432
    v_mfma_f32_16x16x32_bf16 v[28:31], a[100:103], v[204:207], v[28:31]
    v_exp_f32 v183, v183
    v_mfma_f32_16x16x32_bf16 v[24:27], a[100:103], v[200:203], v[24:27]
    buffer_load_dwordx4 v244, s[32:35], s47 offen offset:3072 sc1 lds
    v_mfma_f32_16x16x32_bf16 v[20:23], a[100:103], v[196:199], v[20:23]
    v_cvt_pk_bf16_f32 v215, v182, v183
    v_mfma_f32_16x16x32_bf16 v[16:19], a[100:103], v[192:195], v[16:19]
    ds_read_b128 a[100:103], v241 offset:19456
    s_add_u32 s47, s47, 8192
    v_mfma_f32_16x16x32_bf16 v[32:35], a[104:107], v[192:195], v[32:35]
    v_exp_f32 v168, v168
    v_mfma_f32_16x16x32_bf16 v[36:39], a[104:107], v[196:199], v[36:39]
    v_exp_f32 v169, v169
    s_add_u32 s48, s48, 16384
    v_mfma_f32_16x16x32_bf16 v[40:43], a[104:107], v[200:203], v[40:43]
    v_cvt_pk_bf16_f32 v216, v168, v169
    v_mfma_f32_16x16x32_bf16 v[44:47], a[104:107], v[204:207], v[44:47]
    ds_read_b128 a[104:107], v241 offset:22528
    s_and_b32 s48, s48, 0x1ffff
    v_mfma_f32_16x16x32_bf16 v[60:63], a[108:111], v[204:207], v[60:63]
    v_exp_f32 v170, v170
    v_mfma_f32_16x16x32_bf16 v[56:59], a[108:111], v[200:203], v[56:59]
    v_exp_f32 v171, v171
    s_add_u32 s41, s46, 238592
    v_mfma_f32_16x16x32_bf16 v[52:55], a[108:111], v[196:199], v[52:55]
    buffer_store_dwordx2 a[212:213], v244, s[16:19], s41 offen sc1
    v_mfma_f32_16x16x32_bf16 v[48:51], a[108:111], v[192:195], v[48:51]
    ds_read_b128 a[108:111], v241 offset:23552
    v_mfma_f32_16x16x32_bf16 v[64:67], a[112:115], v[192:195], v[64:67]
    v_cvt_pk_bf16_f32 v217, v170, v171
    v_mfma_f32_16x16x32_bf16 v[68:71], a[112:115], v[196:199], v[68:71]
    v_exp_f32 v184, v184
    v_mfma_f32_16x16x32_bf16 v[72:75], a[112:115], v[200:203], v[72:75]
    v_exp_f32 v185, v185
    v_mfma_f32_16x16x32_bf16 v[76:79], a[112:115], v[204:207], v[76:79]
    ds_read_b128 a[112:115], v241 offset:26624
    v_mfma_f32_16x16x32_bf16 v[92:95], a[116:119], v[204:207], v[92:95]
    v_cvt_pk_bf16_f32 v218, v184, v185
    v_mfma_f32_16x16x32_bf16 v[88:91], a[116:119], v[200:203], v[88:91]
    v_exp_f32 v186, v186
    v_mfma_f32_16x16x32_bf16 v[84:87], a[116:119], v[196:199], v[84:87]
    v_exp_f32 v187, v187
    v_mfma_f32_16x16x32_bf16 v[80:83], a[116:119], v[192:195], v[80:83]
    ds_read_b128 a[116:119], v241 offset:27648
    v_mfma_f32_16x16x32_bf16 v[96:99], a[120:123], v[192:195], v[96:99]
    v_cvt_pk_bf16_f32 v219, v186, v187
    v_mfma_f32_16x16x32_bf16 v[100:103], a[120:123], v[196:199], v[100:103]
    v_exp_f32 v172, v172
    v_mfma_f32_16x16x32_bf16 v[104:107], a[120:123], v[200:203], v[104:107]
    v_exp_f32 v173, v173
    v_mfma_f32_16x16x32_bf16 v[108:111], a[120:123], v[204:207], v[108:111]
    ds_read_b128 a[120:123], v241 offset:30720
    s_waitcnt lgkmcnt(9)
    v_mfma_f32_16x16x32_bf16 v[124:127], a[124:127], v[204:207], v[124:127]
    v_cvt_pk_bf16_f32 v220, v172, v173
    v_mfma_f32_16x16x32_bf16 v[120:123], a[124:127], v[200:203], v[120:123]
    v_exp_f32 v174, v174
    v_mfma_f32_16x16x32_bf16 v[116:119], a[124:127], v[196:199], v[116:119]
    v_exp_f32 v175, v175
    v_mfma_f32_16x16x32_bf16 v[112:115], a[124:127], v[192:195], v[112:115]
    ds_read_b128 a[124:127], v241 offset:31744
    v_mfma_f32_16x16x32_bf16 a[128:131], a[144:147], v[192:195], a[128:131]
    v_add_u32 v241, 32768, v241
    v_mfma_f32_16x16x32_bf16 a[132:135], a[144:147], v[196:199], a[132:135]
    v_and_b32 v241, 0x1ffff, v241
    v_mfma_f32_16x16x32_bf16 a[136:139], a[144:147], v[200:203], a[136:139]
    v_cvt_pk_bf16_f32 v221, v174, v175
    v_mfma_f32_16x16x32_bf16 a[140:143], a[144:147], v[204:207], a[140:143]
    v_exp_f32 v188, v188
    v_exp_f32 v189, v189
    s_nop 0
    v_cvt_pk_bf16_f32 v222, v188, v189
    v_exp_f32 v190, v190
    v_exp_f32 v191, v191
    s_nop 0
    v_cvt_pk_bf16_f32 v223, v190, v191
    v_mfma_f32_16x16x32_bf16 v[160:163], a[64:67], a[0:3], v[224:227]
    v_exp_f32 v128, v128
    s_mov_b32 m0, s48
    v_mfma_f32_16x16x32_bf16 v[164:167], a[64:67], a[16:19], v[228:231]
    buffer_load_dwordx4 v244, s[28:31], s47 offen sc1 lds
    v_mfma_f32_16x16x32_bf16 v[168:171], a[64:67], a[32:35], v[232:235]
    v_exp_f32 v129, v129
    v_mfma_f32_16x16x32_bf16 v[172:175], a[64:67], a[48:51], v[236:239]
    ds_read_b128 a[64:67], v241 offset:0
    v_mfma_f32_16x16x32_bf16 v[160:163], a[68:71], a[4:7], v[160:163]
    v_cvt_pk_bf16_f32 v192, v128, v129
    v_mfma_f32_16x16x32_bf16 v[164:167], a[68:71], a[20:23], v[164:167]
    v_exp_f32 v130, v130
    v_mfma_f32_16x16x32_bf16 v[168:171], a[68:71], a[36:39], v[168:171]
    v_exp_f32 v131, v131
    v_mfma_f32_16x16x32_bf16 v[172:175], a[68:71], a[52:55], v[172:175]
    ds_read_b128 a[68:71], v241 offset:1024
    v_mfma_f32_16x16x32_bf16 v[160:163], a[72:75], a[8:11], v[160:163]
    buffer_load_dwordx4 a[148:151], v244, s[52:55], s51 offen
    s_add_u32 s51, s51, 1024
    v_mfma_f32_16x16x32_bf16 v[164:167], a[72:75], a[24:27], v[164:167]
    v_cvt_pk_bf16_f32 v193, v130, v131
    v_mfma_f32_16x16x32_bf16 v[168:171], a[72:75], a[40:43], v[168:171]
    v_exp_f32 v144, v144
    v_mfma_f32_16x16x32_bf16 v[172:175], a[72:75], a[56:59], v[172:175]
    ds_read_b128 a[72:75], v241 offset:4096
    v_mfma_f32_16x16x32_bf16 v[160:163], a[76:79], a[12:15], v[160:163]
    v_exp_f32 v145, v145
    v_mfma_f32_16x16x32_bf16 v[164:167], a[76:79], a[28:31], v[164:167]
    buffer_load_dwordx4 v244, s[28:31], s47 offen offset:1024 sc1 lds
    v_mfma_f32_16x16x32_bf16 v[168:171], a[76:79], a[44:47], v[168:171]
    v_cvt_pk_bf16_f32 v194, v144, v145
    v_mfma_f32_16x16x32_bf16 v[172:175], a[76:79], a[60:63], v[172:175]
    ds_read_b128 a[76:79], v241 offset:5120
    v_mfma_f32_16x16x32_bf16 v[176:179], a[80:83], a[0:3], v[224:227]
    v_exp_f32 v146, v146
    v_mfma_f32_16x16x32_bf16 v[180:183], a[80:83], a[16:19], v[228:231]
    v_exp_f32 v147, v147
    v_mfma_f32_16x16x32_bf16 v[184:187], a[80:83], a[32:35], v[232:235]
    v_cvt_pk_bf16_f32 v195, v146, v147
    v_mfma_f32_16x16x32_bf16 v[188:191], a[80:83], a[48:51], v[236:239]
    ds_read_b128 a[80:83], v241 offset:8192
    v_mfma_f32_16x16x32_bf16 v[176:179], a[84:87], a[4:7], v[176:179]
    v_exp_f32 v132, v132
    v_mfma_f32_16x16x32_bf16 v[180:183], a[84:87], a[20:23], v[180:183]
    v_exp_f32 v133, v133
    v_mfma_f32_16x16x32_bf16 v[184:187], a[84:87], a[36:39], v[184:187]
    v_cvt_pk_bf16_f32 v196, v132, v133
    v_mfma_f32_16x16x32_bf16 v[188:191], a[84:87], a[52:55], v[188:191]
    ds_read_b128 a[84:87], v241 offset:9216
    s_waitcnt lgkmcnt(9)
    v_mfma_f32_16x16x32_bf16 v[176:179], a[88:91], a[8:11], v[176:179]
    v_exp_f32 v134, v134
    v_mfma_f32_16x16x32_bf16 v[180:183], a[88:91], a[24:27], v[180:183]
    buffer_load_dwordx4 v244, s[32:35], s47 offen offset:2048 sc1 lds
    v_mfma_f32_16x16x32_bf16 v[184:187], a[88:91], a[40:43], v[184:187]
    v_exp_f32 v135, v135
    v_mfma_f32_16x16x32_bf16 v[188:191], a[88:91], a[56:59], v[188:191]
    ds_read_b128 a[88:91], v241 offset:12288
    v_mfma_f32_16x16x32_bf16 v[176:179], a[92:95], a[12:15], v[176:179]
    v_cvt_pk_bf16_f32 v197, v134, v135
    v_mfma_f32_16x16x32_bf16 v[180:183], a[92:95], a[28:31], v[180:183]
    v_exp_f32 v148, v148
    v_mfma_f32_16x16x32_bf16 v[184:187], a[92:95], a[44:47], v[184:187]
    v_exp_f32 v149, v149
    v_mfma_f32_16x16x32_bf16 v[188:191], a[92:95], a[60:63], v[188:191]
    ds_read_b128 a[92:95], v241 offset:13312
    v_mfma_f32_16x16x32_bf16 v[0:3], a[96:99], v[208:211], v[0:3]
    v_cvt_pk_bf16_f32 v198, v148, v149
    v_mfma_f32_16x16x32_bf16 v[4:7], a[96:99], v[212:215], v[4:7]
    v_exp_f32 v150, v150
    v_mfma_f32_16x16x32_bf16 v[8:11], a[96:99], v[216:219], v[8:11]
    v_exp_f32 v151, v151
    v_mfma_f32_16x16x32_bf16 v[12:15], a[96:99], v[220:223], v[12:15]
    ds_read_b128 a[96:99], v241 offset:2048
    v_mfma_f32_16x16x32_bf16 v[28:31], a[100:103], v[220:223], v[28:31]
    v_cvt_pk_bf16_f32 v199, v150, v151
    v_mfma_f32_16x16x32_bf16 v[24:27], a[100:103], v[216:219], v[24:27]
    buffer_load_dwordx4 v244, s[32:35], s47 offen offset:3072 sc1 lds
    v_mfma_f32_16x16x32_bf16 v[20:23], a[100:103], v[212:215], v[20:23]
    v_exp_f32 v136, v136
    v_mfma_f32_16x16x32_bf16 v[16:19], a[100:103], v[208:211], v[16:19]
    ds_read_b128 a[100:103], v241 offset:3072
    s_add_u32 s47, s47, 8192
    v_mfma_f32_16x16x32_bf16 v[32:35], a[104:107], v[208:211], v[32:35]
    v_exp_f32 v137, v137
    v_mfma_f32_16x16x32_bf16 v[36:39], a[104:107], v[212:215], v[36:39]
    v_cvt_pk_bf16_f32 v200, v136, v137
    s_add_u32 s48, s48, 16384
    v_mfma_f32_16x16x32_bf16 v[40:43], a[104:107], v[216:219], v[40:43]
    v_exp_f32 v138, v138
    v_mfma_f32_16x16x32_bf16 v[44:47], a[104:107], v[220:223], v[44:47]
    ds_read_b128 a[104:107], v241 offset:6144
    s_and_b32 s48, s48, 0x1ffff
    v_mfma_f32_16x16x32_bf16 v[60:63], a[108:111], v[220:223], v[60:63]
    v_exp_f32 v139, v139
    v_mfma_f32_16x16x32_bf16 v[56:59], a[108:111], v[216:219], v[56:59]
    v_cvt_pk_bf16_f32 v201, v138, v139
    v_mfma_f32_16x16x32_bf16 v[52:55], a[108:111], v[212:215], v[52:55]
    v_exp_f32 v152, v152
    v_mfma_f32_16x16x32_bf16 v[48:51], a[108:111], v[208:211], v[48:51]
    ds_read_b128 a[108:111], v241 offset:7168
    v_mfma_f32_16x16x32_bf16 v[64:67], a[112:115], v[208:211], v[64:67]
    v_exp_f32 v153, v153
    v_mfma_f32_16x16x32_bf16 v[68:71], a[112:115], v[212:215], v[68:71]
    v_cvt_pk_bf16_f32 v202, v152, v153
    v_mfma_f32_16x16x32_bf16 v[72:75], a[112:115], v[216:219], v[72:75]
    v_exp_f32 v154, v154
    v_mfma_f32_16x16x32_bf16 v[76:79], a[112:115], v[220:223], v[76:79]
    ds_read_b128 a[112:115], v241 offset:10240
    s_waitcnt lgkmcnt(9)
    v_mfma_f32_16x16x32_bf16 v[92:95], a[116:119], v[220:223], v[92:95]
    v_exp_f32 v155, v155
    v_mfma_f32_16x16x32_bf16 v[88:91], a[116:119], v[216:219], v[88:91]
    v_cvt_pk_bf16_f32 v203, v154, v155
    v_mfma_f32_16x16x32_bf16 v[84:87], a[116:119], v[212:215], v[84:87]
    v_exp_f32 v140, v140
    v_mfma_f32_16x16x32_bf16 v[80:83], a[116:119], v[208:211], v[80:83]
    ds_read_b128 a[116:119], v241 offset:11264
    v_mfma_f32_16x16x32_bf16 v[96:99], a[120:123], v[208:211], v[96:99]
    v_exp_f32 v141, v141
    v_mfma_f32_16x16x32_bf16 v[100:103], a[120:123], v[212:215], v[100:103]
    v_cvt_pk_bf16_f32 v204, v140, v141
    v_mfma_f32_16x16x32_bf16 v[104:107], a[120:123], v[216:219], v[104:107]
    v_exp_f32 v142, v142
    v_mfma_f32_16x16x32_bf16 v[108:111], a[120:123], v[220:223], v[108:111]
    ds_read_b128 a[120:123], v241 offset:14336
    v_mfma_f32_16x16x32_bf16 v[124:127], a[124:127], v[220:223], v[124:127]
    v_exp_f32 v143, v143
    v_mfma_f32_16x16x32_bf16 v[120:123], a[124:127], v[216:219], v[120:123]
    v_cvt_pk_bf16_f32 v205, v142, v143
    v_mfma_f32_16x16x32_bf16 v[116:119], a[124:127], v[212:215], v[116:119]
    v_exp_f32 v156, v156
    v_mfma_f32_16x16x32_bf16 v[112:115], a[124:127], v[208:211], v[112:115]
    ds_read_b128 a[124:127], v241 offset:15360
    v_mfma_f32_16x16x32_bf16 a[128:131], a[144:147], v[208:211], a[128:131]
    v_exp_f32 v157, v157
    v_mfma_f32_16x16x32_bf16 a[132:135], a[144:147], v[212:215], a[132:135]
    v_cvt_pk_bf16_f32 v206, v156, v157
    v_mfma_f32_16x16x32_bf16 a[136:139], a[144:147], v[216:219], a[136:139]
    v_exp_f32 v158, v158
    v_mfma_f32_16x16x32_bf16 a[140:143], a[144:147], v[220:223], a[140:143]
    v_exp_f32 v159, v159
    s_nop 0
    v_cvt_pk_bf16_f32 v207, v158, v159
    s_waitcnt vmcnt(19)
    s_barrier
    v_mfma_f32_16x16x32_bf16 v[128:131], a[64:67], a[0:3], v[224:227]
    v_exp_f32 v160, v160
    s_mov_b32 m0, s48
    v_mfma_f32_16x16x32_bf16 v[132:135], a[64:67], a[16:19], v[228:231]
    buffer_load_dwordx4 v244, s[28:31], s47 offen sc1 lds
    v_mfma_f32_16x16x32_bf16 v[136:139], a[64:67], a[32:35], v[232:235]
    v_exp_f32 v161, v161
    v_mfma_f32_16x16x32_bf16 v[140:143], a[64:67], a[48:51], v[236:239]
    ds_read_b128 a[64:67], v241 offset:16384
    v_mfma_f32_16x16x32_bf16 v[128:131], a[68:71], a[4:7], v[128:131]
    v_cvt_pk_bf16_f32 v208, v160, v161
    v_mfma_f32_16x16x32_bf16 v[132:135], a[68:71], a[20:23], v[132:135]
    v_exp_f32 v162, v162
    v_mfma_f32_16x16x32_bf16 v[136:139], a[68:71], a[36:39], v[136:139]
    v_exp_f32 v163, v163
    v_mfma_f32_16x16x32_bf16 v[140:143], a[68:71], a[52:55], v[140:143]
    ds_read_b128 a[68:71], v241 offset:17408
    v_mfma_f32_16x16x32_bf16 v[128:131], a[72:75], a[8:11], v[128:131]
    buffer_load_dwordx4 a[148:151], v244, s[56:59], s60 offen
    s_add_u32 s60, s60, 1024
    v_mfma_f32_16x16x32_bf16 v[132:135], a[72:75], a[24:27], v[132:135]
    v_cvt_pk_bf16_f32 v209, v162, v163
    v_mfma_f32_16x16x32_bf16 v[136:139], a[72:75], a[40:43], v[136:139]
    v_exp_f32 v176, v176
    v_mfma_f32_16x16x32_bf16 v[140:143], a[72:75], a[56:59], v[140:143]
    ds_read_b128 a[72:75], v241 offset:20480
    v_mfma_f32_16x16x32_bf16 v[128:131], a[76:79], a[12:15], v[128:131]
    v_exp_f32 v177, v177
    v_mfma_f32_16x16x32_bf16 v[132:135], a[76:79], a[28:31], v[132:135]
    buffer_load_dwordx4 v244, s[28:31], s47 offen offset:1024 sc1 lds
    v_mfma_f32_16x16x32_bf16 v[136:139], a[76:79], a[44:47], v[136:139]
    v_cvt_pk_bf16_f32 v210, v176, v177
    v_mfma_f32_16x16x32_bf16 v[140:143], a[76:79], a[60:63], v[140:143]
    ds_read_b128 a[76:79], v241 offset:21504
    s_waitcnt lgkmcnt(9)
    v_mfma_f32_16x16x32_bf16 v[144:147], a[80:83], a[0:3], v[224:227]
    v_exp_f32 v178, v178
    v_mfma_f32_16x16x32_bf16 v[148:151], a[80:83], a[16:19], v[228:231]
    v_exp_f32 v179, v179
    v_mfma_f32_16x16x32_bf16 v[152:155], a[80:83], a[32:35], v[232:235]
    v_cvt_pk_bf16_f32 v211, v178, v179
    v_mfma_f32_16x16x32_bf16 v[156:159], a[80:83], a[48:51], v[236:239]
    ds_read_b128 a[80:83], v241 offset:24576
    v_mfma_f32_16x16x32_bf16 v[144:147], a[84:87], a[4:7], v[144:147]
    v_exp_f32 v164, v164
    v_mfma_f32_16x16x32_bf16 v[148:151], a[84:87], a[20:23], v[148:151]
    v_exp_f32 v165, v165
    v_mfma_f32_16x16x32_bf16 v[152:155], a[84:87], a[36:39], v[152:155]
    v_cvt_pk_bf16_f32 v212, v164, v165
    v_mfma_f32_16x16x32_bf16 v[156:159], a[84:87], a[52:55], v[156:159]
    ds_read_b128 a[84:87], v241 offset:25600
    v_mfma_f32_16x16x32_bf16 v[144:147], a[88:91], a[8:11], v[144:147]
    v_exp_f32 v166, v166
    v_mfma_f32_16x16x32_bf16 v[148:151], a[88:91], a[24:27], v[148:151]
    buffer_load_dwordx4 v244, s[32:35], s47 offen offset:2048 sc1 lds
    v_mfma_f32_16x16x32_bf16 v[152:155], a[88:91], a[40:43], v[152:155]
    v_exp_f32 v167, v167
    v_mfma_f32_16x16x32_bf16 v[156:159], a[88:91], a[56:59], v[156:159]
    ds_read_b128 a[88:91], v241 offset:28672
    v_mfma_f32_16x16x32_bf16 v[144:147], a[92:95], a[12:15], v[144:147]
    v_cvt_pk_bf16_f32 v213, v166, v167
    v_mfma_f32_16x16x32_bf16 v[148:151], a[92:95], a[28:31], v[148:151]
    v_exp_f32 v180, v180
    v_mfma_f32_16x16x32_bf16 v[152:155], a[92:95], a[44:47], v[152:155]
    v_exp_f32 v181, v181
    v_mfma_f32_16x16x32_bf16 v[156:159], a[92:95], a[60:63], v[156:159]
    ds_read_b128 a[92:95], v241 offset:29696
    v_mfma_f32_16x16x32_bf16 v[0:3], a[96:99], v[192:195], v[0:3]
    v_cvt_pk_bf16_f32 v214, v180, v181
    v_mfma_f32_16x16x32_bf16 v[4:7], a[96:99], v[196:199], v[4:7]
    v_exp_f32 v182, v182
    v_mfma_f32_16x16x32_bf16 v[8:11], a[96:99], v[200:203], v[8:11]
    v_exp_f32 v183, v183
    v_mfma_f32_16x16x32_bf16 v[12:15], a[96:99], v[204:207], v[12:15]
    ds_read_b128 a[96:99], v241 offset:18432
    v_mfma_f32_16x16x32_bf16 v[28:31], a[100:103], v[204:207], v[28:31]
    v_cvt_pk_bf16_f32 v215, v182, v183
    v_mfma_f32_16x16x32_bf16 v[24:27], a[100:103], v[200:203], v[24:27]
    buffer_load_dwordx4 v244, s[32:35], s47 offen offset:3072 sc1 lds
    v_mfma_f32_16x16x32_bf16 v[20:23], a[100:103], v[196:199], v[20:23]
    v_exp_f32 v168, v168
    v_mfma_f32_16x16x32_bf16 v[16:19], a[100:103], v[192:195], v[16:19]
    ds_read_b128 a[100:103], v241 offset:19456
    s_add_u32 s47, s47, 8192
    v_mfma_f32_16x16x32_bf16 v[32:35], a[104:107], v[192:195], v[32:35]
    v_exp_f32 v169, v169
    v_mfma_f32_16x16x32_bf16 v[36:39], a[104:107], v[196:199], v[36:39]
    v_cvt_pk_bf16_f32 v216, v168, v169
    s_add_u32 s48, s48, 16384
    v_mfma_f32_16x16x32_bf16 v[40:43], a[104:107], v[200:203], v[40:43]
    v_exp_f32 v170, v170
    v_mfma_f32_16x16x32_bf16 v[44:47], a[104:107], v[204:207], v[44:47]
    ds_read_b128 a[104:107], v241 offset:22528
    s_and_b32 s48, s48, 0x1ffff
    s_waitcnt lgkmcnt(9)
    v_mfma_f32_16x16x32_bf16 v[60:63], a[108:111], v[204:207], v[60:63]
    v_exp_f32 v171, v171
    v_mfma_f32_16x16x32_bf16 v[56:59], a[108:111], v[200:203], v[56:59]
    v_cvt_pk_bf16_f32 v217, v170, v171
    v_mfma_f32_16x16x32_bf16 v[52:55], a[108:111], v[196:199], v[52:55]
    v_exp_f32 v184, v184
    v_mfma_f32_16x16x32_bf16 v[48:51], a[108:111], v[192:195], v[48:51]
    ds_read_b128 a[108:111], v241 offset:23552
    v_mfma_f32_16x16x32_bf16 v[64:67], a[112:115], v[192:195], v[64:67]
    v_exp_f32 v185, v185
    v_mfma_f32_16x16x32_bf16 v[68:71], a[112:115], v[196:199], v[68:71]
    v_cvt_pk_bf16_f32 v218, v184, v185
    v_mfma_f32_16x16x32_bf16 v[72:75], a[112:115], v[200:203], v[72:75]
    v_exp_f32 v186, v186
    v_mfma_f32_16x16x32_bf16 v[76:79], a[112:115], v[204:207], v[76:79]
    ds_read_b128 a[112:115], v241 offset:26624
    v_mfma_f32_16x16x32_bf16 v[92:95], a[116:119], v[204:207], v[92:95]
    v_exp_f32 v187, v187
    v_mfma_f32_16x16x32_bf16 v[88:91], a[116:119], v[200:203], v[88:91]
    v_cvt_pk_bf16_f32 v219, v186, v187
    v_mfma_f32_16x16x32_bf16 v[84:87], a[116:119], v[196:199], v[84:87]
    v_exp_f32 v172, v172
    v_mfma_f32_16x16x32_bf16 v[80:83], a[116:119], v[192:195], v[80:83]
    ds_read_b128 a[116:119], v241 offset:27648
    v_mfma_f32_16x16x32_bf16 v[96:99], a[120:123], v[192:195], v[96:99]
    v_exp_f32 v173, v173
    v_mfma_f32_16x16x32_bf16 v[100:103], a[120:123], v[196:199], v[100:103]
    v_cvt_pk_bf16_f32 v220, v172, v173
    v_mfma_f32_16x16x32_bf16 v[104:107], a[120:123], v[200:203], v[104:107]
    v_exp_f32 v174, v174
    v_mfma_f32_16x16x32_bf16 v[108:111], a[120:123], v[204:207], v[108:111]
    ds_read_b128 a[120:123], v241 offset:30720
    v_mfma_f32_16x16x32_bf16 v[124:127], a[124:127], v[204:207], v[124:127]
    v_exp_f32 v175, v175
    v_mfma_f32_16x16x32_bf16 v[120:123], a[124:127], v[200:203], v[120:123]
    v_cvt_pk_bf16_f32 v221, v174, v175
    v_mfma_f32_16x16x32_bf16 v[116:119], a[124:127], v[196:199], v[116:119]
    v_exp_f32 v188, v188
    v_mfma_f32_16x16x32_bf16 v[112:115], a[124:127], v[192:195], v[112:115]
    ds_read_b128 a[124:127], v241 offset:31744
    v_mfma_f32_16x16x32_bf16 a[128:131], a[144:147], v[192:195], a[128:131]
    v_add_u32 v241, 32768, v241
    v_mfma_f32_16x16x32_bf16 a[132:135], a[144:147], v[196:199], a[132:135]
    v_and_b32 v241, 0x1ffff, v241
    v_mfma_f32_16x16x32_bf16 a[136:139], a[144:147], v[200:203], a[136:139]
    v_exp_f32 v189, v189
    v_mfma_f32_16x16x32_bf16 a[140:143], a[144:147], v[204:207], a[140:143]
    v_cvt_pk_bf16_f32 v222, v188, v189
    v_exp_f32 v190, v190
    v_exp_f32 v191, v191
    s_nop 0
    v_cvt_pk_bf16_f32 v223, v190, v191
    v_mfma_f32_16x16x32_bf16 v[160:163], a[64:67], a[0:3], v[224:227]
    v_exp_f32 v128, v128
    s_mov_b32 m0, s48
    v_mfma_f32_16x16x32_bf16 v[164:167], a[64:67], a[16:19], v[228:231]
    buffer_load_dwordx4 v244, s[28:31], s47 offen sc1 lds
    v_mfma_f32_16x16x32_bf16 v[168:171], a[64:67], a[32:35], v[232:235]
    v_exp_f32 v129, v129
    v_mfma_f32_16x16x32_bf16 v[172:175], a[64:67], a[48:51], v[236:239]
    ds_read_b128 a[64:67], v241 offset:0
    v_mfma_f32_16x16x32_bf16 v[160:163], a[68:71], a[4:7], v[160:163]
    v_cvt_pk_bf16_f32 v192, v128, v129
    v_mfma_f32_16x16x32_bf16 v[164:167], a[68:71], a[20:23], v[164:167]
    v_exp_f32 v130, v130
    v_mfma_f32_16x16x32_bf16 v[168:171], a[68:71], a[36:39], v[168:171]
    v_exp_f32 v131, v131
    v_mfma_f32_16x16x32_bf16 v[172:175], a[68:71], a[52:55], v[172:175]
    ds_read_b128 a[68:71], v241 offset:1024
    s_waitcnt lgkmcnt(9)
    v_mfma_f32_16x16x32_bf16 v[160:163], a[72:75], a[8:11], v[160:163]
    buffer_load_dwordx4 a[148:151], v244, s[52:55], s51 offen
    s_add_u32 s51, s51, 1024
    v_mfma_f32_16x16x32_bf16 v[164:167], a[72:75], a[24:27], v[164:167]
    v_cvt_pk_bf16_f32 v193, v130, v131
    v_mfma_f32_16x16x32_bf16 v[168:171], a[72:75], a[40:43], v[168:171]
    v_exp_f32 v144, v144
    v_mfma_f32_16x16x32_bf16 v[172:175], a[72:75], a[56:59], v[172:175]
    ds_read_b128 a[72:75], v241 offset:4096
    v_mfma_f32_16x16x32_bf16 v[160:163], a[76:79], a[12:15], v[160:163]
    v_exp_f32 v145, v145
    v_mfma_f32_16x16x32_bf16 v[164:167], a[76:79], a[28:31], v[164:167]
    buffer_load_dwordx4 v244, s[28:31], s47 offen offset:1024 sc1 lds
    v_mfma_f32_16x16x32_bf16 v[168:171], a[76:79], a[44:47], v[168:171]
    v_cvt_pk_bf16_f32 v194, v144, v145
    v_mfma_f32_16x16x32_bf16 v[172:175], a[76:79], a[60:63], v[172:175]
    ds_read_b128 a[76:79], v241 offset:5120
    v_mfma_f32_16x16x32_bf16 v[176:179], a[80:83], a[0:3], v[224:227]
    v_exp_f32 v146, v146
    v_mfma_f32_16x16x32_bf16 v[180:183], a[80:83], a[16:19], v[228:231]
    v_exp_f32 v147, v147
    v_mfma_f32_16x16x32_bf16 v[184:187], a[80:83], a[32:35], v[232:235]
    v_cvt_pk_bf16_f32 v195, v146, v147
    v_mfma_f32_16x16x32_bf16 v[188:191], a[80:83], a[48:51], v[236:239]
    ds_read_b128 a[80:83], v241 offset:8192
    v_mfma_f32_16x16x32_bf16 v[176:179], a[84:87], a[4:7], v[176:179]
    v_exp_f32 v132, v132
    v_mfma_f32_16x16x32_bf16 v[180:183], a[84:87], a[20:23], v[180:183]
    v_exp_f32 v133, v133
    v_mfma_f32_16x16x32_bf16 v[184:187], a[84:87], a[36:39], v[184:187]
    v_cvt_pk_bf16_f32 v196, v132, v133
    v_mfma_f32_16x16x32_bf16 v[188:191], a[84:87], a[52:55], v[188:191]
    ds_read_b128 a[84:87], v241 offset:9216
    v_mfma_f32_16x16x32_bf16 v[176:179], a[88:91], a[8:11], v[176:179]
    v_exp_f32 v134, v134
    v_mfma_f32_16x16x32_bf16 v[180:183], a[88:91], a[24:27], v[180:183]
    buffer_load_dwordx4 v244, s[32:35], s47 offen offset:2048 sc1 lds
    v_mfma_f32_16x16x32_bf16 v[184:187], a[88:91], a[40:43], v[184:187]
    v_exp_f32 v135, v135
    v_mfma_f32_16x16x32_bf16 v[188:191], a[88:91], a[56:59], v[188:191]
    ds_read_b128 a[88:91], v241 offset:12288
    v_mfma_f32_16x16x32_bf16 v[176:179], a[92:95], a[12:15], v[176:179]
    v_cvt_pk_bf16_f32 v197, v134, v135
    v_mfma_f32_16x16x32_bf16 v[180:183], a[92:95], a[28:31], v[180:183]
    v_exp_f32 v148, v148
    v_mfma_f32_16x16x32_bf16 v[184:187], a[92:95], a[44:47], v[184:187]
    v_exp_f32 v149, v149
    v_mfma_f32_16x16x32_bf16 v[188:191], a[92:95], a[60:63], v[188:191]
    ds_read_b128 a[92:95], v241 offset:13312
    v_mfma_f32_16x16x32_bf16 v[0:3], a[96:99], v[208:211], v[0:3]
    v_cvt_pk_bf16_f32 v198, v148, v149
    v_mfma_f32_16x16x32_bf16 v[4:7], a[96:99], v[212:215], v[4:7]
    v_exp_f32 v150, v150
    v_mfma_f32_16x16x32_bf16 v[8:11], a[96:99], v[216:219], v[8:11]
    v_exp_f32 v151, v151
    v_mfma_f32_16x16x32_bf16 v[12:15], a[96:99], v[220:223], v[12:15]
    ds_read_b128 a[96:99], v241 offset:2048
    s_waitcnt lgkmcnt(9)
    v_mfma_f32_16x16x32_bf16 v[28:31], a[100:103], v[220:223], v[28:31]
    v_cvt_pk_bf16_f32 v199, v150, v151
    v_mfma_f32_16x16x32_bf16 v[24:27], a[100:103], v[216:219], v[24:27]
    buffer_load_dwordx4 v244, s[32:35], s47 offen offset:3072 sc1 lds
    v_mfma_f32_16x16x32_bf16 v[20:23], a[100:103], v[212:215], v[20:23]
    buffer_load_dwordx4 a[148:151], v244, s[8:11], s37 offen
    v_mfma_f32_16x16x32_bf16 v[16:19], a[100:103], v[208:211], v[16:19]
    ds_read_b128 a[100:103], v241 offset:3072
    s_add_u32 s47, s47, 8192
    v_mfma_f32_16x16x32_bf16 v[32:35], a[104:107], v[208:211], v[32:35]
    v_exp_f32 v136, v136
    v_mfma_f32_16x16x32_bf16 v[36:39], a[104:107], v[212:215], v[36:39]
    v_exp_f32 v137, v137
    s_add_u32 s48, s48, 16384
    v_mfma_f32_16x16x32_bf16 v[40:43], a[104:107], v[216:219], v[40:43]
    v_cvt_pk_bf16_f32 v200, v136, v137
    v_mfma_f32_16x16x32_bf16 v[44:47], a[104:107], v[220:223], v[44:47]
    ds_read_b128 a[104:107], v241 offset:6144
    s_and_b32 s48, s48, 0x1ffff
    v_mfma_f32_16x16x32_bf16 v[60:63], a[108:111], v[220:223], v[60:63]
    v_exp_f32 v138, v138
    v_mfma_f32_16x16x32_bf16 v[56:59], a[108:111], v[216:219], v[56:59]
    v_exp_f32 v139, v139
    v_mfma_f32_16x16x32_bf16 v[52:55], a[108:111], v[212:215], v[52:55]
    v_cvt_pk_bf16_f32 v201, v138, v139
    v_mfma_f32_16x16x32_bf16 v[48:51], a[108:111], v[208:211], v[48:51]
    ds_read_b128 a[108:111], v241 offset:7168
    v_mfma_f32_16x16x32_bf16 v[64:67], a[112:115], v[208:211], v[64:67]
    v_exp_f32 v152, v152
    v_mfma_f32_16x16x32_bf16 v[68:71], a[112:115], v[212:215], v[68:71]
    v_exp_f32 v153, v153
    v_mfma_f32_16x16x32_bf16 v[72:75], a[112:115], v[216:219], v[72:75]
    v_cvt_pk_bf16_f32 v202, v152, v153
    v_mfma_f32_16x16x32_bf16 v[76:79], a[112:115], v[220:223], v[76:79]
    ds_read_b128 a[112:115], v241 offset:10240
    v_mfma_f32_16x16x32_bf16 v[92:95], a[116:119], v[220:223], v[92:95]
    v_exp_f32 v154, v154
    v_mfma_f32_16x16x32_bf16 v[88:91], a[116:119], v[216:219], v[88:91]
    v_exp_f32 v155, v155
    v_mfma_f32_16x16x32_bf16 v[84:87], a[116:119], v[212:215], v[84:87]
    v_cvt_pk_bf16_f32 v203, v154, v155
    v_mfma_f32_16x16x32_bf16 v[80:83], a[116:119], v[208:211], v[80:83]
    ds_read_b128 a[116:119], v241 offset:11264
    v_mfma_f32_16x16x32_bf16 v[96:99], a[120:123], v[208:211], v[96:99]
    v_exp_f32 v140, v140
    v_mfma_f32_16x16x32_bf16 v[100:103], a[120:123], v[212:215], v[100:103]
    v_exp_f32 v141, v141
    v_mfma_f32_16x16x32_bf16 v[104:107], a[120:123], v[216:219], v[104:107]
    v_cvt_pk_bf16_f32 v204, v140, v141
    v_mfma_f32_16x16x32_bf16 v[108:111], a[120:123], v[220:223], v[108:111]
    ds_read_b128 a[120:123], v241 offset:14336
    v_mfma_f32_16x16x32_bf16 v[124:127], a[124:127], v[220:223], v[124:127]
    v_exp_f32 v142, v142
    v_mfma_f32_16x16x32_bf16 v[120:123], a[124:127], v[216:219], v[120:123]
    v_exp_f32 v143, v143
    v_mfma_f32_16x16x32_bf16 v[116:119], a[124:127], v[212:215], v[116:119]
    v_cvt_pk_bf16_f32 v205, v142, v143
    v_mfma_f32_16x16x32_bf16 v[112:115], a[124:127], v[208:211], v[112:115]
    ds_read_b128 a[124:127], v241 offset:15360
    v_mfma_f32_16x16x32_bf16 a[128:131], a[144:147], v[208:211], a[128:131]
    v_exp_f32 v156, v156
    v_mfma_f32_16x16x32_bf16 a[132:135], a[144:147], v[212:215], a[132:135]
    v_exp_f32 v157, v157
    v_mfma_f32_16x16x32_bf16 a[136:139], a[144:147], v[216:219], a[136:139]
    v_cvt_pk_bf16_f32 v206, v156, v157
    v_mfma_f32_16x16x32_bf16 a[140:143], a[144:147], v[220:223], a[140:143]
    v_exp_f32 v158, v158
    v_exp_f32 v159, v159
    s_nop 0
    v_cvt_pk_bf16_f32 v207, v158, v159
    s_waitcnt vmcnt(15)
    s_barrier
    s_cmp_lg_u32 s3, 0
    s_cbranch_scc1 pa_fh
    s_add_u32 s40, s101, 0xffef8000
    v_mov_b32 v246, 0
    v_mov_b32 v247, s100
    s_mov_b64 exec, 1
    buffer_store_dword v247, v246, s[16:19], s40 offen sc1
    s_mov_b64 exec, -1
pa_fh:
    s_waitcnt lgkmcnt(9)
    v_mfma_f32_16x16x32_bf16 v[128:131], a[64:67], a[0:3], v[224:227]
    v_exp_f32 v160, v160
    s_mov_b32 m0, s48
    v_mfma_f32_16x16x32_bf16 v[132:135], a[64:67], a[16:19], v[228:231]
    buffer_load_dwordx4 v244, s[28:31], s47 offen sc1 lds
    v_mfma_f32_16x16x32_bf16 v[136:139], a[64:67], a[32:35], v[232:235]
    v_exp_f32 v161, v161
    v_mfma_f32_16x16x32_bf16 v[140:143], a[64:67], a[48:51], v[236:239]
    ds_read_b128 a[64:67], v241 offset:16384
    v_mfma_f32_16x16x32_bf16 v[128:131], a[68:71], a[4:7], v[128:131]
    v_cvt_pk_bf16_f32 v208, v160, v161
    v_mfma_f32_16x16x32_bf16 v[132:135], a[68:71], a[20:23], v[132:135]
    v_exp_f32 v162, v162
    v_mfma_f32_16x16x32_bf16 v[136:139], a[68:71], a[36:39], v[136:139]
    v_exp_f32 v163, v163
    v_mfma_f32_16x16x32_bf16 v[140:143], a[68:71], a[52:55], v[140:143]
    ds_read_b128 a[68:71], v241 offset:17408
    v_mfma_f32_16x16x32_bf16 v[128:131], a[72:75], a[8:11], v[128:131]
    buffer_load_dwordx4 a[148:151], v244, s[56:59], s60 offen
    s_add_u32 s60, s60, 1024
    v_mfma_f32_16x16x32_bf16 v[132:135], a[72:75], a[24:27], v[132:135]
    v_cvt_pk_bf16_f32 v209, v162, v163
    v_mfma_f32_16x16x32_bf16 v[136:139], a[72:75], a[40:43], v[136:139]
    v_exp_f32 v176, v176
    v_mfma_f32_16x16x32_bf16 v[140:143], a[72:75], a[56:59], v[140:143]
    ds_read_b128 a[72:75], v241 offset:20480
    v_mfma_f32_16x16x32_bf16 v[128:131], a[76:79], a[12:15], v[128:131]
    v_exp_f32 v177, v177
    v_mfma_f32_16x16x32_bf16 v[132:135], a[76:79], a[28:31], v[132:135]
    buffer_load_dwordx4 v244, s[28:31], s47 offen offset:1024 sc1 lds
    v_mfma_f32_16x16x32_bf16 v[136:139], a[76:79], a[44:47], v[136:139]
    v_cvt_pk_bf16_f32 v210, v176, v177
    v_mfma_f32_16x16x32_bf16 v[140:143], a[76:79], a[60:63], v[140:143]
    ds_read_b128 a[76:79], v241 offset:21504
    v_mfma_f32_16x16x32_bf16 v[144:147], a[80:83], a[0:3], v[224:227]
    v_exp_f32 v178, v178
    v_mfma_f32_16x16x32_bf16 v[148:151], a[80:83], a[16:19], v[228:231]
    v_exp_f32 v179, v179
    v_mfma_f32_16x16x32_bf16 v[152:155], a[80:83], a[32:35], v[232:235]
    v_cvt_pk_bf16_f32 v211, v178, v179
    v_mfma_f32_16x16x32_bf16 v[156:159], a[80:83], a[48:51], v[236:239]
    ds_read_b128 a[80:83], v241 offset:24576
    v_mfma_f32_16x16x32_bf16 v[144:147], a[84:87], a[4:7], v[144:147]
    v_exp_f32 v164, v164
    v_mfma_f32_16x16x32_bf16 v[148:151], a[84:87], a[20:23], v[148:151]
    v_exp_f32 v165, v165
    v_mfma_f32_16x16x32_bf16 v[152:155], a[84:87], a[36:39], v[152:155]
    v_cvt_pk_bf16_f32 v212, v164, v165
    v_mfma_f32_16x16x32_bf16 v[156:159], a[84:87], a[52:55], v[156:159]
    ds_read_b128 a[84:87], v241 offset:25600
    v_mfma_f32_16x16x32_bf16 v[144:147], a[88:91], a[8:11], v[144:147]
    v_exp_f32 v166, v166
    v_mfma_f32_16x16x32_bf16 v[148:151], a[88:91], a[24:27], v[148:151]
    buffer_load_dwordx4 v244, s[32:35], s47 offen offset:2048 sc1 lds
    v_mfma_f32_16x16x32_bf16 v[152:155], a[88:91], a[40:43], v[152:155]
    v_exp_f32 v167, v167
    v_mfma_f32_16x16x32_bf16 v[156:159], a[88:91], a[56:59], v[156:159]
    ds_read_b128 a[88:91], v241 offset:28672
    s_waitcnt lgkmcnt(9)
    v_mfma_f32_16x16x32_bf16 v[144:147], a[92:95], a[12:15], v[144:147]
    v_cvt_pk_bf16_f32 v213, v166, v167
    v_mfma_f32_16x16x32_bf16 v[148:151], a[92:95], a[28:31], v[148:151]
    v_exp_f32 v180, v180
    v_mfma_f32_16x16x32_bf16 v[152:155], a[92:95], a[44:47], v[152:155]
    v_exp_f32 v181, v181
    v_mfma_f32_16x16x32_bf16 v[156:159], a[92:95], a[60:63], v[156:159]
    ds_read_b128 a[92:95], v241 offset:29696
    v_mfma_f32_16x16x32_bf16 v[0:3], a[96:99], v[192:195], v[0:3]
    v_cvt_pk_bf16_f32 v214, v180, v181
    v_mfma_f32_16x16x32_bf16 v[4:7], a[96:99], v[196:199], v[4:7]
    v_exp_f32 v182, v182
    v_mfma_f32_16x16x32_bf16 v[8:11], a[96:99], v[200:203], v[8:11]
    v_exp_f32 v183, v183
    v_mfma_f32_16x16x32_bf16 v[12:15], a[96:99], v[204:207], v[12:15]
    ds_read_b128 a[96:99], v241 offset:18432
    v_mfma_f32_16x16x32_bf16 v[28:31], a[100:103], v[204:207], v[28:31]
    v_cvt_pk_bf16_f32 v215, v182, v183
    v_mfma_f32_16x16x32_bf16 v[24:27], a[100:103], v[200:203], v[24:27]
    buffer_load_dwordx4 v244, s[32:35], s47 offen offset:3072 sc1 lds
    v_mfma_f32_16x16x32_bf16 v[20:23], a[100:103], v[196:199], v[20:23]
    v_exp_f32 v168, v168
    v_mfma_f32_16x16x32_bf16 v[16:19], a[100:103], v[192:195], v[16:19]
    ds_read_b128 a[100:103], v241 offset:19456
    s_add_u32 s47, s47, 8192
    v_mfma_f32_16x16x32_bf16 v[32:35], a[104:107], v[192:195], v[32:35]
    v_exp_f32 v169, v169
    v_mfma_f32_16x16x32_bf16 v[36:39], a[104:107], v[196:199], v[36:39]
    v_cvt_pk_bf16_f32 v216, v168, v169
    s_add_u32 s48, s48, 16384
    v_mfma_f32_16x16x32_bf16 v[40:43], a[104:107], v[200:203], v[40:43]
    v_exp_f32 v170, v170
    v_mfma_f32_16x16x32_bf16 v[44:47], a[104:107], v[204:207], v[44:47]
    ds_read_b128 a[104:107], v241 offset:22528
    s_and_b32 s48, s48, 0x1ffff
    v_mfma_f32_16x16x32_bf16 v[60:63], a[108:111], v[204:207], v[60:63]
    v_exp_f32 v171, v171
    v_mfma_f32_16x16x32_bf16 v[56:59], a[108:111], v[200:203], v[56:59]
    v_cvt_pk_bf16_f32 v217, v170, v171
    v_mfma_f32_16x16x32_bf16 v[52:55], a[108:111], v[196:199], v[52:55]
    v_exp_f32 v184, v184
    v_mfma_f32_16x16x32_bf16 v[48:51], a[108:111], v[192:195], v[48:51]
    ds_read_b128 a[108:111], v241 offset:23552
    v_mfma_f32_16x16x32_bf16 v[64:67], a[112:115], v[192:195], v[64:67]
    v_exp_f32 v185, v185
    v_mfma_f32_16x16x32_bf16 v[68:71], a[112:115], v[196:199], v[68:71]
    v_cvt_pk_bf16_f32 v218, v184, v185
    v_mfma_f32_16x16x32_bf16 v[72:75], a[112:115], v[200:203], v[72:75]
    v_exp_f32 v186, v186
    v_mfma_f32_16x16x32_bf16 v[76:79], a[112:115], v[204:207], v[76:79]
    ds_read_b128 a[112:115], v241 offset:26624
    v_mfma_f32_16x16x32_bf16 v[92:95], a[116:119], v[204:207], v[92:95]
    v_exp_f32 v187, v187
    v_mfma_f32_16x16x32_bf16 v[88:91], a[116:119], v[200:203], v[88:91]
    v_cvt_pk_bf16_f32 v219, v186, v187
    v_mfma_f32_16x16x32_bf16 v[84:87], a[116:119], v[196:199], v[84:87]
    v_exp_f32 v172, v172
    v_mfma_f32_16x16x32_bf16 v[80:83], a[116:119], v[192:195], v[80:83]
    ds_read_b128 a[116:119], v241 offset:27648
    s_waitcnt lgkmcnt(9)
    v_mfma_f32_16x16x32_bf16 v[96:99], a[120:123], v[192:195], v[96:99]
    v_exp_f32 v173, v173
    v_mfma_f32_16x16x32_bf16 v[100:103], a[120:123], v[196:199], v[100:103]
    v_cvt_pk_bf16_f32 v220, v172, v173
    v_mfma_f32_16x16x32_bf16 v[104:107], a[120:123], v[200:203], v[104:107]
    v_exp_f32 v174, v174
    v_mfma_f32_16x16x32_bf16 v[108:111], a[120:123], v[204:207], v[108:111]
    ds_read_b128 a[120:123], v241 offset:30720
    v_mfma_f32_16x16x32_bf16 v[124:127], a[124:127], v[204:207], v[124:127]
    v_exp_f32 v175, v175
    v_mfma_f32_16x16x32_bf16 v[120:123], a[124:127], v[200:203], v[120:123]
    v_cvt_pk_bf16_f32 v221, v174, v175
    v_mfma_f32_16x16x32_bf16 v[116:119], a[124:127], v[196:199], v[116:119]
    v_exp_f32 v188, v188
    v_mfma_f32_16x16x32_bf16 v[112:115], a[124:127], v[192:195], v[112:115]
    ds_read_b128 a[124:127], v241 offset:31744
    v_mfma_f32_16x16x32_bf16 a[128:131], a[144:147], v[192:195], a[128:131]
    v_add_u32 v241, 32768, v241
    v_mfma_f32_16x16x32_bf16 a[132:135], a[144:147], v[196:199], a[132:135]
    v_and_b32 v241, 0x1ffff, v241
    v_mfma_f32_16x16x32_bf16 a[136:139], a[144:147], v[200:203], a[136:139]
    v_exp_f32 v189, v189
    v_mfma_f32_16x16x32_bf16 a[140:143], a[144:147], v[204:207], a[140:143]
    v_cvt_pk_bf16_f32 v222, v188, v189
    v_exp_f32 v190, v190
    v_exp_f32 v191, v191
    s_nop 0
    v_cvt_pk_bf16_f32 v223, v190, v191
    v_mfma_f32_16x16x32_bf16 v[160:163], a[64:67], a[0:3], v[224:227]
    v_exp_f32 v128, v128
    s_mov_b32 m0, s48
    v_mfma_f32_16x16x32_bf16 v[164:167], a[64:67], a[16:19], v[228:231]
    buffer_load_dwordx4 v244, s[28:31], s47 offen sc1 lds
    v_mfma_f32_16x16x32_bf16 v[168:171], a[64:67], a[32:35], v[232:235]
    v_exp_f32 v129, v129
    v_mfma_f32_16x16x32_bf16 v[172:175], a[64:67], a[48:51], v[236:239]
    ds_read_b128 a[64:67], v241 offset:0
    v_mfma_f32_16x16x32_bf16 v[160:163], a[68:71], a[4:7], v[160:163]
    v_cvt_pk_bf16_f32 v192, v128, v129
    v_mfma_f32_16x16x32_bf16 v[164:167], a[68:71], a[20:23], v[164:167]
    v_exp_f32 v130, v130
    v_mfma_f32_16x16x32_bf16 v[168:171], a[68:71], a[36:39], v[168:171]
    v_exp_f32 v131, v131
    v_mfma_f32_16x16x32_bf16 v[172:175], a[68:71], a[52:55], v[172:175]
    ds_read_b128 a[68:71], v241 offset:1024
    v_mfma_f32_16x16x32_bf16 v[160:163], a[72:75], a[8:11], v[160:163]
    buffer_load_dwordx4 a[148:151], v244, s[52:55], s51 offen
    s_add_u32 s51, s51, 1024
    v_mfma_f32_16x16x32_bf16 v[164:167], a[72:75], a[24:27], v[164:167]
    v_cvt_pk_bf16_f32 v193, v130, v131
    v_mfma_f32_16x16x32_bf16 v[168:171], a[72:75], a[40:43], v[168:171]
    v_exp_f32 v144, v144
    v_mfma_f32_16x16x32_bf16 v[172:175], a[72:75], a[56:59], v[172:175]
    ds_read_b128 a[72:75], v241 offset:4096
    v_mfma_f32_16x16x32_bf16 v[160:163], a[76:79], a[12:15], v[160:163]
    v_exp_f32 v145, v145
    v_mfma_f32_16x16x32_bf16 v[164:167], a[76:79], a[28:31], v[164:167]
    buffer_load_dwordx4 v244, s[28:31], s47 offen offset:1024 sc1 lds
    v_mfma_f32_16x16x32_bf16 v[168:171], a[76:79], a[44:47], v[168:171]
    v_cvt_pk_bf16_f32 v194, v144, v145
    v_mfma_f32_16x16x32_bf16 v[172:175], a[76:79], a[60:63], v[172:175]
    ds_read_b128 a[76:79], v241 offset:5120
    v_mfma_f32_16x16x32_bf16 v[176:179], a[80:83], a[0:3], v[224:227]
    v_exp_f32 v146, v146
    v_mfma_f32_16x16x32_bf16 v[180:183], a[80:83], a[16:19], v[228:231]
    v_exp_f32 v147, v147
    v_mfma_f32_16x16x32_bf16 v[184:187], a[80:83], a[32:35], v[232:235]
    v_cvt_pk_bf16_f32 v195, v146, v147
    v_mfma_f32_16x16x32_bf16 v[188:191], a[80:83], a[48:51], v[236:239]
    ds_read_b128 a[80:83], v241 offset:8192
    s_waitcnt lgkmcnt(9)
    v_mfma_f32_16x16x32_bf16 v[176:179], a[84:87], a[4:7], v[176:179]
    v_exp_f32 v132, v132
    v_mfma_f32_16x16x32_bf16 v[180:183], a[84:87], a[20:23], v[180:183]
    v_exp_f32 v133, v133
    v_mfma_f32_16x16x32_bf16 v[184:187], a[84:87], a[36:39], v[184:187]
    v_cvt_pk_bf16_f32 v196, v132, v133
    v_mfma_f32_16x16x32_bf16 v[188:191], a[84:87], a[52:55], v[188:191]
    ds_read_b128 a[84:87], v241 offset:9216
    v_mfma_f32_16x16x32_bf16 v[176:179], a[88:91], a[8:11], v[176:179]
    v_exp_f32 v134, v134
    v_mfma_f32_16x16x32_bf16 v[180:183], a[88:91], a[24:27], v[180:183]
    buffer_load_dwordx4 v244, s[32:35], s47 offen offset:2048 sc1 lds
    v_mfma_f32_16x16x32_bf16 v[184:187], a[88:91], a[40:43], v[184:187]
    v_exp_f32 v135, v135
    v_mfma_f32_16x16x32_bf16 v[188:191], a[88:91], a[56:59], v[188:191]
    ds_read_b128 a[88:91], v241 offset:12288
    v_mfma_f32_16x16x32_bf16 v[176:179], a[92:95], a[12:15], v[176:179]
    v_cvt_pk_bf16_f32 v197, v134, v135
    v_mfma_f32_16x16x32_bf16 v[180:183], a[92:95], a[28:31], v[180:183]
    v_exp_f32 v148, v148
    v_mfma_f32_16x16x32_bf16 v[184:187], a[92:95], a[44:47], v[184:187]
    v_exp_f32 v149, v149
    v_mfma_f32_16x16x32_bf16 v[188:191], a[92:95], a[60:63], v[188:191]
    ds_read_b128 a[92:95], v241 offset:13312
    v_mfma_f32_16x16x32_bf16 v[0:3], a[96:99], v[208:211], v[0:3]
    v_cvt_pk_bf16_f32 v198, v148, v149
    v_mfma_f32_16x16x32_bf16 v[4:7], a[96:99], v[212:215], v[4:7]
    v_exp_f32 v150, v150
    v_mfma_f32_16x16x32_bf16 v[8:11], a[96:99], v[216:219], v[8:11]
    v_exp_f32 v151, v151
    v_mfma_f32_16x16x32_bf16 v[12:15], a[96:99], v[220:223], v[12:15]
    ds_read_b128 a[96:99], v241 offset:2048
    v_mfma_f32_16x16x32_bf16 v[28:31], a[100:103], v[220:223], v[28:31]
    v_cvt_pk_bf16_f32 v199, v150, v151
    v_mfma_f32_16x16x32_bf16 v[24:27], a[100:103], v[216:219], v[24:27]
    buffer_load_dwordx4 v244, s[32:35], s47 offen offset:3072 sc1 lds
    v_mfma_f32_16x16x32_bf16 v[20:23], a[100:103], v[212:215], v[20:23]
    v_exp_f32 v136, v136
    v_mfma_f32_16x16x32_bf16 v[16:19], a[100:103], v[208:211], v[16:19]
    ds_read_b128 a[100:103], v241 offset:3072
    s_add_u32 s47, s47, 8192
    v_mfma_f32_16x16x32_bf16 v[32:35], a[104:107], v[208:211], v[32:35]
    v_exp_f32 v137, v137
    v_mfma_f32_16x16x32_bf16 v[36:39], a[104:107], v[212:215], v[36:39]
    v_cvt_pk_bf16_f32 v200, v136, v137
    s_add_u32 s48, s48, 16384
    v_mfma_f32_16x16x32_bf16 v[40:43], a[104:107], v[216:219], v[40:43]
    v_exp_f32 v138, v138
    v_mfma_f32_16x16x32_bf16 v[44:47], a[104:107], v[220:223], v[44:47]
    ds_read_b128 a[104:107], v241 offset:6144
    s_and_b32 s48, s48, 0x1ffff
    v_mfma_f32_16x16x32_bf16 v[60:63], a[108:111], v[220:223], v[60:63]
    v_exp_f32 v139, v139
    v_mfma_f32_16x16x32_bf16 v[56:59], a[108:111], v[216:219], v[56:59]
    v_cvt_pk_bf16_f32 v201, v138, v139
    v_mfma_f32_16x16x32_bf16 v[52:55], a[108:111], v[212:215], v[52:55]
    v_exp_f32 v152, v152
    v_mfma_f32_16x16x32_bf16 v[48:51], a[108:111], v[208:211], v[48:51]
    ds_read_b128 a[108:111], v241 offset:7168
    s_waitcnt lgkmcnt(9)
    v_mfma_f32_16x16x32_bf16 v[64:67], a[112:115], v[208:211], v[64:67]
    v_exp_f32 v153, v153
    v_mfma_f32_16x16x32_bf16 v[68:71], a[112:115], v[212:215], v[68:71]
    v_cvt_pk_bf16_f32 v202, v152, v153
    v_mfma_f32_16x16x32_bf16 v[72:75], a[112:115], v[216:219], v[72:75]
    v_exp_f32 v154, v154
    v_mfma_f32_16x16x32_bf16 v[76:79], a[112:115], v[220:223], v[76:79]
    ds_read_b128 a[112:115], v241 offset:10240
    v_mfma_f32_16x16x32_bf16 v[92:95], a[116:119], v[220:223], v[92:95]
    v_exp_f32 v155, v155
    v_mfma_f32_16x16x32_bf16 v[88:91], a[116:119], v[216:219], v[88:91]
    v_cvt_pk_bf16_f32 v203, v154, v155
    v_mfma_f32_16x16x32_bf16 v[84:87], a[116:119], v[212:215], v[84:87]
    v_exp_f32 v140, v140
    v_mfma_f32_16x16x32_bf16 v[80:83], a[116:119], v[208:211], v[80:83]
    ds_read_b128 a[116:119], v241 offset:11264
    v_mfma_f32_16x16x32_bf16 v[96:99], a[120:123], v[208:211], v[96:99]
    v_exp_f32 v141, v141
    v_mfma_f32_16x16x32_bf16 v[100:103], a[120:123], v[212:215], v[100:103]
    v_cvt_pk_bf16_f32 v204, v140, v141
    v_mfma_f32_16x16x32_bf16 v[104:107], a[120:123], v[216:219], v[104:107]
    v_exp_f32 v142, v142
    v_mfma_f32_16x16x32_bf16 v[108:111], a[120:123], v[220:223], v[108:111]
    ds_read_b128 a[120:123], v241 offset:14336
    v_mfma_f32_16x16x32_bf16 v[124:127], a[124:127], v[220:223], v[124:127]
    v_exp_f32 v143, v143
    v_mfma_f32_16x16x32_bf16 v[120:123], a[124:127], v[216:219], v[120:123]
    v_cvt_pk_bf16_f32 v205, v142, v143
    v_mfma_f32_16x16x32_bf16 v[116:119], a[124:127], v[212:215], v[116:119]
    v_exp_f32 v156, v156
    v_mfma_f32_16x16x32_bf16 v[112:115], a[124:127], v[208:211], v[112:115]
    ds_read_b128 a[124:127], v241 offset:15360
    v_mfma_f32_16x16x32_bf16 a[128:131], a[144:147], v[208:211], a[128:131]
    v_exp_f32 v157, v157
    v_mfma_f32_16x16x32_bf16 a[132:135], a[144:147], v[212:215], a[132:135]
    v_cvt_pk_bf16_f32 v206, v156, v157
    v_mfma_f32_16x16x32_bf16 a[136:139], a[144:147], v[216:219], a[136:139]
    v_exp_f32 v158, v158
    v_mfma_f32_16x16x32_bf16 a[140:143], a[144:147], v[220:223], a[140:143]
    v_exp_f32 v159, v159
    s_nop 0
    v_cvt_pk_bf16_f32 v207, v158, v159
    s_waitcnt vmcnt(15)
    s_barrier
    v_mfma_f32_16x16x32_bf16 v[128:131], a[64:67], a[0:3], v[224:227]
    v_exp_f32 v160, v160
    s_mov_b32 m0, s48
    v_mfma_f32_16x16x32_bf16 v[132:135], a[64:67], a[16:19], v[228:231]
    buffer_load_dwordx4 v244, s[28:31], s47 offen sc1 lds
    v_mfma_f32_16x16x32_bf16 v[136:139], a[64:67], a[32:35], v[232:235]
    v_exp_f32 v161, v161
    v_mfma_f32_16x16x32_bf16 v[140:143], a[64:67], a[48:51], v[236:239]
    ds_read_b128 a[64:67], v241 offset:16384
    v_mfma_f32_16x16x32_bf16 v[128:131], a[68:71], a[4:7], v[128:131]
    v_cvt_pk_bf16_f32 v208, v160, v161
    v_mfma_f32_16x16x32_bf16 v[132:135], a[68:71], a[20:23], v[132:135]
    v_exp_f32 v162, v162
    v_mfma_f32_16x16x32_bf16 v[136:139], a[68:71], a[36:39], v[136:139]
    v_exp_f32 v163, v163
    v_mfma_f32_16x16x32_bf16 v[140:143], a[68:71], a[52:55], v[140:143]
    ds_read_b128 a[68:71], v241 offset:17408
    v_mfma_f32_16x16x32_bf16 v[128:131], a[72:75], a[8:11], v[128:131]
    buffer_load_dwordx4 a[148:151], v244, s[56:59], s60 offen
    s_add_u32 s60, s60, 1024
    v_mfma_f32_16x16x32_bf16 v[132:135], a[72:75], a[24:27], v[132:135]
    v_cvt_pk_bf16_f32 v209, v162, v163
    v_mfma_f32_16x16x32_bf16 v[136:139], a[72:75], a[40:43], v[136:139]
    v_exp_f32 v176, v176
    v_mfma_f32_16x16x32_bf16 v[140:143], a[72:75], a[56:59], v[140:143]
    ds_read_b128 a[72:75], v241 offset:20480
    s_waitcnt lgkmcnt(9)
    v_mfma_f32_16x16x32_bf16 v[128:131], a[76:79], a[12:15], v[128:131]
    v_exp_f32 v177, v177
    v_mfma_f32_16x16x32_bf16 v[132:135], a[76:79], a[28:31], v[132:135]
    buffer_load_dwordx4 v244, s[28:31], s47 offen offset:1024 sc1 lds
    v_mfma_f32_16x16x32_bf16 v[136:139], a[76:79], a[44:47], v[136:139]
    v_cvt_pk_bf16_f32 v210, v176, v177
    v_mfma_f32_16x16x32_bf16 v[140:143], a[76:79], a[60:63], v[140:143]
    ds_read_b128 a[76:79], v241 offset:21504
    v_mfma_f32_16x16x32_bf16 v[144:147], a[80:83], a[0:3], v[224:227]
    v_exp_f32 v178, v178
    v_mfma_f32_16x16x32_bf16 v[148:151], a[80:83], a[16:19], v[228:231]
    v_exp_f32 v179, v179
    v_mfma_f32_16x16x32_bf16 v[152:155], a[80:83], a[32:35], v[232:235]
    v_cvt_pk_bf16_f32 v211, v178, v179
    v_mfma_f32_16x16x32_bf16 v[156:159], a[80:83], a[48:51], v[236:239]
    ds_read_b128 a[80:83], v241 offset:24576
    v_mfma_f32_16x16x32_bf16 v[144:147], a[84:87], a[4:7], v[144:147]
    v_exp_f32 v164, v164
    v_mfma_f32_16x16x32_bf16 v[148:151], a[84:87], a[20:23], v[148:151]
    v_exp_f32 v165, v165
    v_mfma_f32_16x16x32_bf16 v[152:155], a[84:87], a[36:39], v[152:155]
    v_cvt_pk_bf16_f32 v212, v164, v165
    v_mfma_f32_16x16x32_bf16 v[156:159], a[84:87], a[52:55], v[156:159]
    ds_read_b128 a[84:87], v241 offset:25600
    v_mfma_f32_16x16x32_bf16 v[144:147], a[88:91], a[8:11], v[144:147]
    v_exp_f32 v166, v166
    v_mfma_f32_16x16x32_bf16 v[148:151], a[88:91], a[24:27], v[148:151]
    buffer_load_dwordx4 v244, s[32:35], s47 offen offset:2048 sc1 lds
    v_mfma_f32_16x16x32_bf16 v[152:155], a[88:91], a[40:43], v[152:155]
    v_exp_f32 v167, v167
    v_mfma_f32_16x16x32_bf16 v[156:159], a[88:91], a[56:59], v[156:159]
    ds_read_b128 a[88:91], v241 offset:28672
    v_mfma_f32_16x16x32_bf16 v[144:147], a[92:95], a[12:15], v[144:147]
    v_cvt_pk_bf16_f32 v213, v166, v167
    v_mfma_f32_16x16x32_bf16 v[148:151], a[92:95], a[28:31], v[148:151]
    v_exp_f32 v180, v180
    v_mfma_f32_16x16x32_bf16 v[152:155], a[92:95], a[44:47], v[152:155]
    v_exp_f32 v181, v181
    v_mfma_f32_16x16x32_bf16 v[156:159], a[92:95], a[60:63], v[156:159]
    ds_read_b128 a[92:95], v241 offset:29696
    v_mfma_f32_16x16x32_bf16 v[0:3], a[96:99], v[192:195], v[0:3]
    v_cvt_pk_bf16_f32 v214, v180, v181
    v_mfma_f32_16x16x32_bf16 v[4:7], a[96:99], v[196:199], v[4:7]
    v_exp_f32 v182, v182
    v_mfma_f32_16x16x32_bf16 v[8:11], a[96:99], v[200:203], v[8:11]
    v_exp_f32 v183, v183
    v_mfma_f32_16x16x32_bf16 v[12:15], a[96:99], v[204:207], v[12:15]
    ds_read_b128 a[96:99], v241 offset:18432
    v_mfma_f32_16x16x32_bf16 v[28:31], a[100:103], v[204:207], v[28:31]
    v_cvt_pk_bf16_f32 v215, v182, v183
    v_mfma_f32_16x16x32_bf16 v[24:27], a[100:103], v[200:203], v[24:27]
    buffer_load_dwordx4 v244, s[32:35], s47 offen offset:3072 sc1 lds
    v_mfma_f32_16x16x32_bf16 v[20:23], a[100:103], v[196:199], v[20:23]
    v_exp_f32 v168, v168
    v_mfma_f32_16x16x32_bf16 v[16:19], a[100:103], v[192:195], v[16:19]
    ds_read_b128 a[100:103], v241 offset:19456
    s_add_u32 s47, s47, 8192
    s_waitcnt lgkmcnt(9)
    v_mfma_f32_16x16x32_bf16 v[32:35], a[104:107], v[192:195], v[32:35]
    v_exp_f32 v169, v169
    v_mfma_f32_16x16x32_bf16 v[36:39], a[104:107], v[196:199], v[36:39]
    v_cvt_pk_bf16_f32 v216, v168, v169
    s_add_u32 s48, s48, 16384
    v_mfma_f32_16x16x32_bf16 v[40:43], a[104:107], v[200:203], v[40:43]
    v_exp_f32 v170, v170
    v_mfma_f32_16x16x32_bf16 v[44:47], a[104:107], v[204:207], v[44:47]
    ds_read_b128 a[104:107], v241 offset:22528
    s_and_b32 s48, s48, 0x1ffff
    v_mfma_f32_16x16x32_bf16 v[60:63], a[108:111], v[204:207], v[60:63]
    v_exp_f32 v171, v171
    v_mfma_f32_16x16x32_bf16 v[56:59], a[108:111], v[200:203], v[56:59]
    v_cvt_pk_bf16_f32 v217, v170, v171
    v_mfma_f32_16x16x32_bf16 v[52:55], a[108:111], v[196:199], v[52:55]
    v_exp_f32 v184, v184
    v_mfma_f32_16x16x32_bf16 v[48:51], a[108:111], v[192:195], v[48:51]
    ds_read_b128 a[108:111], v241 offset:23552
    v_mfma_f32_16x16x32_bf16 v[64:67], a[112:115], v[192:195], v[64:67]
    v_exp_f32 v185, v185
    v_mfma_f32_16x16x32_bf16 v[68:71], a[112:115], v[196:199], v[68:71]
    v_cvt_pk_bf16_f32 v218, v184, v185
    v_mfma_f32_16x16x32_bf16 v[72:75], a[112:115], v[200:203], v[72:75]
    v_exp_f32 v186, v186
    v_mfma_f32_16x16x32_bf16 v[76:79], a[112:115], v[204:207], v[76:79]
    ds_read_b128 a[112:115], v241 offset:26624
    v_mfma_f32_16x16x32_bf16 v[92:95], a[116:119], v[204:207], v[92:95]
    v_exp_f32 v187, v187
    v_mfma_f32_16x16x32_bf16 v[88:91], a[116:119], v[200:203], v[88:91]
    v_cvt_pk_bf16_f32 v219, v186, v187
    v_mfma_f32_16x16x32_bf16 v[84:87], a[116:119], v[196:199], v[84:87]
    v_exp_f32 v172, v172
    v_mfma_f32_16x16x32_bf16 v[80:83], a[116:119], v[192:195], v[80:83]
    ds_read_b128 a[116:119], v241 offset:27648
    v_mfma_f32_16x16x32_bf16 v[96:99], a[120:123], v[192:195], v[96:99]
    v_exp_f32 v173, v173
    v_mfma_f32_16x16x32_bf16 v[100:103], a[120:123], v[196:199], v[100:103]
    v_cvt_pk_bf16_f32 v220, v172, v173
    v_mfma_f32_16x16x32_bf16 v[104:107], a[120:123], v[200:203], v[104:107]
    v_exp_f32 v174, v174
    v_mfma_f32_16x16x32_bf16 v[108:111], a[120:123], v[204:207], v[108:111]
    ds_read_b128 a[120:123], v241 offset:30720
    v_mfma_f32_16x16x32_bf16 v[124:127], a[124:127], v[204:207], v[124:127]
    v_exp_f32 v175, v175
    v_mfma_f32_16x16x32_bf16 v[120:123], a[124:127], v[200:203], v[120:123]
    v_cvt_pk_bf16_f32 v221, v174, v175
    v_mfma_f32_16x16x32_bf16 v[116:119], a[124:127], v[196:199], v[116:119]
    v_exp_f32 v188, v188
    v_mfma_f32_16x16x32_bf16 v[112:115], a[124:127], v[192:195], v[112:115]
    ds_read_b128 a[124:127], v241 offset:31744
    v_mfma_f32_16x16x32_bf16 a[128:131], a[144:147], v[192:195], a[128:131]
    v_add_u32 v241, 32768, v241
    v_mfma_f32_16x16x32_bf16 a[132:135], a[144:147], v[196:199], a[132:135]
    v_and_b32 v241, 0x1ffff, v241
    v_mfma_f32_16x16x32_bf16 a[136:139], a[144:147], v[200:203], a[136:139]
    v_exp_f32 v189, v189
    v_mfma_f32_16x16x32_bf16 a[140:143], a[144:147], v[204:207], a[140:143]
    v_cvt_pk_bf16_f32 v222, v188, v189
    v_exp_f32 v190, v190
    v_exp_f32 v191, v191
    s_nop 0
    v_cvt_pk_bf16_f32 v223, v190, v191
    v_mfma_f32_16x16x32_bf16 v[160:163], a[64:67], a[0:3], v[224:227]
    v_exp_f32 v128, v128
    v_mfma_f32_16x16x32_bf16 v[164:167], a[64:67], a[16:19], v[228:231]
    v_exp_f32 v129, v129
    v_mfma_f32_16x16x32_bf16 v[168:171], a[64:67], a[32:35], v[232:235]
    v_cvt_pk_bf16_f32 v192, v128, v129
    v_mfma_f32_16x16x32_bf16 v[172:175], a[64:67], a[48:51], v[236:239]
    v_exp_f32 v130, v130
    s_waitcnt lgkmcnt(8)
    v_mfma_f32_16x16x32_bf16 v[160:163], a[68:71], a[4:7], v[160:163]
    v_exp_f32 v131, v131
    v_mfma_f32_16x16x32_bf16 v[164:167], a[68:71], a[20:23], v[164:167]
    v_cvt_pk_bf16_f32 v193, v130, v131
    v_mfma_f32_16x16x32_bf16 v[168:171], a[68:71], a[36:39], v[168:171]
    v_exp_f32 v144, v144
    v_mfma_f32_16x16x32_bf16 v[172:175], a[68:71], a[52:55], v[172:175]
    v_exp_f32 v145, v145
    v_mfma_f32_16x16x32_bf16 v[160:163], a[72:75], a[8:11], v[160:163]
    buffer_load_dwordx4 a[148:151], v244, s[52:55], s51 offen
    s_add_u32 s51, s51, 1024
    v_mfma_f32_16x16x32_bf16 v[164:167], a[72:75], a[24:27], v[164:167]
    v_cvt_pk_bf16_f32 v194, v144, v145
    v_mfma_f32_16x16x32_bf16 v[168:171], a[72:75], a[40:43], v[168:171]
    v_exp_f32 v146, v146
    v_mfma_f32_16x16x32_bf16 v[172:175], a[72:75], a[56:59], v[172:175]
    v_exp_f32 v147, v147
    v_mfma_f32_16x16x32_bf16 v[160:163], a[76:79], a[12:15], v[160:163]
    v_cvt_pk_bf16_f32 v195, v146, v147
    v_mfma_f32_16x16x32_bf16 v[164:167], a[76:79], a[28:31], v[164:167]
    v_exp_f32 v132, v132
    v_mfma_f32_16x16x32_bf16 v[168:171], a[76:79], a[44:47], v[168:171]
    v_exp_f32 v133, v133
    v_mfma_f32_16x16x32_bf16 v[172:175], a[76:79], a[60:63], v[172:175]
    v_cvt_pk_bf16_f32 v196, v132, v133
    v_mfma_f32_16x16x32_bf16 v[176:179], a[80:83], a[0:3], v[224:227]
    v_exp_f32 v134, v134
    v_mfma_f32_16x16x32_bf16 v[180:183], a[80:83], a[16:19], v[228:231]
    v_exp_f32 v135, v135
    v_mfma_f32_16x16x32_bf16 v[184:187], a[80:83], a[32:35], v[232:235]
    v_cvt_pk_bf16_f32 v197, v134, v135
    v_mfma_f32_16x16x32_bf16 v[188:191], a[80:83], a[48:51], v[236:239]
    v_exp_f32 v148, v148
    v_mfma_f32_16x16x32_bf16 v[176:179], a[84:87], a[4:7], v[176:179]
    v_exp_f32 v149, v149
    v_mfma_f32_16x16x32_bf16 v[180:183], a[84:87], a[20:23], v[180:183]
    v_cvt_pk_bf16_f32 v198, v148, v149
    v_mfma_f32_16x16x32_bf16 v[184:187], a[84:87], a[36:39], v[184:187]
    v_exp_f32 v150, v150
    v_mfma_f32_16x16x32_bf16 v[188:191], a[84:87], a[52:55], v[188:191]
    v_exp_f32 v151, v151
    v_mfma_f32_16x16x32_bf16 v[176:179], a[88:91], a[8:11], v[176:179]
    v_cvt_pk_bf16_f32 v199, v150, v151
    v_mfma_f32_16x16x32_bf16 v[180:183], a[88:91], a[24:27], v[180:183]
    v_exp_f32 v136, v136
    v_mfma_f32_16x16x32_bf16 v[184:187], a[88:91], a[40:43], v[184:187]
    v_exp_f32 v137, v137
    v_mfma_f32_16x16x32_bf16 v[188:191], a[88:91], a[56:59], v[188:191]
    v_cvt_pk_bf16_f32 v200, v136, v137
    v_mfma_f32_16x16x32_bf16 v[176:179], a[92:95], a[12:15], v[176:179]
    v_exp_f32 v138, v138
    v_mfma_f32_16x16x32_bf16 v[180:183], a[92:95], a[28:31], v[180:183]
    v_exp_f32 v139, v139
    v_mfma_f32_16x16x32_bf16 v[184:187], a[92:95], a[44:47], v[184:187]
    v_cvt_pk_bf16_f32 v201, v138, v139
    v_mfma_f32_16x16x32_bf16 v[188:191], a[92:95], a[60:63], v[188:191]
    v_exp_f32 v152, v152
    s_waitcnt lgkmcnt(1)
    v_mfma_f32_16x16x32_bf16 v[0:3], a[96:99], v[208:211], v[0:3]
    v_exp_f32 v153, v153
    v_mfma_f32_16x16x32_bf16 v[4:7], a[96:99], v[212:215], v[4:7]
    v_cvt_pk_bf16_f32 v202, v152, v153
    v_mfma_f32_16x16x32_bf16 v[8:11], a[96:99], v[216:219], v[8:11]
    v_exp_f32 v154, v154
    v_mfma_f32_16x16x32_bf16 v[12:15], a[96:99], v[220:223], v[12:15]
    ds_read_b128 a[96:99], v241 offset:2048
    v_mfma_f32_16x16x32_bf16 v[28:31], a[100:103], v[220:223], v[28:31]
    v_exp_f32 v155, v155
    v_mfma_f32_16x16x32_bf16 v[24:27], a[100:103], v[216:219], v[24:27]
    v_cvt_pk_bf16_f32 v203, v154, v155
    v_mfma_f32_16x16x32_bf16 v[20:23], a[100:103], v[212:215], v[20:23]
    v_exp_f32 v140, v140
    v_mfma_f32_16x16x32_bf16 v[16:19], a[100:103], v[208:211], v[16:19]
    ds_read_b128 a[100:103], v241 offset:3072
    v_mfma_f32_16x16x32_bf16 v[32:35], a[104:107], v[208:211], v[32:35]
    v_exp_f32 v141, v141
    v_mfma_f32_16x16x32_bf16 v[36:39], a[104:107], v[212:215], v[36:39]
    v_cvt_pk_bf16_f32 v204, v140, v141
    v_mfma_f32_16x16x32_bf16 v[40:43], a[104:107], v[216:219], v[40:43]
    v_exp_f32 v142, v142
    v_mfma_f32_16x16x32_bf16 v[44:47], a[104:107], v[220:223], v[44:47]
    ds_read_b128 a[104:107], v241 offset:6144
    v_mfma_f32_16x16x32_bf16 v[60:63], a[108:111], v[220:223], v[60:63]
    v_exp_f32 v143, v143
    v_mfma_f32_16x16x32_bf16 v[56:59], a[108:111], v[216:219], v[56:59]
    v_cvt_pk_bf16_f32 v205, v142, v143
    v_mfma_f32_16x16x32_bf16 v[52:55], a[108:111], v[212:215], v[52:55]
    v_exp_f32 v156, v156
    v_mfma_f32_16x16x32_bf16 v[48:51], a[108:111], v[208:211], v[48:51]
    ds_read_b128 a[108:111], v241 offset:7168
    v_mfma_f32_16x16x32_bf16 v[64:67], a[112:115], v[208:211], v[64:67]
    v_exp_f32 v157, v157
    v_mfma_f32_16x16x32_bf16 v[68:71], a[112:115], v[212:215], v[68:71]
    v_cvt_pk_bf16_f32 v206, v156, v157
    v_mfma_f32_16x16x32_bf16 v[72:75], a[112:115], v[216:219], v[72:75]
    v_exp_f32 v158, v158
    v_mfma_f32_16x16x32_bf16 v[76:79], a[112:115], v[220:223], v[76:79]
    ds_read_b128 a[112:115], v241 offset:10240
    v_mfma_f32_16x16x32_bf16 v[92:95], a[116:119], v[220:223], v[92:95]
    v_exp_f32 v159, v159
    v_mfma_f32_16x16x32_bf16 v[88:91], a[116:119], v[216:219], v[88:91]
    v_cvt_pk_bf16_f32 v207, v158, v159
    v_mfma_f32_16x16x32_bf16 v[84:87], a[116:119], v[212:215], v[84:87]
    v_mfma_f32_16x16x32_bf16 v[80:83], a[116:119], v[208:211], v[80:83]
    ds_read_b128 a[116:119], v241 offset:11264
    v_mfma_f32_16x16x32_bf16 v[96:99], a[120:123], v[208:211], v[96:99]
    v_mfma_f32_16x16x32_bf16 v[100:103], a[120:123], v[212:215], v[100:103]
    v_mfma_f32_16x16x32_bf16 v[104:107], a[120:123], v[216:219], v[104:107]
    v_mfma_f32_16x16x32_bf16 v[108:111], a[120:123], v[220:223], v[108:111]
    ds_read_b128 a[120:123], v241 offset:14336
    s_waitcnt lgkmcnt(1)
    v_mfma_f32_16x16x32_bf16 v[124:127], a[124:127], v[220:223], v[124:127]
    v_mfma_f32_16x16x32_bf16 v[120:123], a[124:127], v[216:219], v[120:123]
    v_mfma_f32_16x16x32_bf16 v[116:119], a[124:127], v[212:215], v[116:119]
    v_mfma_f32_16x16x32_bf16 v[112:115], a[124:127], v[208:211], v[112:115]
    ds_read_b128 a[124:127], v241 offset:15360
    v_mfma_f32_16x16x32_bf16 a[128:131], a[144:147], v[208:211], a[128:131]
    v_mfma_f32_16x16x32_bf16 a[132:135], a[144:147], v[212:215], a[132:135]
    v_mfma_f32_16x16x32_bf16 a[136:139], a[144:147], v[216:219], a[136:139]
    v_mfma_f32_16x16x32_bf16 a[140:143], a[144:147], v[220:223], a[140:143]
    s_waitcnt vmcnt(16)
    s_barrier
    v_mfma_f32_16x16x32_bf16 v[0:3], a[96:99], v[192:195], v[0:3]
    v_exp_f32 v160, v160
    v_mfma_f32_16x16x32_bf16 v[4:7], a[96:99], v[196:199], v[4:7]
    v_exp_f32 v161, v161
    v_mfma_f32_16x16x32_bf16 v[8:11], a[96:99], v[200:203], v[8:11]
    v_cvt_pk_bf16_f32 v208, v160, v161
    v_mfma_f32_16x16x32_bf16 v[12:15], a[96:99], v[204:207], v[12:15]
    ds_read_b128 a[96:99], v241 offset:18432
    v_mfma_f32_16x16x32_bf16 v[28:31], a[100:103], v[204:207], v[28:31]
    v_exp_f32 v162, v162
    v_mfma_f32_16x16x32_bf16 v[24:27], a[100:103], v[200:203], v[24:27]
    v_exp_f32 v163, v163
    v_mfma_f32_16x16x32_bf16 v[20:23], a[100:103], v[196:199], v[20:23]
    v_cvt_pk_bf16_f32 v209, v162, v163
    v_mfma_f32_16x16x32_bf16 v[16:19], a[100:103], v[192:195], v[16:19]
    ds_read_b128 a[100:103], v241 offset:19456
    v_mfma_f32_16x16x32_bf16 v[32:35], a[104:107], v[192:195], v[32:35]
    v_exp_f32 v176, v176
    v_mfma_f32_16x16x32_bf16 v[36:39], a[104:107], v[196:199], v[36:39]
    v_exp_f32 v177, v177
    v_mfma_f32_16x16x32_bf16 v[40:43], a[104:107], v[200:203], v[40:43]
    v_cvt_pk_bf16_f32 v210, v176, v177
    v_mfma_f32_16x16x32_bf16 v[44:47], a[104:107], v[204:207], v[44:47]
    ds_read_b128 a[104:107], v241 offset:22528
    v_mfma_f32_16x16x32_bf16 v[60:63], a[108:111], v[204:207], v[60:63]
    v_exp_f32 v178, v178
    v_mfma_f32_16x16x32_bf16 v[56:59], a[108:111], v[200:203], v[56:59]
    v_exp_f32 v179, v179
    v_mfma_f32_16x16x32_bf16 v[52:55], a[108:111], v[196:199], v[52:55]
    v_cvt_pk_bf16_f32 v211, v178, v179
    v_mfma_f32_16x16x32_bf16 v[48:51], a[108:111], v[192:195], v[48:51]
    ds_read_b128 a[108:111], v241 offset:23552
    v_mfma_f32_16x16x32_bf16 v[64:67], a[112:115], v[192:195], v[64:67]
    v_exp_f32 v164, v164
    v_mfma_f32_16x16x32_bf16 v[68:71], a[112:115], v[196:199], v[68:71]
    v_exp_f32 v165, v165
    v_mfma_f32_16x16x32_bf16 v[72:75], a[112:115], v[200:203], v[72:75]
    v_cvt_pk_bf16_f32 v212, v164, v165
    v_mfma_f32_16x16x32_bf16 v[76:79], a[112:115], v[204:207], v[76:79]
    ds_read_b128 a[112:115], v241 offset:26624
    v_mfma_f32_16x16x32_bf16 v[92:95], a[116:119], v[204:207], v[92:95]
    v_exp_f32 v166, v166
    v_mfma_f32_16x16x32_bf16 v[88:91], a[116:119], v[200:203], v[88:91]
    v_exp_f32 v167, v167
    v_mfma_f32_16x16x32_bf16 v[84:87], a[116:119], v[196:199], v[84:87]
    v_cvt_pk_bf16_f32 v213, v166, v167
    v_mfma_f32_16x16x32_bf16 v[80:83], a[116:119], v[192:195], v[80:83]
    ds_read_b128 a[116:119], v241 offset:27648
    s_waitcnt lgkmcnt(1)
    v_mfma_f32_16x16x32_bf16 v[96:99], a[120:123], v[192:195], v[96:99]
    v_exp_f32 v180, v180
    v_mfma_f32_16x16x32_bf16 v[100:103], a[120:123], v[196:199], v[100:103]
    v_exp_f32 v181, v181
    v_mfma_f32_16x16x32_bf16 v[104:107], a[120:123], v[200:203], v[104:107]
    v_cvt_pk_bf16_f32 v214, v180, v181
    v_mfma_f32_16x16x32_bf16 v[108:111], a[120:123], v[204:207], v[108:111]
    ds_read_b128 a[120:123], v241 offset:30720
    v_mfma_f32_16x16x32_bf16 v[124:127], a[124:127], v[204:207], v[124:127]
    v_exp_f32 v182, v182
    v_mfma_f32_16x16x32_bf16 v[120:123], a[124:127], v[200:203], v[120:123]
    v_exp_f32 v183, v183
    v_mfma_f32_16x16x32_bf16 v[116:119], a[124:127], v[196:199], v[116:119]
    v_cvt_pk_bf16_f32 v215, v182, v183
    v_mfma_f32_16x16x32_bf16 v[112:115], a[124:127], v[192:195], v[112:115]
    ds_read_b128 a[124:127], v241 offset:31744
    v_mfma_f32_16x16x32_bf16 a[128:131], a[144:147], v[192:195], a[128:131]
    v_exp_f32 v168, v168
    v_mfma_f32_16x16x32_bf16 a[132:135], a[144:147], v[196:199], a[132:135]
    v_exp_f32 v169, v169
    v_mfma_f32_16x16x32_bf16 a[136:139], a[144:147], v[200:203], a[136:139]
    v_cvt_pk_bf16_f32 v216, v168, v169
    v_mfma_f32_16x16x32_bf16 a[140:143], a[144:147], v[204:207], a[140:143]
    v_exp_f32 v170, v170
    v_exp_f32 v171, v171
    s_nop 0
    v_cvt_pk_bf16_f32 v217, v170, v171
    v_exp_f32 v184, v184
    v_exp_f32 v185, v185
    s_nop 0
    v_cvt_pk_bf16_f32 v218, v184, v185
    v_exp_f32 v186, v186
    v_exp_f32 v187, v187
    s_nop 0
    v_cvt_pk_bf16_f32 v219, v186, v187
    v_exp_f32 v172, v172
    v_exp_f32 v173, v173
    s_nop 0
    v_cvt_pk_bf16_f32 v220, v172, v173
    v_exp_f32 v174, v174
    v_exp_f32 v175, v175
    s_nop 0
    v_cvt_pk_bf16_f32 v221, v174, v175
    v_exp_f32 v188, v188
    v_exp_f32 v189, v189
    s_nop 0
    v_cvt_pk_bf16_f32 v222, v188, v189
    v_exp_f32 v190, v190
    v_exp_f32 v191, v191
    s_nop 0
    v_cvt_pk_bf16_f32 v223, v190, v191
    s_cmp_lg_u32 s3, 0
    s_cbranch_scc1 pa_fc
    s_and_b32 s40, s2, 3
    s_lshl_b32 s40, s40, 1
    s_bfe_u32 s41, s2, 0x10003
    s_add_u32 s40, s40, s41
    s_lshl_b32 s40, s40, 12
    s_lshr_b32 s41, s2, 7
    s_lshl_b32 s41, s41, 11
    s_add_u32 s40, s40, s41
    s_add_u32 s40, s40, 0x2e00000
    v_lshlrev_b32 v248, 7, v240
    s_mov_b64 exec, 0xffff
    buffer_load_dword v252, v248, s[16:19], s40 offen sc1
    s_mov_b64 exec, -1
pa_fc:
    v_mfma_f32_16x16x32_bf16 a[128:131], a[144:147], v[208:211], a[128:131]
    v_mfma_f32_16x16x32_bf16 a[132:135], a[144:147], v[212:215], a[132:135]
    v_mfma_f32_16x16x32_bf16 a[136:139], a[144:147], v[216:219], a[136:139]
    v_mfma_f32_16x16x32_bf16 a[140:143], a[144:147], v[220:223], a[140:143]
    v_mfma_f32_16x16x32_bf16 v[0:3], a[96:99], v[208:211], v[0:3]
    v_mfma_f32_16x16x32_bf16 v[16:19], a[100:103], v[208:211], v[16:19]
    v_mfma_f32_16x16x32_bf16 v[32:35], a[104:107], v[208:211], v[32:35]
    v_mfma_f32_16x16x32_bf16 v[48:51], a[108:111], v[208:211], v[48:51]
    s_nop 0
    v_accvgpr_read_b32 v224, a128
    v_accvgpr_read_b32 v228, a132
    v_accvgpr_read_b32 v232, a136
    v_accvgpr_read_b32 v236, a140
    s_mov_b32 s40, 0x4e800000
    v_max3_f32 v245, v224, v228, v232
    v_cmp_gt_f32 vcc, s40, v245
    v_mfma_f32_16x16x32_bf16 v[64:67], a[112:115], v[208:211], v[64:67]
    v_cmp_gt_f32 s[62:63], s40, v236
    s_nop 4
    s_and_b64 vcc, vcc, s[62:63]
    v_cmp_o_f32 s[62:63], v224, v228
    s_nop 4
    s_and_b64 vcc, vcc, s[62:63]
    v_cmp_o_f32 s[62:63], v232, v236
    s_nop 4
    s_and_b64 vcc, vcc, s[62:63]
    s_cmp_eq_u64 vcc, -1
    s_waitcnt lgkmcnt(0)
    v_mfma_f32_16x16x32_bf16 v[80:83], a[116:119], v[208:211], v[80:83]
    s_cbranch_scc0 pa_slow
    v_rcp_f32 v226, v224
    v_rcp_f32 v230, v228
    v_rcp_f32 v234, v232
    v_rcp_f32 v238, v236
    v_fma_f32 v225, -v224, v226, 2.0
    v_mul_f32 v226, v225, v226
    v_mfma_f32_16x16x32_bf16 v[96:99], a[120:123], v[208:211], v[96:99]
    v_mov_b32 v227, v226
    v_fma_f32 v229, -v228, v230, 2.0
    v_mul_f32 v230, v229, v230
    v_mov_b32 v231, v230
    v_fma_f32 v233, -v232, v234, 2.0
    v_mul_f32 v234, v233, v234
    v_mov_b32 v235, v234
    v_mfma_f32_16x16x32_bf16 v[112:115], a[124:127], v[208:211], v[112:115]
    v_fma_f32 v237, -v236, v238, 2.0
    v_mul_f32 v238, v237, v238
    v_mov_b32 v239, v238
    v_mfma_f32_16x16x32_bf16 v[4:7], a[96:99], v[212:215], v[4:7]
    v_pk_mul_f32 v[0:1], v[0:1], v[226:227]
    v_pk_mul_f32 v[16:17], v[16:17], v[226:227]
    v_pk_mul_f32 v[2:3], v[2:3], v[226:227]
    v_pk_mul_f32 v[18:19], v[18:19], v[226:227]
    v_cvt_pk_bf16_f32 v0, v0, v1
    v_mfma_f32_16x16x32_bf16 v[20:23], a[100:103], v[212:215], v[20:23]
    v_cvt_pk_bf16_f32 v1, v2, v3
    v_cvt_pk_bf16_f32 v2, v16, v17
    v_cvt_pk_bf16_f32 v3, v18, v19
    s_add_u32 s40, s49, 0
    buffer_store_dwordx4 v[0:3], v244, s[16:19], s40 offen sc1
    v_mfma_f32_16x16x32_bf16 v[36:39], a[104:107], v[212:215], v[36:39]
    v_pk_mul_f32 v[32:33], v[32:33], v[226:227]
    v_pk_mul_f32 v[48:49], v[48:49], v[226:227]
    v_pk_mul_f32 v[34:35], v[34:35], v[226:227]
    v_pk_mul_f32 v[50:51], v[50:51], v[226:227]
    v_cvt_pk_bf16_f32 v32, v32, v33
    v_mfma_f32_16x16x32_bf16 v[52:55], a[108:111], v[212:215], v[52:55]
    v_cvt_pk_bf16_f32 v33, v34, v35
    v_cvt_pk_bf16_f32 v34, v48, v49
    v_cvt_pk_bf16_f32 v35, v50, v51
    s_add_u32 s40, s49, 2048
    buffer_store_dwordx4 v[32:35], v244, s[16:19], s40 offen sc1
    v_mfma_f32_16x16x32_bf16 v[68:71], a[112:115], v[212:215], v[68:71]
    v_pk_mul_f32 v[64:65], v[64:65], v[226:227]
    v_pk_mul_f32 v[80:81], v[80:81], v[226:227]
    v_pk_mul_f32 v[66:67], v[66:67], v[226:227]
    v_pk_mul_f32 v[82:83], v[82:83], v[226:227]
    v_cvt_pk_bf16_f32 v64, v64, v65
    v_mfma_f32_16x16x32_bf16 v[84:87], a[116:119], v[212:215], v[84:87]
    v_cvt_pk_bf16_f32 v65, v66, v67
    v_cvt_pk_bf16_f32 v66, v80, v81
    v_cvt_pk_bf16_f32 v67, v82, v83
    s_add_u32 s40, s49, 4096
    buffer_store_dwordx4 v[64:67], v244, s[16:19], s40 offen sc1
    v_mfma_f32_16x16x32_bf16 v[100:103], a[120:123], v[212:215], v[100:103]
    v_pk_mul_f32 v[96:97], v[96:97], v[226:227]
    v_pk_mul_f32 v[112:113], v[112:113], v[226:227]
    v_pk_mul_f32 v[98:99], v[98:99], v[226:227]
    v_pk_mul_f32 v[114:115], v[114:115], v[226:227]
    v_cvt_pk_bf16_f32 v96, v96, v97
    v_mfma_f32_16x16x32_bf16 v[116:119], a[124:127], v[212:215], v[116:119]
    v_cvt_pk_bf16_f32 v97, v98, v99
    v_cvt_pk_bf16_f32 v98, v112, v113
    v_cvt_pk_bf16_f32 v99, v114, v115
    s_add_u32 s40, s49, 6144
    buffer_store_dwordx4 v[96:99], v244, s[16:19], s40 offen sc1
    v_mfma_f32_16x16x32_bf16 v[8:11], a[96:99], v[216:219], v[8:11]
    v_pk_mul_f32 v[4:5], v[4:5], v[230:231]
    v_pk_mul_f32 v[20:21], v[20:21], v[230:231]
    v_pk_mul_f32 v[6:7], v[6:7], v[230:231]
    v_pk_mul_f32 v[22:23], v[22:23], v[230:231]
    v_cvt_pk_bf16_f32 v4, v4, v5
    v_mfma_f32_16x16x32_bf16 v[24:27], a[100:103], v[216:219], v[24:27]
    v_cvt_pk_bf16_f32 v5, v6, v7
    v_cvt_pk_bf16_f32 v6, v20, v21
    v_cvt_pk_bf16_f32 v7, v22, v23
    s_add_u32 s40, s49, 1024
    buffer_store_dwordx4 v[4:7], v244, s[16:19], s40 offen sc1
    v_mfma_f32_16x16x32_bf16 v[40:43], a[104:107], v[216:219], v[40:43]
    v_pk_mul_f32 v[36:37], v[36:37], v[230:231]
    v_pk_mul_f32 v[52:53], v[52:53], v[230:231]
    v_pk_mul_f32 v[38:39], v[38:39], v[230:231]
    v_pk_mul_f32 v[54:55], v[54:55], v[230:231]
    v_cvt_pk_bf16_f32 v36, v36, v37
    v_mfma_f32_16x16x32_bf16 v[56:59], a[108:111], v[216:219], v[56:59]
    v_cvt_pk_bf16_f32 v37, v38, v39
    v_cvt_pk_bf16_f32 v38, v52, v53
    v_cvt_pk_bf16_f32 v39, v54, v55
    s_add_u32 s40, s49, 3072
    buffer_store_dwordx4 v[36:39], v244, s[16:19], s40 offen sc1
    v_mfma_f32_16x16x32_bf16 v[72:75], a[112:115], v[216:219], v[72:75]
    v_pk_mul_f32 v[68:69], v[68:69], v[230:231]
    v_pk_mul_f32 v[84:85], v[84:85], v[230:231]
    v_pk_mul_f32 v[70:71], v[70:71], v[230:231]
    v_pk_mul_f32 v[86:87], v[86:87], v[230:231]
    v_cvt_pk_bf16_f32 v68, v68, v69
    v_mfma_f32_16x16x32_bf16 v[88:91], a[116:119], v[216:219], v[88:91]
    v_cvt_pk_bf16_f32 v69, v70, v71
    v_cvt_pk_bf16_f32 v70, v84, v85
    v_cvt_pk_bf16_f32 v71, v86, v87
    s_add_u32 s40, s49, 5120
    buffer_store_dwordx4 v[68:71], v244, s[16:19], s40 offen sc1
    v_mfma_f32_16x16x32_bf16 v[104:107], a[120:123], v[216:219], v[104:107]
    v_pk_mul_f32 v[100:101], v[100:101], v[230:231]
    v_pk_mul_f32 v[116:117], v[116:117], v[230:231]
    v_pk_mul_f32 v[102:103], v[102:103], v[230:231]
    v_pk_mul_f32 v[118:119], v[118:119], v[230:231]
    v_cvt_pk_bf16_f32 v100, v100, v101
    v_mfma_f32_16x16x32_bf16 v[120:123], a[124:127], v[216:219], v[120:123]
    v_cvt_pk_bf16_f32 v101, v102, v103
    v_cvt_pk_bf16_f32 v102, v116, v117
    v_cvt_pk_bf16_f32 v103, v118, v119
    s_add_u32 s40, s49, 7168
    buffer_store_dwordx4 v[100:103], v244, s[16:19], s40 offen sc1
    v_mfma_f32_16x16x32_bf16 v[12:15], a[96:99], v[220:223], v[12:15]
    v_pk_mul_f32 v[8:9], v[8:9], v[234:235]
    v_pk_mul_f32 v[24:25], v[24:25], v[234:235]
    v_pk_mul_f32 v[10:11], v[10:11], v[234:235]
    v_pk_mul_f32 v[26:27], v[26:27], v[234:235]
    v_cvt_pk_bf16_f32 v8, v8, v9
    v_mfma_f32_16x16x32_bf16 v[28:31], a[100:103], v[220:223], v[28:31]
    v_cvt_pk_bf16_f32 v9, v10, v11
    v_cvt_pk_bf16_f32 v10, v24, v25
    v_cvt_pk_bf16_f32 v11, v26, v27
    s_add_u32 s40, s49, 270336
    buffer_store_dwordx4 v[8:11], v244, s[16:19], s40 offen sc1
    v_mfma_f32_16x16x32_bf16 v[44:47], a[104:107], v[220:223], v[44:47]
    v_pk_mul_f32 v[40:41], v[40:41], v[234:235]
    v_pk_mul_f32 v[56:57], v[56:57], v[234:235]
    v_pk_mul_f32 v[42:43], v[42:43], v[234:235]
    v_pk_mul_f32 v[58:59], v[58:59], v[234:235]
    v_cvt_pk_bf16_f32 v40, v40, v41
    v_mfma_f32_16x16x32_bf16 v[60:63], a[108:111], v[220:223], v[60:63]
    v_cvt_pk_bf16_f32 v41, v42, v43
    v_cvt_pk_bf16_f32 v42, v56, v57
    v_cvt_pk_bf16_f32 v43, v58, v59
    s_add_u32 s40, s49, 272384
    buffer_store_dwordx4 v[40:43], v244, s[16:19], s40 offen sc1
    v_mfma_f32_16x16x32_bf16 v[76:79], a[112:115], v[220:223], v[76:79]
    v_pk_mul_f32 v[72:73], v[72:73], v[234:235]
    v_pk_mul_f32 v[88:89], v[88:89], v[234:235]
    v_pk_mul_f32 v[74:75], v[74:75], v[234:235]
    v_pk_mul_f32 v[90:91], v[90:91], v[234:235]
    v_cvt_pk_bf16_f32 v72, v72, v73
    v_mfma_f32_16x16x32_bf16 v[92:95], a[116:119], v[220:223], v[92:95]
    v_cvt_pk_bf16_f32 v73, v74, v75
    v_cvt_pk_bf16_f32 v74, v88, v89
    v_cvt_pk_bf16_f32 v75, v90, v91
    s_add_u32 s40, s49, 274432
    buffer_store_dwordx4 v[72:75], v244, s[16:19], s40 offen sc1
    v_mfma_f32_16x16x32_bf16 v[108:111], a[120:123], v[220:223], v[108:111]
    v_pk_mul_f32 v[104:105], v[104:105], v[234:235]
    v_pk_mul_f32 v[120:121], v[120:121], v[234:235]
    v_pk_mul_f32 v[106:107], v[106:107], v[234:235]
    v_pk_mul_f32 v[122:123], v[122:123], v[234:235]
    v_cvt_pk_bf16_f32 v104, v104, v105
    v_mfma_f32_16x16x32_bf16 v[124:127], a[124:127], v[220:223], v[124:127]
    v_cvt_pk_bf16_f32 v105, v106, v107
    v_cvt_pk_bf16_f32 v106, v120, v121
    v_cvt_pk_bf16_f32 v107, v122, v123
    s_add_u32 s40, s49, 276480
    buffer_store_dwordx4 v[104:107], v244, s[16:19], s40 offen sc1
    v_pk_mul_f32 v[12:13], v[12:13], v[238:239]
    v_pk_mul_f32 v[28:29], v[28:29], v[238:239]
    v_pk_mul_f32 v[14:15], v[14:15], v[238:239]
    v_pk_mul_f32 v[30:31], v[30:31], v[238:239]
    v_cvt_pk_bf16_f32 v12, v12, v13
    v_cvt_pk_bf16_f32 v13, v14, v15
    v_cvt_pk_bf16_f32 v14, v28, v29
    v_cvt_pk_bf16_f32 v15, v30, v31
    s_add_u32 s40, s49, 271360
    buffer_store_dwordx4 v[12:15], v244, s[16:19], s40 offen sc1
    v_pk_mul_f32 v[44:45], v[44:45], v[238:239]
    v_pk_mul_f32 v[60:61], v[60:61], v[238:239]
    v_pk_mul_f32 v[46:47], v[46:47], v[238:239]
    v_pk_mul_f32 v[62:63], v[62:63], v[238:239]
    v_cvt_pk_bf16_f32 v44, v44, v45
    v_cvt_pk_bf16_f32 v45, v46, v47
    v_cvt_pk_bf16_f32 v46, v60, v61
    v_cvt_pk_bf16_f32 v47, v62, v63
    s_add_u32 s40, s49, 273408
    buffer_store_dwordx4 v[44:47], v244, s[16:19], s40 offen sc1
    v_pk_mul_f32 v[76:77], v[76:77], v[238:239]
    v_pk_mul_f32 v[92:93], v[92:93], v[238:239]
    v_pk_mul_f32 v[78:79], v[78:79], v[238:239]
    v_pk_mul_f32 v[94:95], v[94:95], v[238:239]
    v_cvt_pk_bf16_f32 v76, v76, v77
    v_cvt_pk_bf16_f32 v77, v78, v79
    v_cvt_pk_bf16_f32 v78, v92, v93
    v_cvt_pk_bf16_f32 v79, v94, v95
    s_add_u32 s40, s49, 275456
    buffer_store_dwordx4 v[76:79], v244, s[16:19], s40 offen sc1
    v_pk_mul_f32 v[108:109], v[108:109], v[238:239]
    v_pk_mul_f32 v[124:125], v[124:125], v[238:239]
    v_pk_mul_f32 v[110:111], v[110:111], v[238:239]
    v_pk_mul_f32 v[126:127], v[126:127], v[238:239]
    v_cvt_pk_bf16_f32 v108, v108, v109
    v_cvt_pk_bf16_f32 v109, v110, v111
    v_cvt_pk_bf16_f32 v110, v124, v125
    v_cvt_pk_bf16_f32 v111, v126, v127
    s_add_u32 s40, s49, 277504
    buffer_store_dwordx4 v[108:111], v244, s[16:19], s40 offen sc1
pa_oend:
    s_waitcnt vmcnt(17)
    s_load_dwordx2 s[4:5], s[0:1], 32
    s_load_dwordx4 s[40:43], s[0:1], 64
    s_load_dwordx2 s[44:45], s[0:1], 80
    s_load_dwordx2 s[6:7], s[0:1], 96
    s_load_dwordx2 s[48:49], s[0:1], 0
    s_getreg_b32 s91, hwreg(HW_REG_XCC_ID, 0, 4)
    v_mov_b32 v224, v240
    s_bfe_u32 s33, s2, 0x10002
    s_and_b32 s31, s2, 3
    s_lshr_b32 s32, s2, 3
    s_lshr_b32 s37, s2, 7
    s_lshl_b32 s34, s31, 1
    s_and_b32 s35, s32, 1
    s_add_u32 s34, s34, s35
    s_bfe_u32 s35, s32, 0x30001
    s_lshl_b32 s39, s34, 3
    s_add_u32 s39, s39, s35
    s_lshl_b32 s39, s39, 1
    s_add_u32 s39, s39, s37
    v_lshrrev_b32 v230, 4, v224
    v_and_b32 v231, 15, v224
    v_lshlrev_b32 v227, 14, v230
    s_lshl_b32 s31, s37, 3
    v_xor_b32 v232, s31, v231
    v_lshl_add_u32 v227, v232, 4, v227
    v_and_b32 v232, 1, v230
    v_lshlrev_b32 v232, 2, v232
    v_bfe_u32 v233, v224, 2, 2
    v_add_u32 v232, v232, v233
    v_mul_u32_u24 v225, 1056, v232
    v_lshrrev_b32 v232, 1, v230
    v_lshl_add_u32 v225, v232, 8, v225
    v_and_b32 v232, 3, v224
    v_lshl_add_u32 v225, v232, 3, v225
    v_add_u32 v235, 992, v227
    v_lshlrev_b32 v229, 4, v224
    v_lshlrev_b32 v237, 3, v230
    v_mov_b32 v240, 0
    v_mov_b32 v236, 0
    v_mov_b32 v242, 0
    s_waitcnt lgkmcnt(0)
    s_cmp_lg_u32 s3, 0
    s_cbranch_scc1 pb_dec
    s_waitcnt vmcnt(16)
    s_mov_b64 exec, 0xffff
    v_cmp_ne_u32 vcc, s100, v252
    s_mov_b64 exec, -1
    s_nop 3
    s_cmp_eq_u64 vcc, 0
    s_cselect_b32 s63, 1, 0
    s_cmp_eq_u32 s33, 0
    s_cselect_b32 s63, s63, 0
    v_mov_b32 v232, s63
    v_mov_b32 v233, 135428
    ds_write_b32 v233, v232
    s_waitcnt lgkmcnt(0)
pb_dec:
    s_barrier
    v_mov_b32 v233, 135428
    ds_read_b32 v232, v233
    s_waitcnt lgkmcnt(0)
    v_readfirstlane_b32 s63, v232
    s_cmp_eq_u32 s33, 1
    s_cselect_b32 s8, s4, s40
    s_cselect_b32 s9, s5, s41
    s_mov_b32 s10, 0x700000
    s_cselect_b32 s10, 0x800000, s10
    s_mov_b32 s11, 0x20000
    s_mov_b32 s92, 0x1c000
    s_cselect_b32 s92, 0x20000, s92
    s_mov_b32 s32, 0x3a000
    s_cselect_b32 s32, 0x42000, s32
    s_mov_b32 s55, 0x1900000
    s_cselect_b32 s55, 0x800000, s55
    s_cselect_b32 s36, 7, 6
    s_cselect_b32 s16, s48, s42
    s_cselect_b32 s17, s49, s43
    s_mov_b32 s18, 0x800
    s_cselect_b32 s18, 0x400000, s18
    s_mov_b32 s19, 0x20000
    s_lshl_b32 s31, s34, 2
    s_add_u32 s31, s31, s3
    s_lshl_b32 s31, s31, 1
    s_mul_i32 s28, s31, s32
    s_add_u32 s28, s28, s55
    s_mul_i32 s31, s37, s92
    s_add_u32 s28, s28, s31
    s_add_u32 s56, s6, s28
    s_addc_u32 s57, s7, 0
    s_mov_b32 s58, s92
    s_mov_b32 s59, 0x20000
    s_add_u32 s96, s56, s32
    s_addc_u32 s97, s57, 0
    s_mov_b32 s98, s92
    s_mov_b32 s99, 0x20000
    s_mov_b32 s28, 0
    s_lshl_b32 s31, s92, 5
    s_mul_i32 s32, s31, s37
    s_add_u32 s8, s8, s32
    s_addc_u32 s9, s9, 0
    s_mov_b32 s10, s31
    s_lshl_b32 s29, s35, 8
    s_lshl_b32 s31, s37, 7
    s_add_u32 s90, s29, s31
    s_lshl_b32 s31, s3, 12
    s_add_u32 s29, s29, s31
    s_mul_i32 s30, s3, 2112
    s_add_u32 m0, s30, 0
    s_nop 0
    buffer_load_dwordx4 v227, s[8:11], s29 offen lds
    s_mov_b32 s12, s6
    s_mov_b32 s13, s7
    s_mov_b32 s14, 0x10000000
    s_mov_b32 s15, 0x20000
    s_mov_b32 s20, s44
    s_mov_b32 s21, s45
    s_mov_b32 s22, 0x400000
    s_mov_b32 s23, 0x20000
    s_lshl_b32 s38, s39, 15
    s_lshl_b32 s31, s3, 13
    s_add_u32 s38, s38, s31
    s_add_u32 s38, s38, 0x2800000
    s_lshl_b32 s50, s34, 19
    s_lshl_b32 s31, s3, 17
    s_add_u32 s50, s50, s31
    s_add_u32 s50, s50, s90
    s_lshl_b32 s60, s39, 2
    buffer_load_dwordx4 v235, s[8:11], s29 offen offset:1056 lds
    s_add_u32 s29, s29, 65536
    s_add_u32 s60, s60, s3
    s_lshl_b32 s60, s60, 7
    s_add_u32 s60, s60, 0x2f38000
    s_lshl_b32 s61, s2, 7
    s_xor_b32 s62, s61, 16384
    s_add_u32 s89, s62, 0x2f10000
    s_add_u32 s32, s61, 0x2f10000
    s_mul_i32 s31, s3, 32768
    s_add_u32 s31, s31, 0x2f18000
    s_add_u32 s61, s61, s31
    s_add_u32 s62, s62, s31
    v_mov_b32 v244, s100
    v_mov_b32 v245, s91
    s_mul_i32 s51, s2, 33792
    s_xor_b32 s88, s2, 128
    s_mul_i32 s88, s88, 33792
    s_lshl_b32 s31, s3, 13
    s_add_u32 m0, s30, 8448
    s_nop 0
    buffer_load_dwordx4 v227, s[8:11], s29 offen lds
    s_add_u32 s31, s31, 0x6000000
    s_add_u32 s51, s51, s31
    s_add_u32 s88, s88, s31
    s_add_u32 s24, s6, s51
    s_addc_u32 s25, s7, 0
    s_mov_b32 s26, 8192
    s_mov_b32 s27, 0x20000
    s_lshl_b32 s93, s36, 13
    s_sub_u32 s93, 0, s93
    s_mov_b32 s94, 4096
    v_lshlrev_b32 v234, 11, v231
    v_and_b32 v232, 1, v230
    v_lshl_add_u32 v234, v232, 5, v234
    v_lshrrev_b32 v232, 1, v230
    v_lshl_add_u32 v234, v232, 4, v234
    v_mov_b32 v0, 0
    v_mov_b32 v1, 0
    buffer_load_dwordx4 v235, s[8:11], s29 offen offset:1056 lds
    s_add_u32 s29, s29, 65536
    v_mov_b32 v2, 0
    v_mov_b32 v3, 0
    v_mov_b32 v4, 0
    v_mov_b32 v5, 0
    v_mov_b32 v6, 0
    v_mov_b32 v7, 0
    v_mov_b32 v8, 0
    v_mov_b32 v9, 0
    v_mov_b32 v10, 0
    v_mov_b32 v11, 0
    v_mov_b32 v12, 0
    v_mov_b32 v13, 0
    v_mov_b32 v14, 0
    v_mov_b32 v15, 0
    v_mov_b32 v16, 0
    v_mov_b32 v17, 0
    v_mov_b32 v18, 0
    s_add_u32 m0, s30, 16896
    s_nop 0
    buffer_load_dwordx4 v227, s[8:11], s29 offen lds
    v_mov_b32 v19, 0
    v_mov_b32 v20, 0
    v_mov_b32 v21, 0
    v_mov_b32 v22, 0
    v_mov_b32 v23, 0
    v_mov_b32 v24, 0
    v_mov_b32 v25, 0
    v_mov_b32 v26, 0
    v_mov_b32 v27, 0
    v_mov_b32 v28, 0
    v_mov_b32 v29, 0
    v_mov_b32 v30, 0
    v_mov_b32 v31, 0
    v_mov_b32 v32, 0
    v_mov_b32 v33, 0
    v_mov_b32 v34, 0
    v_mov_b32 v35, 0
    buffer_load_dwordx4 v235, s[8:11], s29 offen offset:1056 lds
    s_add_u32 s29, s29, 65536
    v_mov_b32 v36, 0
    v_mov_b32 v37, 0
    v_mov_b32 v38, 0
    v_mov_b32 v39, 0
    v_mov_b32 v40, 0
    v_mov_b32 v41, 0
    v_mov_b32 v42, 0
    v_mov_b32 v43, 0
    v_mov_b32 v44, 0
    v_mov_b32 v45, 0
    v_mov_b32 v46, 0
    v_mov_b32 v47, 0
    v_mov_b32 v48, 0
    v_mov_b32 v49, 0
    v_mov_b32 v50, 0
    v_mov_b32 v51, 0
    v_mov_b32 v52, 0
    s_add_u32 m0, s30, 25344
    s_nop 0
    buffer_load_dwordx4 v227, s[8:11], s29 offen lds
    v_mov_b32 v53, 0
    v_mov_b32 v54, 0
    v_mov_b32 v55, 0
    v_mov_b32 v56, 0
    v_mov_b32 v57, 0
    v_mov_b32 v58, 0
    v_mov_b32 v59, 0
    v_mov_b32 v60, 0
    v_mov_b32 v61, 0
    v_mov_b32 v62, 0
    v_mov_b32 v63, 0
    v_mov_b32 v64, 0
    v_mov_b32 v65, 0
    v_mov_b32 v66, 0
    v_mov_b32 v67, 0
    v_mov_b32 v68, 0
    v_mov_b32 v69, 0
    buffer_load_dwordx4 v235, s[8:11], s29 offen offset:1056 lds
    s_add_u32 s29, s29, 65536
    v_mov_b32 v70, 0
    v_mov_b32 v71, 0
    v_mov_b32 v72, 0
    v_mov_b32 v73, 0
    v_mov_b32 v74, 0
    v_mov_b32 v75, 0
    v_mov_b32 v76, 0
    v_mov_b32 v77, 0
    v_mov_b32 v78, 0
    v_mov_b32 v79, 0
    v_mov_b32 v80, 0
    v_mov_b32 v81, 0
    v_mov_b32 v82, 0
    v_mov_b32 v83, 0
    v_mov_b32 v84, 0
    v_mov_b32 v85, 0
    v_mov_b32 v86, 0
    s_add_u32 m0, s30, 33792
    s_nop 0
    buffer_load_dwordx4 v227, s[8:11], s29 offen lds
    v_mov_b32 v87, 0
    v_mov_b32 v88, 0
    v_mov_b32 v89, 0
    v_mov_b32 v90, 0
    v_mov_b32 v91, 0
    v_mov_b32 v92, 0
    v_mov_b32 v93, 0
    v_mov_b32 v94, 0
    v_mov_b32 v95, 0
    v_mov_b32 v96, 0
    v_mov_b32 v97, 0
    v_mov_b32 v98, 0
    v_mov_b32 v99, 0
    v_mov_b32 v100, 0
    v_mov_b32 v101, 0
    v_mov_b32 v102, 0
    v_mov_b32 v103, 0
    buffer_load_dwordx4 v235, s[8:11], s29 offen offset:1056 lds
    s_add_u32 s29, s29, 65536
    v_mov_b32 v104, 0
    v_mov_b32 v105, 0
    v_mov_b32 v106, 0
    v_mov_b32 v107, 0
    v_mov_b32 v108, 0
    v_mov_b32 v109, 0
    v_mov_b32 v110, 0
    v_mov_b32 v111, 0
    v_mov_b32 v112, 0
    v_mov_b32 v113, 0
    v_mov_b32 v114, 0
    v_mov_b32 v115, 0
    v_mov_b32 v116, 0
    v_mov_b32 v117, 0
    v_mov_b32 v118, 0
    v_mov_b32 v119, 0
    v_mov_b32 v120, 0
    s_add_u32 m0, s30, 42240
    s_nop 0
    buffer_load_dwordx4 v227, s[8:11], s29 offen lds
    v_mov_b32 v121, 0
    v_mov_b32 v122, 0
    v_mov_b32 v123, 0
    v_mov_b32 v124, 0
    v_mov_b32 v125, 0
    v_mov_b32 v126, 0
    v_mov_b32 v127, 0
    buffer_load_dwordx4 v235, s[8:11], s29 offen offset:1056 lds
    s_add_u32 s29, s29, 65536
    s_cmp_lg_u32 s63, 0
    s_cselect_b32 s52, 0, 0x7f000000
    s_cselect_b32 s28, 6144, 0
    buffer_load_dwordx4 a[32:35], v229, s[56:59], s52 offen offset:0 sc1
    buffer_load_dwordx4 a[36:39], v229, s[56:59], s52 offen offset:1024 sc1
    buffer_load_dwordx4 a[40:43], v229, s[96:99], s52 offen offset:0 sc1
    buffer_load_dwordx4 a[44:47], v229, s[96:99], s52 offen offset:1024 sc1
    s_add_u32 s52, s52, 2048
    buffer_load_dwordx4 a[48:51], v229, s[56:59], s52 offen offset:0 sc1
    buffer_load_dwordx4 a[52:55], v229, s[56:59], s52 offen offset:1024 sc1
    buffer_load_dwordx4 a[56:59], v229, s[96:99], s52 offen offset:0 sc1
    buffer_load_dwordx4 a[60:63], v229, s[96:99], s52 offen offset:1024 sc1
    s_add_u32 s52, s52, 2048
    buffer_load_dwordx4 a[64:67], v229, s[56:59], s52 offen offset:0 sc1
    buffer_load_dwordx4 a[68:71], v229, s[56:59], s52 offen offset:1024 sc1
    buffer_load_dwordx4 a[72:75], v229, s[96:99], s52 offen offset:0 sc1
    buffer_load_dwordx4 a[76:79], v229, s[96:99], s52 offen offset:1024 sc1
    s_add_u32 s52, s52, 2048
    s_waitcnt vmcnt(24)
    s_barrier
    s_cmp_lg_u32 s3, 0
    s_cbranch_scc1 pb_xpub
    s_mov_b64 exec, 1
    buffer_store_dword v244, v240, s[12:15], s101 offen sc1
    s_mov_b64 exec, -1
pb_xpub:
    s_waitcnt vmcnt(20)
    s_cmp_lg_u32 s63, 0
    s_cbranch_scc1 pb_fdr
    s_cmp_lg_u32 s3, 0
    s_cbranch_scc1 pb_fdr
    s_mov_b64 exec, 0xffff
    v_lshlrev_b32 v233, 7, v224
    s_lshl_b32 s52, s34, 12
    s_add_u32 s52, s52, 0x2f08000
    s_lshl_b32 s53, s37, 11
    s_add_u32 s52, s52, s53
    s_mov_b32 s53, 0x80000
pb_fdp:
    buffer_load_dword v232, v233, s[12:15], s52 offen sc1
    s_waitcnt vmcnt(0)
    v_cmp_ne_u32 vcc, s100, v232
    s_nop 4
    s_cbranch_vccz pb_fdq
    s_sleep 2
    s_sub_u32 s53, s53, 1
    s_cmp_lg_u32 s53, 0
    s_cbranch_scc1 pb_fdp
pb_fdq:
    s_mov_b64 exec, -1
pb_fdr:
    s_barrier
    s_cmp_lg_u32 s63, 0
    s_cbranch_scc1 pb_have
    buffer_load_dwordx4 a[32:35], v229, s[56:59], s28 offen offset:0 sc1
    buffer_load_dwordx4 a[36:39], v229, s[56:59], s28 offen offset:1024 sc1
    buffer_load_dwordx4 a[40:43], v229, s[96:99], s28 offen offset:0 sc1
    buffer_load_dwordx4 a[44:47], v229, s[96:99], s28 offen offset:1024 sc1
    s_add_u32 s28, s28, 2048
    buffer_load_dwordx4 a[48:51], v229, s[56:59], s28 offen offset:0 sc1
    buffer_load_dwordx4 a[52:55], v229, s[56:59], s28 offen offset:1024 sc1
    buffer_load_dwordx4 a[56:59], v229, s[96:99], s28 offen offset:0 sc1
    buffer_load_dwordx4 a[60:63], v229, s[96:99], s28 offen offset:1024 sc1
    s_add_u32 s28, s28, 2048
    buffer_load_dwordx4 a[64:67], v229, s[56:59], s28 offen offset:0 sc1
    buffer_load_dwordx4 a[68:71], v229, s[56:59], s28 offen offset:1024 sc1
    buffer_load_dwordx4 a[72:75], v229, s[96:99], s28 offen offset:0 sc1
    buffer_load_dwordx4 a[76:79], v229, s[96:99], s28 offen offset:1024 sc1
    s_add_u32 s28, s28, 2048
pb_have:
    buffer_load_dwordx2 v[246:247], v237, s[16:19], s90 offen offset:0
    buffer_load_dwordx2 v[248:249], v237, s[16:19], s90 offen offset:32
    buffer_load_dwordx2 v[250:251], v237, s[16:19], s90 offen offset:64
    buffer_load_dwordx2 v[252:253], v237, s[16:19], s90 offen offset:96
    ds_read_b64_tr_b16 a[0:1], v225 offset:0
    ds_read_b64_tr_b16 a[2:3], v225 offset:512
    ds_read_b64_tr_b16 a[4:5], v225 offset:32
    ds_read_b64_tr_b16 a[6:7], v225 offset:544
    ds_read_b64_tr_b16 a[8:9], v225 offset:64
    ds_read_b64_tr_b16 a[10:11], v225 offset:576
    ds_read_b64_tr_b16 a[12:13], v225 offset:96
    ds_read_b64_tr_b16 a[14:15], v225 offset:608
    ds_read_b64_tr_b16 a[16:17], v225 offset:128
    ds_read_b64_tr_b16 a[18:19], v225 offset:640
    ds_read_b64_tr_b16 a[20:21], v225 offset:160
    ds_read_b64_tr_b16 a[22:23], v225 offset:672
    ds_read_b64_tr_b16 a[24:25], v225 offset:192
    ds_read_b64_tr_b16 a[26:27], v225 offset:704
    ds_read_b64_tr_b16 a[28:29], v225 offset:224
    ds_read_b64_tr_b16 a[30:31], v225 offset:736
    s_getpc_b64 s[40:41]
pa_start_pc3:
    s_sub_u32 s40, s40, pa_start_pc3-pa_start
    s_subb_u32 s41, s41, 0
    s_mov_b32 s42, code_end_label-pa_start
    s_mov_b32 s43, 0x20000
    s_lshr_b32 s44, s2, 3
    s_lshl_b32 s44, s44, 2
    s_add_u32 s44, s44, s3
    s_lshl_b32 s44, s44, 10
pb_g2:
    s_waitcnt vmcnt(22)
    s_barrier
    s_waitcnt vmcnt(15) lgkmcnt(8)
    v_mfma_f32_16x16x32_bf16 v[0:3], a[0:3], a[32:35], v[0:3]
    s_add_u32 m0, s30, 50688
    s_waitcnt vmcnt(14)
    v_mfma_f32_16x16x32_bf16 v[4:7], a[0:3], a[36:39], v[4:7]
    buffer_load_dwordx4 v227, s[8:11], s29 offen lds
    s_waitcnt vmcnt(14)
    v_mfma_f32_16x16x32_bf16 v[8:11], a[0:3], a[40:43], v[8:11]
    s_waitcnt vmcnt(13)
    v_mfma_f32_16x16x32_bf16 v[12:15], a[0:3], a[44:47], v[12:15]
    ds_read_b64_tr_b16 a[0:1], v225 offset:8448
    v_mfma_f32_16x16x32_bf16 v[28:31], a[4:7], a[44:47], v[28:31]
    ds_read_b64_tr_b16 a[2:3], v225 offset:8960
    v_mfma_f32_16x16x32_bf16 v[24:27], a[4:7], a[40:43], v[24:27]
    buffer_load_dwordx4 v235, s[8:11], s29 offen offset:1056 lds
    v_mfma_f32_16x16x32_bf16 v[20:23], a[4:7], a[36:39], v[20:23]
    s_add_u32 s29, s29, 65536
    v_mfma_f32_16x16x32_bf16 v[16:19], a[4:7], a[32:35], v[16:19]
    ds_read_b64_tr_b16 a[4:5], v225 offset:8480
    v_mfma_f32_16x16x32_bf16 v[32:35], a[8:11], a[32:35], v[32:35]
    ds_read_b64_tr_b16 a[6:7], v225 offset:8992
    v_mfma_f32_16x16x32_bf16 v[36:39], a[8:11], a[36:39], v[36:39]
    buffer_load_dwordx4 a[80:83], v229, s[56:59], s28 offen offset:0 sc1
    v_mfma_f32_16x16x32_bf16 v[40:43], a[8:11], a[40:43], v[40:43]
    v_mfma_f32_16x16x32_bf16 v[44:47], a[8:11], a[44:47], v[44:47]
    ds_read_b64_tr_b16 a[8:9], v225 offset:8512
    v_mfma_f32_16x16x32_bf16 v[60:63], a[12:15], a[44:47], v[60:63]
    ds_read_b64_tr_b16 a[10:11], v225 offset:9024
    v_mfma_f32_16x16x32_bf16 v[56:59], a[12:15], a[40:43], v[56:59]
    buffer_load_dwordx4 a[84:87], v229, s[56:59], s28 offen offset:1024 sc1
    v_mfma_f32_16x16x32_bf16 v[52:55], a[12:15], a[36:39], v[52:55]
    v_mfma_f32_16x16x32_bf16 v[48:51], a[12:15], a[32:35], v[48:51]
    ds_read_b64_tr_b16 a[12:13], v225 offset:8544
    s_waitcnt lgkmcnt(7)
    v_mfma_f32_16x16x32_bf16 v[64:67], a[16:19], a[32:35], v[64:67]
    ds_read_b64_tr_b16 a[14:15], v225 offset:9056
    v_mfma_f32_16x16x32_bf16 v[68:71], a[16:19], a[36:39], v[68:71]
    buffer_load_dwordx4 a[88:91], v229, s[96:99], s28 offen offset:0 sc1
    v_mfma_f32_16x16x32_bf16 v[72:75], a[16:19], a[40:43], v[72:75]
    v_mfma_f32_16x16x32_bf16 v[76:79], a[16:19], a[44:47], v[76:79]
    ds_read_b64_tr_b16 a[16:17], v225 offset:8576
    v_mfma_f32_16x16x32_bf16 v[92:95], a[20:23], a[44:47], v[92:95]
    ds_read_b64_tr_b16 a[18:19], v225 offset:9088
    v_mfma_f32_16x16x32_bf16 v[88:91], a[20:23], a[40:43], v[88:91]
    buffer_load_dwordx4 a[92:95], v229, s[96:99], s28 offen offset:1024 sc1
    v_mfma_f32_16x16x32_bf16 v[84:87], a[20:23], a[36:39], v[84:87]
    v_mfma_f32_16x16x32_bf16 v[80:83], a[20:23], a[32:35], v[80:83]
    ds_read_b64_tr_b16 a[20:21], v225 offset:8608
    v_mfma_f32_16x16x32_bf16 v[96:99], a[24:27], a[32:35], v[96:99]
    ds_read_b64_tr_b16 a[22:23], v225 offset:9120
    v_mfma_f32_16x16x32_bf16 v[100:103], a[24:27], a[36:39], v[100:103]
    v_mfma_f32_16x16x32_bf16 v[104:107], a[24:27], a[40:43], v[104:107]
    v_mfma_f32_16x16x32_bf16 v[108:111], a[24:27], a[44:47], v[108:111]
    ds_read_b64_tr_b16 a[24:25], v225 offset:8640
    v_mfma_f32_16x16x32_bf16 v[124:127], a[28:31], a[44:47], v[124:127]
    ds_read_b64_tr_b16 a[26:27], v225 offset:9152
    v_mfma_f32_16x16x32_bf16 v[120:123], a[28:31], a[40:43], v[120:123]
    v_mfma_f32_16x16x32_bf16 v[116:119], a[28:31], a[36:39], v[116:119]
    s_add_u32 s28, s28, 2048
    v_mfma_f32_16x16x32_bf16 v[112:115], a[28:31], a[32:35], v[112:115]
    ds_read_b64_tr_b16 a[28:29], v225 offset:8672
    ds_read_b64_tr_b16 a[30:31], v225 offset:9184
    s_waitcnt vmcnt(15) lgkmcnt(8)
    v_mfma_f32_16x16x32_bf16 v[0:3], a[0:3], a[48:51], v[0:3]
    s_add_u32 m0, s30, 59136
    s_waitcnt vmcnt(14)
    v_mfma_f32_16x16x32_bf16 v[4:7], a[0:3], a[52:55], v[4:7]
    buffer_load_dwordx4 v227, s[8:11], s29 offen lds
    s_waitcnt vmcnt(14)
    v_mfma_f32_16x16x32_bf16 v[8:11], a[0:3], a[56:59], v[8:11]
    s_waitcnt vmcnt(13)
    v_mfma_f32_16x16x32_bf16 v[12:15], a[0:3], a[60:63], v[12:15]
    ds_read_b64_tr_b16 a[0:1], v225 offset:16896
    v_mfma_f32_16x16x32_bf16 v[28:31], a[4:7], a[60:63], v[28:31]
    ds_read_b64_tr_b16 a[2:3], v225 offset:17408
    v_mfma_f32_16x16x32_bf16 v[24:27], a[4:7], a[56:59], v[24:27]
    buffer_load_dwordx4 v235, s[8:11], s29 offen offset:1056 lds
    v_mfma_f32_16x16x32_bf16 v[20:23], a[4:7], a[52:55], v[20:23]
    s_add_u32 s29, s29, 65536
    v_mfma_f32_16x16x32_bf16 v[16:19], a[4:7], a[48:51], v[16:19]
    ds_read_b64_tr_b16 a[4:5], v225 offset:16928
    v_mfma_f32_16x16x32_bf16 v[32:35], a[8:11], a[48:51], v[32:35]
    ds_read_b64_tr_b16 a[6:7], v225 offset:17440
    v_mfma_f32_16x16x32_bf16 v[36:39], a[8:11], a[52:55], v[36:39]
    buffer_load_dwordx4 a[96:99], v229, s[56:59], s28 offen offset:0 sc1
    v_mfma_f32_16x16x32_bf16 v[40:43], a[8:11], a[56:59], v[40:43]
    v_mfma_f32_16x16x32_bf16 v[44:47], a[8:11], a[60:63], v[44:47]
    ds_read_b64_tr_b16 a[8:9], v225 offset:16960
    v_mfma_f32_16x16x32_bf16 v[60:63], a[12:15], a[60:63], v[60:63]
    ds_read_b64_tr_b16 a[10:11], v225 offset:17472
    v_mfma_f32_16x16x32_bf16 v[56:59], a[12:15], a[56:59], v[56:59]
    buffer_load_dwordx4 a[100:103], v229, s[56:59], s28 offen offset:1024 sc1
    v_mfma_f32_16x16x32_bf16 v[52:55], a[12:15], a[52:55], v[52:55]
    v_mfma_f32_16x16x32_bf16 v[48:51], a[12:15], a[48:51], v[48:51]
    ds_read_b64_tr_b16 a[12:13], v225 offset:16992
    s_waitcnt lgkmcnt(7)
    v_mfma_f32_16x16x32_bf16 v[64:67], a[16:19], a[48:51], v[64:67]
    ds_read_b64_tr_b16 a[14:15], v225 offset:17504
    v_mfma_f32_16x16x32_bf16 v[68:71], a[16:19], a[52:55], v[68:71]
    buffer_load_dwordx4 a[104:107], v229, s[96:99], s28 offen offset:0 sc1
    v_mfma_f32_16x16x32_bf16 v[72:75], a[16:19], a[56:59], v[72:75]
    v_mfma_f32_16x16x32_bf16 v[76:79], a[16:19], a[60:63], v[76:79]
    ds_read_b64_tr_b16 a[16:17], v225 offset:17024
    v_mfma_f32_16x16x32_bf16 v[92:95], a[20:23], a[60:63], v[92:95]
    ds_read_b64_tr_b16 a[18:19], v225 offset:17536
    v_mfma_f32_16x16x32_bf16 v[88:91], a[20:23], a[56:59], v[88:91]
    buffer_load_dwordx4 a[108:111], v229, s[96:99], s28 offen offset:1024 sc1
    v_mfma_f32_16x16x32_bf16 v[84:87], a[20:23], a[52:55], v[84:87]
    v_mfma_f32_16x16x32_bf16 v[80:83], a[20:23], a[48:51], v[80:83]
    ds_read_b64_tr_b16 a[20:21], v225 offset:17056
    v_mfma_f32_16x16x32_bf16 v[96:99], a[24:27], a[48:51], v[96:99]
    ds_read_b64_tr_b16 a[22:23], v225 offset:17568
    v_mfma_f32_16x16x32_bf16 v[100:103], a[24:27], a[52:55], v[100:103]
    v_mfma_f32_16x16x32_bf16 v[104:107], a[24:27], a[56:59], v[104:107]
    v_mfma_f32_16x16x32_bf16 v[108:111], a[24:27], a[60:63], v[108:111]
    ds_read_b64_tr_b16 a[24:25], v225 offset:17088
    v_mfma_f32_16x16x32_bf16 v[124:127], a[28:31], a[60:63], v[124:127]
    ds_read_b64_tr_b16 a[26:27], v225 offset:17600
    v_mfma_f32_16x16x32_bf16 v[120:123], a[28:31], a[56:59], v[120:123]
    v_mfma_f32_16x16x32_bf16 v[116:119], a[28:31], a[52:55], v[116:119]
    s_add_u32 s28, s28, 2048
    v_mfma_f32_16x16x32_bf16 v[112:115], a[28:31], a[48:51], v[112:115]
    ds_read_b64_tr_b16 a[28:29], v225 offset:17120
    ds_read_b64_tr_b16 a[30:31], v225 offset:17632
    s_barrier
    s_waitcnt vmcnt(15) lgkmcnt(8)
    v_mfma_f32_16x16x32_bf16 v[0:3], a[0:3], a[64:67], v[0:3]
    s_add_u32 m0, s30, 0
    s_waitcnt vmcnt(14)
    v_mfma_f32_16x16x32_bf16 v[4:7], a[0:3], a[68:71], v[4:7]
    buffer_load_dwordx4 v227, s[8:11], s29 offen lds
    s_waitcnt vmcnt(14)
    v_mfma_f32_16x16x32_bf16 v[8:11], a[0:3], a[72:75], v[8:11]
    s_waitcnt vmcnt(13)
    v_mfma_f32_16x16x32_bf16 v[12:15], a[0:3], a[76:79], v[12:15]
    ds_read_b64_tr_b16 a[0:1], v225 offset:25344
    v_mfma_f32_16x16x32_bf16 v[28:31], a[4:7], a[76:79], v[28:31]
    ds_read_b64_tr_b16 a[2:3], v225 offset:25856
    v_mfma_f32_16x16x32_bf16 v[24:27], a[4:7], a[72:75], v[24:27]
    buffer_load_dwordx4 v235, s[8:11], s29 offen offset:1056 lds
    v_mfma_f32_16x16x32_bf16 v[20:23], a[4:7], a[68:71], v[20:23]
    s_add_u32 s29, s29, 65536
    v_mfma_f32_16x16x32_bf16 v[16:19], a[4:7], a[64:67], v[16:19]
    ds_read_b64_tr_b16 a[4:5], v225 offset:25376
    v_mfma_f32_16x16x32_bf16 v[32:35], a[8:11], a[64:67], v[32:35]
    ds_read_b64_tr_b16 a[6:7], v225 offset:25888
    v_mfma_f32_16x16x32_bf16 v[36:39], a[8:11], a[68:71], v[36:39]
    buffer_load_dwordx4 a[112:115], v229, s[56:59], s28 offen offset:0 sc1
    v_mfma_f32_16x16x32_bf16 v[40:43], a[8:11], a[72:75], v[40:43]
    v_mfma_f32_16x16x32_bf16 v[44:47], a[8:11], a[76:79], v[44:47]
    ds_read_b64_tr_b16 a[8:9], v225 offset:25408
    v_mfma_f32_16x16x32_bf16 v[60:63], a[12:15], a[76:79], v[60:63]
    ds_read_b64_tr_b16 a[10:11], v225 offset:25920
    v_mfma_f32_16x16x32_bf16 v[56:59], a[12:15], a[72:75], v[56:59]
    buffer_load_dwordx4 a[116:119], v229, s[56:59], s28 offen offset:1024 sc1
    v_mfma_f32_16x16x32_bf16 v[52:55], a[12:15], a[68:71], v[52:55]
    v_mfma_f32_16x16x32_bf16 v[48:51], a[12:15], a[64:67], v[48:51]
    ds_read_b64_tr_b16 a[12:13], v225 offset:25440
    s_waitcnt lgkmcnt(7)
    v_mfma_f32_16x16x32_bf16 v[64:67], a[16:19], a[64:67], v[64:67]
    ds_read_b64_tr_b16 a[14:15], v225 offset:25952
    v_mfma_f32_16x16x32_bf16 v[68:71], a[16:19], a[68:71], v[68:71]
    buffer_load_dwordx4 a[120:123], v229, s[96:99], s28 offen offset:0 sc1
    v_mfma_f32_16x16x32_bf16 v[72:75], a[16:19], a[72:75], v[72:75]
    v_mfma_f32_16x16x32_bf16 v[76:79], a[16:19], a[76:79], v[76:79]
    ds_read_b64_tr_b16 a[16:17], v225 offset:25472
    v_mfma_f32_16x16x32_bf16 v[92:95], a[20:23], a[76:79], v[92:95]
    ds_read_b64_tr_b16 a[18:19], v225 offset:25984
    v_mfma_f32_16x16x32_bf16 v[88:91], a[20:23], a[72:75], v[88:91]
    buffer_load_dwordx4 a[124:127], v229, s[96:99], s28 offen offset:1024 sc1
    v_mfma_f32_16x16x32_bf16 v[84:87], a[20:23], a[68:71], v[84:87]
    v_mfma_f32_16x16x32_bf16 v[80:83], a[20:23], a[64:67], v[80:83]
    ds_read_b64_tr_b16 a[20:21], v225 offset:25504
    v_mfma_f32_16x16x32_bf16 v[96:99], a[24:27], a[64:67], v[96:99]
    ds_read_b64_tr_b16 a[22:23], v225 offset:26016
    v_mfma_f32_16x16x32_bf16 v[100:103], a[24:27], a[68:71], v[100:103]
    v_mfma_f32_16x16x32_bf16 v[104:107], a[24:27], a[72:75], v[104:107]
    v_mfma_f32_16x16x32_bf16 v[108:111], a[24:27], a[76:79], v[108:111]
    ds_read_b64_tr_b16 a[24:25], v225 offset:25536
    v_mfma_f32_16x16x32_bf16 v[124:127], a[28:31], a[76:79], v[124:127]
    ds_read_b64_tr_b16 a[26:27], v225 offset:26048
    v_mfma_f32_16x16x32_bf16 v[120:123], a[28:31], a[72:75], v[120:123]
    v_mfma_f32_16x16x32_bf16 v[116:119], a[28:31], a[68:71], v[116:119]
    s_add_u32 s28, s28, 2048
    v_mfma_f32_16x16x32_bf16 v[112:115], a[28:31], a[64:67], v[112:115]
    ds_read_b64_tr_b16 a[28:29], v225 offset:25568
    ds_read_b64_tr_b16 a[30:31], v225 offset:26080
    s_waitcnt vmcnt(15) lgkmcnt(8)
    v_mfma_f32_16x16x32_bf16 v[0:3], a[0:3], a[80:83], v[0:3]
    s_add_u32 m0, s30, 8448
    s_waitcnt vmcnt(14)
    v_mfma_f32_16x16x32_bf16 v[4:7], a[0:3], a[84:87], v[4:7]
    buffer_load_dwordx4 v227, s[8:11], s29 offen lds
    s_waitcnt vmcnt(14)
    v_mfma_f32_16x16x32_bf16 v[8:11], a[0:3], a[88:91], v[8:11]
    s_waitcnt vmcnt(13)
    v_mfma_f32_16x16x32_bf16 v[12:15], a[0:3], a[92:95], v[12:15]
    ds_read_b64_tr_b16 a[0:1], v225 offset:33792
    v_mfma_f32_16x16x32_bf16 v[28:31], a[4:7], a[92:95], v[28:31]
    ds_read_b64_tr_b16 a[2:3], v225 offset:34304
    v_mfma_f32_16x16x32_bf16 v[24:27], a[4:7], a[88:91], v[24:27]
    buffer_load_dwordx4 v235, s[8:11], s29 offen offset:1056 lds
    v_mfma_f32_16x16x32_bf16 v[20:23], a[4:7], a[84:87], v[20:23]
    s_add_u32 s29, s29, 65536
    v_mfma_f32_16x16x32_bf16 v[16:19], a[4:7], a[80:83], v[16:19]
    ds_read_b64_tr_b16 a[4:5], v225 offset:33824
    v_mfma_f32_16x16x32_bf16 v[32:35], a[8:11], a[80:83], v[32:35]
    ds_read_b64_tr_b16 a[6:7], v225 offset:34336
    v_mfma_f32_16x16x32_bf16 v[36:39], a[8:11], a[84:87], v[36:39]
    buffer_load_dwordx4 a[128:131], v229, s[56:59], s28 offen offset:0 sc1
    v_mfma_f32_16x16x32_bf16 v[40:43], a[8:11], a[88:91], v[40:43]
    v_mfma_f32_16x16x32_bf16 v[44:47], a[8:11], a[92:95], v[44:47]
    ds_read_b64_tr_b16 a[8:9], v225 offset:33856
    v_mfma_f32_16x16x32_bf16 v[60:63], a[12:15], a[92:95], v[60:63]
    ds_read_b64_tr_b16 a[10:11], v225 offset:34368
    v_mfma_f32_16x16x32_bf16 v[56:59], a[12:15], a[88:91], v[56:59]
    buffer_load_dwordx4 a[132:135], v229, s[56:59], s28 offen offset:1024 sc1
    v_mfma_f32_16x16x32_bf16 v[52:55], a[12:15], a[84:87], v[52:55]
    v_mfma_f32_16x16x32_bf16 v[48:51], a[12:15], a[80:83], v[48:51]
    ds_read_b64_tr_b16 a[12:13], v225 offset:33888
    s_waitcnt lgkmcnt(7)
    v_mfma_f32_16x16x32_bf16 v[64:67], a[16:19], a[80:83], v[64:67]
    ds_read_b64_tr_b16 a[14:15], v225 offset:34400
    v_mfma_f32_16x16x32_bf16 v[68:71], a[16:19], a[84:87], v[68:71]
    buffer_load_dwordx4 a[136:139], v229, s[96:99], s28 offen offset:0 sc1
    v_mfma_f32_16x16x32_bf16 v[72:75], a[16:19], a[88:91], v[72:75]
    v_mfma_f32_16x16x32_bf16 v[76:79], a[16:19], a[92:95], v[76:79]
    ds_read_b64_tr_b16 a[16:17], v225 offset:33920
    v_mfma_f32_16x16x32_bf16 v[92:95], a[20:23], a[92:95], v[92:95]
    ds_read_b64_tr_b16 a[18:19], v225 offset:34432
    v_mfma_f32_16x16x32_bf16 v[88:91], a[20:23], a[88:91], v[88:91]
    buffer_load_dwordx4 a[140:143], v229, s[96:99], s28 offen offset:1024 sc1
    v_mfma_f32_16x16x32_bf16 v[84:87], a[20:23], a[84:87], v[84:87]
    v_mfma_f32_16x16x32_bf16 v[80:83], a[20:23], a[80:83], v[80:83]
    ds_read_b64_tr_b16 a[20:21], v225 offset:33952
    v_mfma_f32_16x16x32_bf16 v[96:99], a[24:27], a[80:83], v[96:99]
    ds_read_b64_tr_b16 a[22:23], v225 offset:34464
    v_mfma_f32_16x16x32_bf16 v[100:103], a[24:27], a[84:87], v[100:103]
    v_mfma_f32_16x16x32_bf16 v[104:107], a[24:27], a[88:91], v[104:107]
    buffer_load_dwordx4 a[192:195], v229, s[40:43], s44 offen
    v_mfma_f32_16x16x32_bf16 v[108:111], a[24:27], a[92:95], v[108:111]
    ds_read_b64_tr_b16 a[24:25], v225 offset:33984
    v_mfma_f32_16x16x32_bf16 v[124:127], a[28:31], a[92:95], v[124:127]
    ds_read_b64_tr_b16 a[26:27], v225 offset:34496
    v_mfma_f32_16x16x32_bf16 v[120:123], a[28:31], a[88:91], v[120:123]
    v_mfma_f32_16x16x32_bf16 v[116:119], a[28:31], a[84:87], v[116:119]
    s_add_u32 s28, s28, 2048
    v_mfma_f32_16x16x32_bf16 v[112:115], a[28:31], a[80:83], v[112:115]
    ds_read_b64_tr_b16 a[28:29], v225 offset:34016
    ds_read_b64_tr_b16 a[30:31], v225 offset:34528
    s_barrier
    s_waitcnt vmcnt(16) lgkmcnt(8)
    v_mfma_f32_16x16x32_bf16 v[0:3], a[0:3], a[96:99], v[0:3]
    s_add_u32 m0, s30, 16896
    s_waitcnt vmcnt(15)
    v_mfma_f32_16x16x32_bf16 v[4:7], a[0:3], a[100:103], v[4:7]
    buffer_load_dwordx4 v227, s[8:11], s29 offen lds
    s_waitcnt vmcnt(15)
    v_mfma_f32_16x16x32_bf16 v[8:11], a[0:3], a[104:107], v[8:11]
    s_waitcnt vmcnt(14)
    v_mfma_f32_16x16x32_bf16 v[12:15], a[0:3], a[108:111], v[12:15]
    ds_read_b64_tr_b16 a[0:1], v225 offset:42240
    v_mfma_f32_16x16x32_bf16 v[28:31], a[4:7], a[108:111], v[28:31]
    ds_read_b64_tr_b16 a[2:3], v225 offset:42752
    v_mfma_f32_16x16x32_bf16 v[24:27], a[4:7], a[104:107], v[24:27]
    buffer_load_dwordx4 v235, s[8:11], s29 offen offset:1056 lds
    v_mfma_f32_16x16x32_bf16 v[20:23], a[4:7], a[100:103], v[20:23]
    s_add_u32 s29, s29, 65536
    v_mfma_f32_16x16x32_bf16 v[16:19], a[4:7], a[96:99], v[16:19]
    ds_read_b64_tr_b16 a[4:5], v225 offset:42272
    v_mfma_f32_16x16x32_bf16 v[32:35], a[8:11], a[96:99], v[32:35]
    ds_read_b64_tr_b16 a[6:7], v225 offset:42784
    v_mfma_f32_16x16x32_bf16 v[36:39], a[8:11], a[100:103], v[36:39]
    buffer_load_dwordx4 a[144:147], v229, s[56:59], s28 offen offset:0 sc1
    v_mfma_f32_16x16x32_bf16 v[40:43], a[8:11], a[104:107], v[40:43]
    v_mfma_f32_16x16x32_bf16 v[44:47], a[8:11], a[108:111], v[44:47]
    ds_read_b64_tr_b16 a[8:9], v225 offset:42304
    v_mfma_f32_16x16x32_bf16 v[60:63], a[12:15], a[108:111], v[60:63]
    ds_read_b64_tr_b16 a[10:11], v225 offset:42816
    v_mfma_f32_16x16x32_bf16 v[56:59], a[12:15], a[104:107], v[56:59]
    buffer_load_dwordx4 a[148:151], v229, s[56:59], s28 offen offset:1024 sc1
    v_mfma_f32_16x16x32_bf16 v[52:55], a[12:15], a[100:103], v[52:55]
    v_mfma_f32_16x16x32_bf16 v[48:51], a[12:15], a[96:99], v[48:51]
    ds_read_b64_tr_b16 a[12:13], v225 offset:42336
    s_waitcnt lgkmcnt(7)
    v_mfma_f32_16x16x32_bf16 v[64:67], a[16:19], a[96:99], v[64:67]
    ds_read_b64_tr_b16 a[14:15], v225 offset:42848
    v_mfma_f32_16x16x32_bf16 v[68:71], a[16:19], a[100:103], v[68:71]
    buffer_load_dwordx4 a[152:155], v229, s[96:99], s28 offen offset:0 sc1
    v_mfma_f32_16x16x32_bf16 v[72:75], a[16:19], a[104:107], v[72:75]
    v_mfma_f32_16x16x32_bf16 v[76:79], a[16:19], a[108:111], v[76:79]
    ds_read_b64_tr_b16 a[16:17], v225 offset:42368
    v_mfma_f32_16x16x32_bf16 v[92:95], a[20:23], a[108:111], v[92:95]
    ds_read_b64_tr_b16 a[18:19], v225 offset:42880
    v_mfma_f32_16x16x32_bf16 v[88:91], a[20:23], a[104:107], v[88:91]
    buffer_load_dwordx4 a[156:159], v229, s[96:99], s28 offen offset:1024 sc1
    v_mfma_f32_16x16x32_bf16 v[84:87], a[20:23], a[100:103], v[84:87]
    v_mfma_f32_16x16x32_bf16 v[80:83], a[20:23], a[96:99], v[80:83]
    ds_read_b64_tr_b16 a[20:21], v225 offset:42400
    v_mfma_f32_16x16x32_bf16 v[96:99], a[24:27], a[96:99], v[96:99]
    ds_read_b64_tr_b16 a[22:23], v225 offset:42912
    v_mfma_f32_16x16x32_bf16 v[100:103], a[24:27], a[100:103], v[100:103]
    v_mfma_f32_16x16x32_bf16 v[104:107], a[24:27], a[104:107], v[104:107]
    v_mfma_f32_16x16x32_bf16 v[108:111], a[24:27], a[108:111], v[108:111]
    ds_read_b64_tr_b16 a[24:25], v225 offset:42432
    v_mfma_f32_16x16x32_bf16 v[124:127], a[28:31], a[108:111], v[124:127]
    ds_read_b64_tr_b16 a[26:27], v225 offset:42944
    v_mfma_f32_16x16x32_bf16 v[120:123], a[28:31], a[104:107], v[120:123]
    v_mfma_f32_16x16x32_bf16 v[116:119], a[28:31], a[100:103], v[116:119]
    s_add_u32 s28, s28, 2048
    v_mfma_f32_16x16x32_bf16 v[112:115], a[28:31], a[96:99], v[112:115]
    ds_read_b64_tr_b16 a[28:29], v225 offset:42464
    ds_read_b64_tr_b16 a[30:31], v225 offset:42976
    s_waitcnt vmcnt(16) lgkmcnt(8)
    v_mfma_f32_16x16x32_bf16 v[0:3], a[0:3], a[112:115], v[0:3]
    s_add_u32 m0, s30, 25344
    s_waitcnt vmcnt(15)
    v_mfma_f32_16x16x32_bf16 v[4:7], a[0:3], a[116:119], v[4:7]
    buffer_load_dwordx4 v227, s[8:11], s29 offen lds
    s_waitcnt vmcnt(15)
    v_mfma_f32_16x16x32_bf16 v[8:11], a[0:3], a[120:123], v[8:11]
    s_waitcnt vmcnt(14)
    v_mfma_f32_16x16x32_bf16 v[12:15], a[0:3], a[124:127], v[12:15]
    ds_read_b64_tr_b16 a[0:1], v225 offset:50688
    v_mfma_f32_16x16x32_bf16 v[28:31], a[4:7], a[124:127], v[28:31]
    ds_read_b64_tr_b16 a[2:3], v225 offset:51200
    v_mfma_f32_16x16x32_bf16 v[24:27], a[4:7], a[120:123], v[24:27]
    buffer_load_dwordx4 v235, s[8:11], s29 offen offset:1056 lds
    v_mfma_f32_16x16x32_bf16 v[20:23], a[4:7], a[116:119], v[20:23]
    s_add_u32 s29, s29, 65536
    v_mfma_f32_16x16x32_bf16 v[16:19], a[4:7], a[112:115], v[16:19]
    ds_read_b64_tr_b16 a[4:5], v225 offset:50720
    v_mfma_f32_16x16x32_bf16 v[32:35], a[8:11], a[112:115], v[32:35]
    ds_read_b64_tr_b16 a[6:7], v225 offset:51232
    v_mfma_f32_16x16x32_bf16 v[36:39], a[8:11], a[116:119], v[36:39]
    buffer_load_dwordx4 a[32:35], v229, s[56:59], s28 offen offset:0 sc1
    v_mfma_f32_16x16x32_bf16 v[40:43], a[8:11], a[120:123], v[40:43]
    v_mfma_f32_16x16x32_bf16 v[44:47], a[8:11], a[124:127], v[44:47]
    ds_read_b64_tr_b16 a[8:9], v225 offset:50752
    v_mfma_f32_16x16x32_bf16 v[60:63], a[12:15], a[124:127], v[60:63]
    ds_read_b64_tr_b16 a[10:11], v225 offset:51264
    v_mfma_f32_16x16x32_bf16 v[56:59], a[12:15], a[120:123], v[56:59]
    buffer_load_dwordx4 a[36:39], v229, s[56:59], s28 offen offset:1024 sc1
    v_mfma_f32_16x16x32_bf16 v[52:55], a[12:15], a[116:119], v[52:55]
    v_mfma_f32_16x16x32_bf16 v[48:51], a[12:15], a[112:115], v[48:51]
    ds_read_b64_tr_b16 a[12:13], v225 offset:50784
    s_waitcnt lgkmcnt(7)
    v_mfma_f32_16x16x32_bf16 v[64:67], a[16:19], a[112:115], v[64:67]
    ds_read_b64_tr_b16 a[14:15], v225 offset:51296
    v_mfma_f32_16x16x32_bf16 v[68:71], a[16:19], a[116:119], v[68:71]
    buffer_load_dwordx4 a[40:43], v229, s[96:99], s28 offen offset:0 sc1
    v_mfma_f32_16x16x32_bf16 v[72:75], a[16:19], a[120:123], v[72:75]
    v_mfma_f32_16x16x32_bf16 v[76:79], a[16:19], a[124:127], v[76:79]
    ds_read_b64_tr_b16 a[16:17], v225 offset:50816
    v_mfma_f32_16x16x32_bf16 v[92:95], a[20:23], a[124:127], v[92:95]
    ds_read_b64_tr_b16 a[18:19], v225 offset:51328
    v_mfma_f32_16x16x32_bf16 v[88:91], a[20:23], a[120:123], v[88:91]
    buffer_load_dwordx4 a[44:47], v229, s[96:99], s28 offen offset:1024 sc1
    v_mfma_f32_16x16x32_bf16 v[84:87], a[20:23], a[116:119], v[84:87]
    v_mfma_f32_16x16x32_bf16 v[80:83], a[20:23], a[112:115], v[80:83]
    ds_read_b64_tr_b16 a[20:21], v225 offset:50848
    v_mfma_f32_16x16x32_bf16 v[96:99], a[24:27], a[112:115], v[96:99]
    ds_read_b64_tr_b16 a[22:23], v225 offset:51360
    v_mfma_f32_16x16x32_bf16 v[100:103], a[24:27], a[116:119], v[100:103]
    v_mfma_f32_16x16x32_bf16 v[104:107], a[24:27], a[120:123], v[104:107]
    v_mfma_f32_16x16x32_bf16 v[108:111], a[24:27], a[124:127], v[108:111]
    ds_read_b64_tr_b16 a[24:25], v225 offset:50880
    v_mfma_f32_16x16x32_bf16 v[124:127], a[28:31], a[124:127], v[124:127]
    ds_read_b64_tr_b16 a[26:27], v225 offset:51392
    v_mfma_f32_16x16x32_bf16 v[120:123], a[28:31], a[120:123], v[120:123]
    v_mfma_f32_16x16x32_bf16 v[116:119], a[28:31], a[116:119], v[116:119]
    s_add_u32 s28, s28, 2048
    v_mfma_f32_16x16x32_bf16 v[112:115], a[28:31], a[112:115], v[112:115]
    ds_read_b64_tr_b16 a[28:29], v225 offset:50912
    ds_read_b64_tr_b16 a[30:31], v225 offset:51424
    s_barrier
    s_waitcnt vmcnt(16) lgkmcnt(8)
    v_mfma_f32_16x16x32_bf16 v[0:3], a[0:3], a[128:131], v[0:3]
    s_add_u32 m0, s30, 33792
    s_waitcnt vmcnt(15)
    v_mfma_f32_16x16x32_bf16 v[4:7], a[0:3], a[132:135], v[4:7]
    buffer_load_dwordx4 v227, s[8:11], s29 offen lds
    s_waitcnt vmcnt(15)
    v_mfma_f32_16x16x32_bf16 v[8:11], a[0:3], a[136:139], v[8:11]
    s_waitcnt vmcnt(14)
    v_mfma_f32_16x16x32_bf16 v[12:15], a[0:3], a[140:143], v[12:15]
    ds_read_b64_tr_b16 a[0:1], v225 offset:59136
    v_mfma_f32_16x16x32_bf16 v[28:31], a[4:7], a[140:143], v[28:31]
    ds_read_b64_tr_b16 a[2:3], v225 offset:59648
    v_mfma_f32_16x16x32_bf16 v[24:27], a[4:7], a[136:139], v[24:27]
    buffer_load_dwordx4 v235, s[8:11], s29 offen offset:1056 lds
    v_mfma_f32_16x16x32_bf16 v[20:23], a[4:7], a[132:135], v[20:23]
    s_add_u32 s29, s29, 65536
    v_mfma_f32_16x16x32_bf16 v[16:19], a[4:7], a[128:131], v[16:19]
    ds_read_b64_tr_b16 a[4:5], v225 offset:59168
    v_mfma_f32_16x16x32_bf16 v[32:35], a[8:11], a[128:131], v[32:35]
    ds_read_b64_tr_b16 a[6:7], v225 offset:59680
    v_mfma_f32_16x16x32_bf16 v[36:39], a[8:11], a[132:135], v[36:39]
    buffer_load_dwordx4 a[48:51], v229, s[56:59], s28 offen offset:0 sc1
    v_mfma_f32_16x16x32_bf16 v[40:43], a[8:11], a[136:139], v[40:43]
    v_mfma_f32_16x16x32_bf16 v[44:47], a[8:11], a[140:143], v[44:47]
    ds_read_b64_tr_b16 a[8:9], v225 offset:59200
    v_mfma_f32_16x16x32_bf16 v[60:63], a[12:15], a[140:143], v[60:63]
    ds_read_b64_tr_b16 a[10:11], v225 offset:59712
    v_mfma_f32_16x16x32_bf16 v[56:59], a[12:15], a[136:139], v[56:59]
    buffer_load_dwordx4 a[52:55], v229, s[56:59], s28 offen offset:1024 sc1
    v_mfma_f32_16x16x32_bf16 v[52:55], a[12:15], a[132:135], v[52:55]
    v_mfma_f32_16x16x32_bf16 v[48:51], a[12:15], a[128:131], v[48:51]
    ds_read_b64_tr_b16 a[12:13], v225 offset:59232
    s_waitcnt lgkmcnt(7)
    v_mfma_f32_16x16x32_bf16 v[64:67], a[16:19], a[128:131], v[64:67]
    ds_read_b64_tr_b16 a[14:15], v225 offset:59744
    v_mfma_f32_16x16x32_bf16 v[68:71], a[16:19], a[132:135], v[68:71]
    buffer_load_dwordx4 a[56:59], v229, s[96:99], s28 offen offset:0 sc1
    v_mfma_f32_16x16x32_bf16 v[72:75], a[16:19], a[136:139], v[72:75]
    v_mfma_f32_16x16x32_bf16 v[76:79], a[16:19], a[140:143], v[76:79]
    ds_read_b64_tr_b16 a[16:17], v225 offset:59264
    v_mfma_f32_16x16x32_bf16 v[92:95], a[20:23], a[140:143], v[92:95]
    ds_read_b64_tr_b16 a[18:19], v225 offset:59776
    v_mfma_f32_16x16x32_bf16 v[88:91], a[20:23], a[136:139], v[88:91]
    buffer_load_dwordx4 a[60:63], v229, s[96:99], s28 offen offset:1024 sc1
    v_mfma_f32_16x16x32_bf16 v[84:87], a[20:23], a[132:135], v[84:87]
    v_mfma_f32_16x16x32_bf16 v[80:83], a[20:23], a[128:131], v[80:83]
    ds_read_b64_tr_b16 a[20:21], v225 offset:59296
    v_mfma_f32_16x16x32_bf16 v[96:99], a[24:27], a[128:131], v[96:99]
    ds_read_b64_tr_b16 a[22:23], v225 offset:59808
    v_mfma_f32_16x16x32_bf16 v[100:103], a[24:27], a[132:135], v[100:103]
    v_mfma_f32_16x16x32_bf16 v[104:107], a[24:27], a[136:139], v[104:107]
    v_mfma_f32_16x16x32_bf16 v[108:111], a[24:27], a[140:143], v[108:111]
    ds_read_b64_tr_b16 a[24:25], v225 offset:59328
    v_mfma_f32_16x16x32_bf16 v[124:127], a[28:31], a[140:143], v[124:127]
    ds_read_b64_tr_b16 a[26:27], v225 offset:59840
    v_mfma_f32_16x16x32_bf16 v[120:123], a[28:31], a[136:139], v[120:123]
    v_mfma_f32_16x16x32_bf16 v[116:119], a[28:31], a[132:135], v[116:119]
    s_add_u32 s28, s28, 2048
    v_mfma_f32_16x16x32_bf16 v[112:115], a[28:31], a[128:131], v[112:115]
    ds_read_b64_tr_b16 a[28:29], v225 offset:59360
    ds_read_b64_tr_b16 a[30:31], v225 offset:59872
    s_waitcnt vmcnt(15) lgkmcnt(8)
    v_mfma_f32_16x16x32_bf16 v[0:3], a[0:3], a[144:147], v[0:3]
    s_add_u32 m0, s30, 42240
    s_waitcnt vmcnt(14)
    v_mfma_f32_16x16x32_bf16 v[4:7], a[0:3], a[148:151], v[4:7]
    buffer_load_dwordx4 v227, s[8:11], s29 offen lds
    s_waitcnt vmcnt(14)
    v_mfma_f32_16x16x32_bf16 v[8:11], a[0:3], a[152:155], v[8:11]
    s_waitcnt vmcnt(13)
    v_mfma_f32_16x16x32_bf16 v[12:15], a[0:3], a[156:159], v[12:15]
    ds_read_b64_tr_b16 a[0:1], v225 offset:0
    v_mfma_f32_16x16x32_bf16 v[28:31], a[4:7], a[156:159], v[28:31]
    ds_read_b64_tr_b16 a[2:3], v225 offset:512
    v_mfma_f32_16x16x32_bf16 v[24:27], a[4:7], a[152:155], v[24:27]
    buffer_load_dwordx4 v235, s[8:11], s29 offen offset:1056 lds
    v_mfma_f32_16x16x32_bf16 v[20:23], a[4:7], a[148:151], v[20:23]
    s_add_u32 s29, s29, 65536
    v_mfma_f32_16x16x32_bf16 v[16:19], a[4:7], a[144:147], v[16:19]
    ds_read_b64_tr_b16 a[4:5], v225 offset:32
    v_mfma_f32_16x16x32_bf16 v[32:35], a[8:11], a[144:147], v[32:35]
    ds_read_b64_tr_b16 a[6:7], v225 offset:544
    v_mfma_f32_16x16x32_bf16 v[36:39], a[8:11], a[148:151], v[36:39]
    buffer_load_dwordx4 a[64:67], v229, s[56:59], s28 offen offset:0 sc1
    v_mfma_f32_16x16x32_bf16 v[40:43], a[8:11], a[152:155], v[40:43]
    v_mfma_f32_16x16x32_bf16 v[44:47], a[8:11], a[156:159], v[44:47]
    ds_read_b64_tr_b16 a[8:9], v225 offset:64
    v_mfma_f32_16x16x32_bf16 v[60:63], a[12:15], a[156:159], v[60:63]
    ds_read_b64_tr_b16 a[10:11], v225 offset:576
    v_mfma_f32_16x16x32_bf16 v[56:59], a[12:15], a[152:155], v[56:59]
    buffer_load_dwordx4 a[68:71], v229, s[56:59], s28 offen offset:1024 sc1
    v_mfma_f32_16x16x32_bf16 v[52:55], a[12:15], a[148:151], v[52:55]
    v_mfma_f32_16x16x32_bf16 v[48:51], a[12:15], a[144:147], v[48:51]
    ds_read_b64_tr_b16 a[12:13], v225 offset:96
    s_waitcnt lgkmcnt(7)
    v_mfma_f32_16x16x32_bf16 v[64:67], a[16:19], a[144:147], v[64:67]
    ds_read_b64_tr_b16 a[14:15], v225 offset:608
    v_mfma_f32_16x16x32_bf16 v[68:71], a[16:19], a[148:151], v[68:71]
    buffer_load_dwordx4 a[72:75], v229, s[96:99], s28 offen offset:0 sc1
    v_mfma_f32_16x16x32_bf16 v[72:75], a[16:19], a[152:155], v[72:75]
    v_mfma_f32_16x16x32_bf16 v[76:79], a[16:19], a[156:159], v[76:79]
    ds_read_b64_tr_b16 a[16:17], v225 offset:128
    v_mfma_f32_16x16x32_bf16 v[92:95], a[20:23], a[156:159], v[92:95]
    ds_read_b64_tr_b16 a[18:19], v225 offset:640
    v_mfma_f32_16x16x32_bf16 v[88:91], a[20:23], a[152:155], v[88:91]
    buffer_load_dwordx4 a[76:79], v229, s[96:99], s28 offen offset:1024 sc1
    v_mfma_f32_16x16x32_bf16 v[84:87], a[20:23], a[148:151], v[84:87]
    v_mfma_f32_16x16x32_bf16 v[80:83], a[20:23], a[144:147], v[80:83]
    ds_read_b64_tr_b16 a[20:21], v225 offset:160
    v_mfma_f32_16x16x32_bf16 v[96:99], a[24:27], a[144:147], v[96:99]
    ds_read_b64_tr_b16 a[22:23], v225 offset:672
    v_mfma_f32_16x16x32_bf16 v[100:103], a[24:27], a[148:151], v[100:103]
    v_mfma_f32_16x16x32_bf16 v[104:107], a[24:27], a[152:155], v[104:107]
    v_mfma_f32_16x16x32_bf16 v[108:111], a[24:27], a[156:159], v[108:111]
    ds_read_b64_tr_b16 a[24:25], v225 offset:192
    v_mfma_f32_16x16x32_bf16 v[124:127], a[28:31], a[156:159], v[124:127]
    ds_read_b64_tr_b16 a[26:27], v225 offset:704
    v_mfma_f32_16x16x32_bf16 v[120:123], a[28:31], a[152:155], v[120:123]
    v_mfma_f32_16x16x32_bf16 v[116:119], a[28:31], a[148:151], v[116:119]
    s_add_u32 s28, s28, 2048
    v_mfma_f32_16x16x32_bf16 v[112:115], a[28:31], a[144:147], v[112:115]
    ds_read_b64_tr_b16 a[28:29], v225 offset:224
    ds_read_b64_tr_b16 a[30:31], v225 offset:736
    s_sub_u32 s36, s36, 1
    s_cmp_lg_u32 s36, 0
    s_cbranch_scc1 pb_g2
    s_waitcnt vmcnt(16)
    s_barrier
    s_waitcnt vmcnt(15) lgkmcnt(8)
    v_mfma_f32_16x16x32_bf16 v[0:3], a[0:3], a[32:35], v[0:3]
    s_add_u32 m0, s30, 50688
    s_waitcnt vmcnt(14)
    v_mfma_f32_16x16x32_bf16 v[4:7], a[0:3], a[36:39], v[4:7]
    buffer_load_dwordx4 v227, s[8:11], s29 offen lds
    s_waitcnt vmcnt(14)
    v_mfma_f32_16x16x32_bf16 v[8:11], a[0:3], a[40:43], v[8:11]
    buffer_load_dwordx4 v235, s[8:11], s29 offen offset:1056 lds
    s_add_u32 s29, s29, 65536
    s_waitcnt vmcnt(14)
    v_mfma_f32_16x16x32_bf16 v[12:15], a[0:3], a[44:47], v[12:15]
    ds_read_b64_tr_b16 a[0:1], v225 offset:8448
    v_mfma_f32_16x16x32_bf16 v[16:19], a[4:7], a[32:35], v[16:19]
    ds_read_b64_tr_b16 a[2:3], v225 offset:8960
    s_add_u32 m0, s30, 59136
    v_mfma_f32_16x16x32_bf16 v[20:23], a[4:7], a[36:39], v[20:23]
    buffer_load_dwordx4 v227, s[8:11], s29 offen lds
    v_mfma_f32_16x16x32_bf16 v[24:27], a[4:7], a[40:43], v[24:27]
    buffer_load_dwordx4 v235, s[8:11], s29 offen offset:1056 lds
    s_add_u32 s29, s29, 65536
    v_mfma_f32_16x16x32_bf16 v[28:31], a[4:7], a[44:47], v[28:31]
    ds_read_b64_tr_b16 a[4:5], v225 offset:8480
    v_mfma_f32_16x16x32_bf16 v[32:35], a[8:11], a[32:35], v[32:35]
    ds_read_b64_tr_b16 a[6:7], v225 offset:8992
    v_mfma_f32_16x16x32_bf16 v[36:39], a[8:11], a[36:39], v[36:39]
    buffer_load_dwordx4 a[80:83], v229, s[56:59], s28 offen offset:0 sc1
    v_mfma_f32_16x16x32_bf16 v[40:43], a[8:11], a[40:43], v[40:43]
    buffer_load_dwordx4 a[84:87], v229, s[56:59], s28 offen offset:1024 sc1
    v_mfma_f32_16x16x32_bf16 v[44:47], a[8:11], a[44:47], v[44:47]
    ds_read_b64_tr_b16 a[8:9], v225 offset:8512
    v_mfma_f32_16x16x32_bf16 v[48:51], a[12:15], a[32:35], v[48:51]
    ds_read_b64_tr_b16 a[10:11], v225 offset:9024
    v_mfma_f32_16x16x32_bf16 v[52:55], a[12:15], a[36:39], v[52:55]
    buffer_load_dwordx4 a[88:91], v229, s[96:99], s28 offen offset:0 sc1
    v_mfma_f32_16x16x32_bf16 v[56:59], a[12:15], a[40:43], v[56:59]
    buffer_load_dwordx4 a[92:95], v229, s[96:99], s28 offen offset:1024 sc1
    s_add_u32 s28, s28, 2048
    v_mfma_f32_16x16x32_bf16 v[60:63], a[12:15], a[44:47], v[60:63]
    ds_read_b64_tr_b16 a[12:13], v225 offset:8544
    s_waitcnt lgkmcnt(7)
    v_mfma_f32_16x16x32_bf16 v[64:67], a[16:19], a[32:35], v[64:67]
    ds_read_b64_tr_b16 a[14:15], v225 offset:9056
    v_mfma_f32_16x16x32_bf16 v[68:71], a[16:19], a[36:39], v[68:71]
    buffer_load_dwordx4 a[96:99], v229, s[56:59], s28 offen offset:0 sc1
    v_mfma_f32_16x16x32_bf16 v[72:75], a[16:19], a[40:43], v[72:75]
    buffer_load_dwordx4 a[100:103], v229, s[56:59], s28 offen offset:1024 sc1
    v_mfma_f32_16x16x32_bf16 v[76:79], a[16:19], a[44:47], v[76:79]
    ds_read_b64_tr_b16 a[16:17], v225 offset:8576
    v_mfma_f32_16x16x32_bf16 v[80:83], a[20:23], a[32:35], v[80:83]
    ds_read_b64_tr_b16 a[18:19], v225 offset:9088
    v_mfma_f32_16x16x32_bf16 v[84:87], a[20:23], a[36:39], v[84:87]
    buffer_load_dwordx4 a[104:107], v229, s[96:99], s28 offen offset:0 sc1
    v_mfma_f32_16x16x32_bf16 v[88:91], a[20:23], a[40:43], v[88:91]
    buffer_load_dwordx4 a[108:111], v229, s[96:99], s28 offen offset:1024 sc1
    s_add_u32 s28, s28, 2048
    v_mfma_f32_16x16x32_bf16 v[92:95], a[20:23], a[44:47], v[92:95]
    ds_read_b64_tr_b16 a[20:21], v225 offset:8608
    v_mfma_f32_16x16x32_bf16 v[96:99], a[24:27], a[32:35], v[96:99]
    ds_read_b64_tr_b16 a[22:23], v225 offset:9120
    v_mfma_f32_16x16x32_bf16 v[100:103], a[24:27], a[36:39], v[100:103]
    buffer_load_dwordx4 a[112:115], v229, s[56:59], s28 offen offset:0 sc1
    v_mfma_f32_16x16x32_bf16 v[104:107], a[24:27], a[40:43], v[104:107]
    buffer_load_dwordx4 a[116:119], v229, s[56:59], s28 offen offset:1024 sc1
    v_mfma_f32_16x16x32_bf16 v[108:111], a[24:27], a[44:47], v[108:111]
    ds_read_b64_tr_b16 a[24:25], v225 offset:8640
    v_mfma_f32_16x16x32_bf16 v[112:115], a[28:31], a[32:35], v[112:115]
    ds_read_b64_tr_b16 a[26:27], v225 offset:9152
    v_mfma_f32_16x16x32_bf16 v[116:119], a[28:31], a[36:39], v[116:119]
    buffer_load_dwordx4 a[120:123], v229, s[96:99], s28 offen offset:0 sc1
    v_mfma_f32_16x16x32_bf16 v[120:123], a[28:31], a[40:43], v[120:123]
    buffer_load_dwordx4 a[124:127], v229, s[96:99], s28 offen offset:1024 sc1
    s_add_u32 s28, s28, 2048
    v_mfma_f32_16x16x32_bf16 v[124:127], a[28:31], a[44:47], v[124:127]
    ds_read_b64_tr_b16 a[28:29], v225 offset:8672
    ds_read_b64_tr_b16 a[30:31], v225 offset:9184
    s_waitcnt vmcnt(25) lgkmcnt(8)
    v_mfma_f32_16x16x32_bf16 v[0:3], a[0:3], a[48:51], v[0:3]
    buffer_load_dwordx4 a[128:131], v229, s[56:59], s28 offen offset:0 sc1
    s_waitcnt vmcnt(25)
    v_mfma_f32_16x16x32_bf16 v[4:7], a[0:3], a[52:55], v[4:7]
    buffer_load_dwordx4 a[132:135], v229, s[56:59], s28 offen offset:1024 sc1
    s_waitcnt vmcnt(25)
    v_mfma_f32_16x16x32_bf16 v[8:11], a[0:3], a[56:59], v[8:11]
    buffer_load_dwordx4 a[136:139], v229, s[96:99], s28 offen offset:0 sc1
    s_waitcnt vmcnt(25)
    v_mfma_f32_16x16x32_bf16 v[12:15], a[0:3], a[60:63], v[12:15]
    buffer_load_dwordx4 a[140:143], v229, s[96:99], s28 offen offset:1024 sc1
    s_add_u32 s28, s28, 2048
    v_mfma_f32_16x16x32_bf16 v[16:19], a[4:7], a[48:51], v[16:19]
    buffer_load_dwordx4 a[144:147], v229, s[56:59], s28 offen offset:0 sc1
    v_mfma_f32_16x16x32_bf16 v[20:23], a[4:7], a[52:55], v[20:23]
    buffer_load_dwordx4 a[148:151], v229, s[56:59], s28 offen offset:1024 sc1
    v_mfma_f32_16x16x32_bf16 v[24:27], a[4:7], a[56:59], v[24:27]
    buffer_load_dwordx4 a[152:155], v229, s[96:99], s28 offen offset:0 sc1
    v_mfma_f32_16x16x32_bf16 v[28:31], a[4:7], a[60:63], v[28:31]
    buffer_load_dwordx4 a[156:159], v229, s[96:99], s28 offen offset:1024 sc1
    s_add_u32 s28, s28, 2048
    v_mfma_f32_16x16x32_bf16 v[32:35], a[8:11], a[48:51], v[32:35]
    v_mfma_f32_16x16x32_bf16 v[36:39], a[8:11], a[52:55], v[36:39]
    ds_read_b64_tr_b16 a[0:1], v225 offset:17024
    v_mfma_f32_16x16x32_bf16 v[40:43], a[8:11], a[56:59], v[40:43]
    ds_read_b64_tr_b16 a[2:3], v225 offset:17536
    v_mfma_f32_16x16x32_bf16 v[44:47], a[8:11], a[60:63], v[44:47]
    ds_read_b64_tr_b16 a[4:5], v225 offset:17056
    v_mfma_f32_16x16x32_bf16 v[48:51], a[12:15], a[48:51], v[48:51]
    ds_read_b64_tr_b16 a[6:7], v225 offset:17568
    s_add_u32 s51, s50, 0
    v_mfma_f32_16x16x32_bf16 v[52:55], a[12:15], a[52:55], v[52:55]
    buffer_load_dwordx4 v[192:195], v234, s[16:19], s51 offen offset:0
    v_mfma_f32_16x16x32_bf16 v[56:59], a[12:15], a[56:59], v[56:59]
    buffer_load_dwordx4 v[208:211], v234, s[16:19], s51 offen offset:64
    s_add_u32 s51, s50, 32768
    v_mfma_f32_16x16x32_bf16 v[60:63], a[12:15], a[60:63], v[60:63]
    buffer_load_dwordx4 v[196:199], v234, s[16:19], s51 offen offset:0
    s_waitcnt lgkmcnt(4)
    v_mfma_f32_16x16x32_bf16 v[64:67], a[16:19], a[48:51], v[64:67]
    buffer_load_dwordx4 v[212:215], v234, s[16:19], s51 offen offset:64
    v_mfma_f32_16x16x32_bf16 v[68:71], a[16:19], a[52:55], v[68:71]
    ds_read_b64_tr_b16 a[8:9], v225 offset:25472
    v_mfma_f32_16x16x32_bf16 v[72:75], a[16:19], a[56:59], v[72:75]
    ds_read_b64_tr_b16 a[10:11], v225 offset:25984
    v_mfma_f32_16x16x32_bf16 v[76:79], a[16:19], a[60:63], v[76:79]
    ds_read_b64_tr_b16 a[12:13], v225 offset:25504
    v_mfma_f32_16x16x32_bf16 v[80:83], a[20:23], a[48:51], v[80:83]
    ds_read_b64_tr_b16 a[14:15], v225 offset:26016
    s_add_u32 s51, s50, 65536
    v_mfma_f32_16x16x32_bf16 v[84:87], a[20:23], a[52:55], v[84:87]
    buffer_load_dwordx4 v[200:203], v234, s[16:19], s51 offen offset:0
    v_mfma_f32_16x16x32_bf16 v[88:91], a[20:23], a[56:59], v[88:91]
    buffer_load_dwordx4 v[216:219], v234, s[16:19], s51 offen offset:64
    s_add_u32 s51, s50, 98304
    v_mfma_f32_16x16x32_bf16 v[92:95], a[20:23], a[60:63], v[92:95]
    buffer_load_dwordx4 v[204:207], v234, s[16:19], s51 offen offset:0
    v_mfma_f32_16x16x32_bf16 v[96:99], a[24:27], a[48:51], v[96:99]
    buffer_load_dwordx4 v[220:223], v234, s[16:19], s51 offen offset:64
    v_mfma_f32_16x16x32_bf16 v[100:103], a[24:27], a[52:55], v[100:103]
    v_mfma_f32_16x16x32_bf16 v[104:107], a[24:27], a[56:59], v[104:107]
    v_mfma_f32_16x16x32_bf16 v[108:111], a[24:27], a[60:63], v[108:111]
    v_mfma_f32_16x16x32_bf16 v[112:115], a[28:31], a[48:51], v[112:115]
    v_mfma_f32_16x16x32_bf16 v[116:119], a[28:31], a[52:55], v[116:119]
    v_mfma_f32_16x16x32_bf16 v[120:123], a[28:31], a[56:59], v[120:123]
    v_mfma_f32_16x16x32_bf16 v[124:127], a[28:31], a[60:63], v[124:127]
    s_waitcnt vmcnt(36)
    s_barrier
    s_waitcnt vmcnt(35) lgkmcnt(6)
    v_mfma_f32_16x16x32_bf16 v[64:67], a[0:3], a[64:67], v[64:67]
    ds_read_b64_tr_b16 a[16:17], v225 offset:33920
    s_waitcnt vmcnt(34)
    v_mfma_f32_16x16x32_bf16 v[68:71], a[0:3], a[68:71], v[68:71]
    s_waitcnt vmcnt(33)
    v_mfma_f32_16x16x32_bf16 v[72:75], a[0:3], a[72:75], v[72:75]
    ds_read_b64_tr_b16 a[18:19], v225 offset:34432
    s_waitcnt vmcnt(32)
    v_mfma_f32_16x16x32_bf16 v[76:79], a[0:3], a[76:79], v[76:79]
    s_waitcnt lgkmcnt(6)
    v_mfma_f32_16x16x32_bf16 v[92:95], a[4:7], a[76:79], v[92:95]
    ds_read_b64_tr_b16 a[20:21], v225 offset:33952
    v_mfma_f32_16x16x32_bf16 v[88:91], a[4:7], a[72:75], v[88:91]
    v_mfma_f32_16x16x32_bf16 v[84:87], a[4:7], a[68:71], v[84:87]
    ds_read_b64_tr_b16 a[22:23], v225 offset:34464
    v_mfma_f32_16x16x32_bf16 v[80:83], a[4:7], a[64:67], v[80:83]
    s_waitcnt vmcnt(27) lgkmcnt(6)
    v_mfma_f32_16x16x32_bf16 v[64:67], a[8:11], a[80:83], v[64:67]
    ds_read_b64_tr_b16 a[24:25], v225 offset:42368
    s_waitcnt vmcnt(26)
    v_mfma_f32_16x16x32_bf16 v[68:71], a[8:11], a[84:87], v[68:71]
    s_waitcnt vmcnt(25)
    v_mfma_f32_16x16x32_bf16 v[72:75], a[8:11], a[88:91], v[72:75]
    ds_read_b64_tr_b16 a[26:27], v225 offset:42880
    s_waitcnt vmcnt(24)
    v_mfma_f32_16x16x32_bf16 v[76:79], a[8:11], a[92:95], v[76:79]
    s_waitcnt lgkmcnt(6)
    v_mfma_f32_16x16x32_bf16 v[92:95], a[12:15], a[92:95], v[92:95]
    ds_read_b64_tr_b16 a[28:29], v225 offset:42400
    v_mfma_f32_16x16x32_bf16 v[88:91], a[12:15], a[88:91], v[88:91]
    v_mfma_f32_16x16x32_bf16 v[84:87], a[12:15], a[84:87], v[84:87]
    ds_read_b64_tr_b16 a[30:31], v225 offset:42912
    v_mfma_f32_16x16x32_bf16 v[80:83], a[12:15], a[80:83], v[80:83]
    s_barrier
    s_waitcnt vmcnt(23) lgkmcnt(6)
    v_mfma_f32_16x16x32_bf16 v[64:67], a[16:19], a[96:99], v[64:67]
    ds_read_b64_tr_b16 a[0:1], v225 offset:50816
    s_waitcnt vmcnt(22)
    v_mfma_f32_16x16x32_bf16 v[68:71], a[16:19], a[100:103], v[68:71]
    s_waitcnt vmcnt(21)
    v_mfma_f32_16x16x32_bf16 v[72:75], a[16:19], a[104:107], v[72:75]
    ds_read_b64_tr_b16 a[2:3], v225 offset:51328
    s_waitcnt vmcnt(20)
    v_mfma_f32_16x16x32_bf16 v[76:79], a[16:19], a[108:111], v[76:79]
    s_waitcnt lgkmcnt(6)
    v_mfma_f32_16x16x32_bf16 v[92:95], a[20:23], a[108:111], v[92:95]
    ds_read_b64_tr_b16 a[4:5], v225 offset:50848
    v_mfma_f32_16x16x32_bf16 v[88:91], a[20:23], a[104:107], v[88:91]
    v_mfma_f32_16x16x32_bf16 v[84:87], a[20:23], a[100:103], v[84:87]
    ds_read_b64_tr_b16 a[6:7], v225 offset:51360
    v_mfma_f32_16x16x32_bf16 v[80:83], a[20:23], a[96:99], v[80:83]
    s_waitcnt vmcnt(19) lgkmcnt(6)
    v_mfma_f32_16x16x32_bf16 v[64:67], a[24:27], a[112:115], v[64:67]
    ds_read_b64_tr_b16 a[8:9], v225 offset:59264
    s_waitcnt vmcnt(18)
    v_mfma_f32_16x16x32_bf16 v[68:71], a[24:27], a[116:119], v[68:71]
    s_waitcnt vmcnt(17)
    v_mfma_f32_16x16x32_bf16 v[72:75], a[24:27], a[120:123], v[72:75]
    ds_read_b64_tr_b16 a[10:11], v225 offset:59776
    s_waitcnt vmcnt(16)
    v_mfma_f32_16x16x32_bf16 v[76:79], a[24:27], a[124:127], v[76:79]
    s_waitcnt lgkmcnt(6)
    v_mfma_f32_16x16x32_bf16 v[92:95], a[28:31], a[124:127], v[92:95]
    ds_read_b64_tr_b16 a[12:13], v225 offset:59296
    v_mfma_f32_16x16x32_bf16 v[88:91], a[28:31], a[120:123], v[88:91]
    v_mfma_f32_16x16x32_bf16 v[84:87], a[28:31], a[116:119], v[84:87]
    ds_read_b64_tr_b16 a[14:15], v225 offset:59808
    v_mfma_f32_16x16x32_bf16 v[80:83], a[28:31], a[112:115], v[80:83]
    s_waitcnt vmcnt(15) lgkmcnt(6)
    v_mfma_f32_16x16x32_bf16 v[64:67], a[0:3], a[128:131], v[64:67]
    ds_read_b64_tr_b16 a[16:17], v225 offset:17088
    s_waitcnt vmcnt(14)
    v_mfma_f32_16x16x32_bf16 v[68:71], a[0:3], a[132:135], v[68:71]
    s_waitcnt vmcnt(13)
    v_mfma_f32_16x16x32_bf16 v[72:75], a[0:3], a[136:139], v[72:75]
    ds_read_b64_tr_b16 a[18:19], v225 offset:17600
    s_waitcnt vmcnt(12)
    v_mfma_f32_16x16x32_bf16 v[76:79], a[0:3], a[140:143], v[76:79]
    s_waitcnt lgkmcnt(6)
    v_mfma_f32_16x16x32_bf16 v[92:95], a[4:7], a[140:143], v[92:95]
    ds_read_b64_tr_b16 a[20:21], v225 offset:25536
    v_mfma_f32_16x16x32_bf16 v[88:91], a[4:7], a[136:139], v[88:91]
    v_mfma_f32_16x16x32_bf16 v[84:87], a[4:7], a[132:135], v[84:87]
    ds_read_b64_tr_b16 a[22:23], v225 offset:26048
    v_mfma_f32_16x16x32_bf16 v[80:83], a[4:7], a[128:131], v[80:83]
    s_waitcnt vmcnt(11) lgkmcnt(6)
    v_mfma_f32_16x16x32_bf16 v[64:67], a[8:11], a[144:147], v[64:67]
    ds_read_b64_tr_b16 a[24:25], v225 offset:33984
    s_waitcnt vmcnt(10)
    v_mfma_f32_16x16x32_bf16 v[68:71], a[8:11], a[148:151], v[68:71]
    s_waitcnt vmcnt(9)
    v_mfma_f32_16x16x32_bf16 v[72:75], a[8:11], a[152:155], v[72:75]
    ds_read_b64_tr_b16 a[26:27], v225 offset:34496
    s_waitcnt vmcnt(8)
    v_mfma_f32_16x16x32_bf16 v[76:79], a[8:11], a[156:159], v[76:79]
    s_waitcnt lgkmcnt(6)
    v_mfma_f32_16x16x32_bf16 v[92:95], a[12:15], a[156:159], v[92:95]
    ds_read_b64_tr_b16 a[28:29], v225 offset:42432
    v_mfma_f32_16x16x32_bf16 v[88:91], a[12:15], a[152:155], v[88:91]
    v_mfma_f32_16x16x32_bf16 v[84:87], a[12:15], a[148:151], v[84:87]
    ds_read_b64_tr_b16 a[30:31], v225 offset:42944
    v_mfma_f32_16x16x32_bf16 v[80:83], a[12:15], a[144:147], v[80:83]
    s_waitcnt lgkmcnt(6)
    v_mfma_f32_16x16x32_bf16 v[96:99], a[16:19], a[64:67], v[96:99]
    ds_read_b64_tr_b16 a[0:1], v225 offset:50880
    v_mfma_f32_16x16x32_bf16 v[100:103], a[16:19], a[68:71], v[100:103]
    v_mfma_f32_16x16x32_bf16 v[104:107], a[16:19], a[72:75], v[104:107]
    ds_read_b64_tr_b16 a[2:3], v225 offset:51392
    v_mfma_f32_16x16x32_bf16 v[108:111], a[16:19], a[76:79], v[108:111]
    v_cvt_pk_bf16_f32 v64, v64, v65
    s_waitcnt lgkmcnt(6)
    v_mfma_f32_16x16x32_bf16 v[108:111], a[20:23], a[92:95], v[108:111]
    ds_read_b64_tr_b16 a[4:5], v225 offset:59328
    v_mfma_f32_16x16x32_bf16 v[104:107], a[20:23], a[88:91], v[104:107]
    v_cvt_pk_bf16_f32 v65, v66, v67
    v_mfma_f32_16x16x32_bf16 v[100:103], a[20:23], a[84:87], v[100:103]
    ds_read_b64_tr_b16 a[6:7], v225 offset:59840
    v_mfma_f32_16x16x32_bf16 v[96:99], a[20:23], a[80:83], v[96:99]
    v_cvt_pk_bf16_f32 v66, v68, v69
    s_waitcnt lgkmcnt(6)
    v_mfma_f32_16x16x32_bf16 v[96:99], a[24:27], a[96:99], v[96:99]
    ds_read_b64_tr_b16 a[8:9], v225 offset:17120
    v_mfma_f32_16x16x32_bf16 v[100:103], a[24:27], a[100:103], v[100:103]
    v_cvt_pk_bf16_f32 v67, v70, v71
    v_mfma_f32_16x16x32_bf16 v[104:107], a[24:27], a[104:107], v[104:107]
    ds_read_b64_tr_b16 a[10:11], v225 offset:17632
    v_mfma_f32_16x16x32_bf16 v[108:111], a[24:27], a[108:111], v[108:111]
    buffer_store_dwordx4 v[64:67], v229, s[24:27], 0 offen offset:0 sc1
    s_waitcnt lgkmcnt(6)
    v_mfma_f32_16x16x32_bf16 v[108:111], a[28:31], a[124:127], v[108:111]
    ds_read_b64_tr_b16 a[12:13], v225 offset:25568
    v_mfma_f32_16x16x32_bf16 v[104:107], a[28:31], a[120:123], v[104:107]
    v_cvt_pk_bf16_f32 v68, v72, v73
    v_mfma_f32_16x16x32_bf16 v[100:103], a[28:31], a[116:119], v[100:103]
    ds_read_b64_tr_b16 a[14:15], v225 offset:26080
    v_mfma_f32_16x16x32_bf16 v[96:99], a[28:31], a[112:115], v[96:99]
    v_cvt_pk_bf16_f32 v69, v74, v75
    s_waitcnt lgkmcnt(6)
    v_mfma_f32_16x16x32_bf16 v[96:99], a[0:3], a[128:131], v[96:99]
    ds_read_b64_tr_b16 a[16:17], v225 offset:34016
    v_mfma_f32_16x16x32_bf16 v[100:103], a[0:3], a[132:135], v[100:103]
    v_cvt_pk_bf16_f32 v70, v76, v77
    v_mfma_f32_16x16x32_bf16 v[104:107], a[0:3], a[136:139], v[104:107]
    ds_read_b64_tr_b16 a[18:19], v225 offset:34528
    v_mfma_f32_16x16x32_bf16 v[108:111], a[0:3], a[140:143], v[108:111]
    v_cvt_pk_bf16_f32 v71, v78, v79
    s_waitcnt lgkmcnt(6)
    v_mfma_f32_16x16x32_bf16 v[108:111], a[4:7], a[156:159], v[108:111]
    ds_read_b64_tr_b16 a[20:21], v225 offset:42464
    v_mfma_f32_16x16x32_bf16 v[104:107], a[4:7], a[152:155], v[104:107]
    buffer_store_dwordx4 v[68:71], v229, s[24:27], 0 offen offset:1024 sc1
    v_mfma_f32_16x16x32_bf16 v[100:103], a[4:7], a[148:151], v[100:103]
    ds_read_b64_tr_b16 a[22:23], v225 offset:42976
    v_mfma_f32_16x16x32_bf16 v[96:99], a[4:7], a[144:147], v[96:99]
    v_cvt_pk_bf16_f32 v72, v80, v81
    s_waitcnt lgkmcnt(6)
    v_mfma_f32_16x16x32_bf16 v[112:115], a[8:11], a[64:67], v[112:115]
    ds_read_b64_tr_b16 a[24:25], v225 offset:50912
    v_mfma_f32_16x16x32_bf16 v[116:119], a[8:11], a[68:71], v[116:119]
    v_cvt_pk_bf16_f32 v73, v82, v83
    v_mfma_f32_16x16x32_bf16 v[120:123], a[8:11], a[72:75], v[120:123]
    ds_read_b64_tr_b16 a[26:27], v225 offset:51424
    v_mfma_f32_16x16x32_bf16 v[124:127], a[8:11], a[76:79], v[124:127]
    v_cvt_pk_bf16_f32 v74, v84, v85
    s_waitcnt lgkmcnt(6)
    v_mfma_f32_16x16x32_bf16 v[124:127], a[12:15], a[92:95], v[124:127]
    ds_read_b64_tr_b16 a[28:29], v225 offset:59360
    v_mfma_f32_16x16x32_bf16 v[120:123], a[12:15], a[88:91], v[120:123]
    v_cvt_pk_bf16_f32 v75, v86, v87
    v_mfma_f32_16x16x32_bf16 v[116:119], a[12:15], a[84:87], v[116:119]
    ds_read_b64_tr_b16 a[30:31], v225 offset:59872
    v_mfma_f32_16x16x32_bf16 v[112:115], a[12:15], a[80:83], v[112:115]
    buffer_store_dwordx4 v[72:75], v229, s[24:27], 0 offen offset:2048 sc1
    s_waitcnt lgkmcnt(6)
    v_mfma_f32_16x16x32_bf16 v[112:115], a[16:19], a[96:99], v[112:115]
    ds_read_b64_tr_b16 a[0:1], v225 offset:16896
    v_mfma_f32_16x16x32_bf16 v[116:119], a[16:19], a[100:103], v[116:119]
    v_cvt_pk_bf16_f32 v76, v88, v89
    v_mfma_f32_16x16x32_bf16 v[120:123], a[16:19], a[104:107], v[120:123]
    ds_read_b64_tr_b16 a[2:3], v225 offset:17408
    v_mfma_f32_16x16x32_bf16 v[124:127], a[16:19], a[108:111], v[124:127]
    v_cvt_pk_bf16_f32 v77, v90, v91
    s_waitcnt lgkmcnt(6)
    v_mfma_f32_16x16x32_bf16 v[124:127], a[20:23], a[124:127], v[124:127]
    ds_read_b64_tr_b16 a[4:5], v225 offset:16928
    v_mfma_f32_16x16x32_bf16 v[120:123], a[20:23], a[120:123], v[120:123]
    v_cvt_pk_bf16_f32 v78, v92, v93
    v_mfma_f32_16x16x32_bf16 v[116:119], a[20:23], a[116:119], v[116:119]
    ds_read_b64_tr_b16 a[6:7], v225 offset:17440
    v_mfma_f32_16x16x32_bf16 v[112:115], a[20:23], a[112:115], v[112:115]
    v_cvt_pk_bf16_f32 v79, v94, v95
    s_waitcnt lgkmcnt(6)
    v_mfma_f32_16x16x32_bf16 v[112:115], a[24:27], a[128:131], v[112:115]
    ds_read_b64_tr_b16 a[8:9], v225 offset:25344
    v_mfma_f32_16x16x32_bf16 v[116:119], a[24:27], a[132:135], v[116:119]
    buffer_store_dwordx4 v[76:79], v229, s[24:27], 0 offen offset:3072 sc1
    v_mfma_f32_16x16x32_bf16 v[120:123], a[24:27], a[136:139], v[120:123]
    ds_read_b64_tr_b16 a[10:11], v225 offset:25856
    v_mfma_f32_16x16x32_bf16 v[124:127], a[24:27], a[140:143], v[124:127]
    v_cvt_pk_bf16_f32 v80, v96, v97
    s_waitcnt lgkmcnt(6)
    v_mfma_f32_16x16x32_bf16 v[124:127], a[28:31], a[156:159], v[124:127]
    ds_read_b64_tr_b16 a[12:13], v225 offset:25376
    v_mfma_f32_16x16x32_bf16 v[120:123], a[28:31], a[152:155], v[120:123]
    v_cvt_pk_bf16_f32 v81, v98, v99
    v_mfma_f32_16x16x32_bf16 v[116:119], a[28:31], a[148:151], v[116:119]
    ds_read_b64_tr_b16 a[14:15], v225 offset:25888
    v_mfma_f32_16x16x32_bf16 v[112:115], a[28:31], a[144:147], v[112:115]
    v_cvt_pk_bf16_f32 v82, v100, v101
    s_waitcnt lgkmcnt(6)
    v_mfma_f32_16x16x32_bf16 v[0:3], a[0:3], a[64:67], v[0:3]
    ds_read_b64_tr_b16 a[16:17], v225 offset:33792
    v_mfma_f32_16x16x32_bf16 v[4:7], a[0:3], a[68:71], v[4:7]
    v_cvt_pk_bf16_f32 v83, v102, v103
    v_mfma_f32_16x16x32_bf16 v[8:11], a[0:3], a[72:75], v[8:11]
    ds_read_b64_tr_b16 a[18:19], v225 offset:34304
    v_mfma_f32_16x16x32_bf16 v[12:15], a[0:3], a[76:79], v[12:15]
    buffer_store_dwordx4 v[80:83], v229, s[24:27], s94 offen offset:0 sc1
    s_waitcnt lgkmcnt(6)
    v_mfma_f32_16x16x32_bf16 v[28:31], a[4:7], a[76:79], v[28:31]
    ds_read_b64_tr_b16 a[20:21], v225 offset:33824
    v_mfma_f32_16x16x32_bf16 v[24:27], a[4:7], a[72:75], v[24:27]
    v_cvt_pk_bf16_f32 v84, v104, v105
    v_mfma_f32_16x16x32_bf16 v[20:23], a[4:7], a[68:71], v[20:23]
    ds_read_b64_tr_b16 a[22:23], v225 offset:34336
    v_mfma_f32_16x16x32_bf16 v[16:19], a[4:7], a[64:67], v[16:19]
    v_cvt_pk_bf16_f32 v85, v106, v107
    s_waitcnt lgkmcnt(6)
    v_mfma_f32_16x16x32_bf16 v[0:3], a[8:11], a[80:83], v[0:3]
    ds_read_b64_tr_b16 a[24:25], v225 offset:42240
    v_mfma_f32_16x16x32_bf16 v[4:7], a[8:11], a[84:87], v[4:7]
    v_cvt_pk_bf16_f32 v86, v108, v109
    v_mfma_f32_16x16x32_bf16 v[8:11], a[8:11], a[88:91], v[8:11]
    ds_read_b64_tr_b16 a[26:27], v225 offset:42752
    v_mfma_f32_16x16x32_bf16 v[12:15], a[8:11], a[92:95], v[12:15]
    v_cvt_pk_bf16_f32 v87, v110, v111
    s_waitcnt lgkmcnt(6)
    v_mfma_f32_16x16x32_bf16 v[28:31], a[12:15], a[92:95], v[28:31]
    ds_read_b64_tr_b16 a[28:29], v225 offset:42272
    v_mfma_f32_16x16x32_bf16 v[24:27], a[12:15], a[88:91], v[24:27]
    buffer_store_dwordx4 v[84:87], v229, s[24:27], s94 offen offset:1024 sc1
    v_mfma_f32_16x16x32_bf16 v[20:23], a[12:15], a[84:87], v[20:23]
    ds_read_b64_tr_b16 a[30:31], v225 offset:42784
    v_mfma_f32_16x16x32_bf16 v[16:19], a[12:15], a[80:83], v[16:19]
    v_cvt_pk_bf16_f32 v88, v112, v113
    s_waitcnt lgkmcnt(6)
    v_mfma_f32_16x16x32_bf16 v[0:3], a[16:19], a[96:99], v[0:3]
    ds_read_b64_tr_b16 a[0:1], v225 offset:50688
    v_mfma_f32_16x16x32_bf16 v[4:7], a[16:19], a[100:103], v[4:7]
    v_cvt_pk_bf16_f32 v89, v114, v115
    v_mfma_f32_16x16x32_bf16 v[8:11], a[16:19], a[104:107], v[8:11]
    ds_read_b64_tr_b16 a[2:3], v225 offset:51200
    v_mfma_f32_16x16x32_bf16 v[12:15], a[16:19], a[108:111], v[12:15]
    v_cvt_pk_bf16_f32 v90, v116, v117
    s_waitcnt lgkmcnt(6)
    v_mfma_f32_16x16x32_bf16 v[28:31], a[20:23], a[108:111], v[28:31]
    ds_read_b64_tr_b16 a[4:5], v225 offset:50720
    v_mfma_f32_16x16x32_bf16 v[24:27], a[20:23], a[104:107], v[24:27]
    v_cvt_pk_bf16_f32 v91, v118, v119
    v_mfma_f32_16x16x32_bf16 v[20:23], a[20:23], a[100:103], v[20:23]
    ds_read_b64_tr_b16 a[6:7], v225 offset:51232
    v_mfma_f32_16x16x32_bf16 v[16:19], a[20:23], a[96:99], v[16:19]
    buffer_store_dwordx4 v[88:91], v229, s[24:27], s94 offen offset:2048 sc1
    s_waitcnt lgkmcnt(6)
    v_mfma_f32_16x16x32_bf16 v[0:3], a[24:27], a[112:115], v[0:3]
    ds_read_b64_tr_b16 a[8:9], v225 offset:59136
    v_mfma_f32_16x16x32_bf16 v[4:7], a[24:27], a[116:119], v[4:7]
    v_cvt_pk_bf16_f32 v92, v120, v121
    v_mfma_f32_16x16x32_bf16 v[8:11], a[24:27], a[120:123], v[8:11]
    ds_read_b64_tr_b16 a[10:11], v225 offset:59648
    v_mfma_f32_16x16x32_bf16 v[12:15], a[24:27], a[124:127], v[12:15]
    v_cvt_pk_bf16_f32 v93, v122, v123
    s_waitcnt lgkmcnt(6)
    v_mfma_f32_16x16x32_bf16 v[28:31], a[28:31], a[124:127], v[28:31]
    ds_read_b64_tr_b16 a[12:13], v225 offset:59168
    v_mfma_f32_16x16x32_bf16 v[24:27], a[28:31], a[120:123], v[24:27]
    v_cvt_pk_bf16_f32 v94, v124, v125
    v_mfma_f32_16x16x32_bf16 v[20:23], a[28:31], a[116:119], v[20:23]
    ds_read_b64_tr_b16 a[14:15], v225 offset:59680
    v_mfma_f32_16x16x32_bf16 v[16:19], a[28:31], a[112:115], v[16:19]
    v_cvt_pk_bf16_f32 v95, v126, v127
    s_waitcnt lgkmcnt(6)
    v_mfma_f32_16x16x32_bf16 v[0:3], a[0:3], a[128:131], v[0:3]
    ds_read_b64_tr_b16 a[16:17], v225 offset:16960
    v_mfma_f32_16x16x32_bf16 v[4:7], a[0:3], a[132:135], v[4:7]
    buffer_store_dwordx4 v[92:95], v229, s[24:27], s94 offen offset:3072 sc1
    v_mfma_f32_16x16x32_bf16 v[8:11], a[0:3], a[136:139], v[8:11]
    ds_read_b64_tr_b16 a[18:19], v225 offset:17472
    v_mfma_f32_16x16x32_bf16 v[12:15], a[0:3], a[140:143], v[12:15]
    s_waitcnt lgkmcnt(6)
    v_mfma_f32_16x16x32_bf16 v[28:31], a[4:7], a[140:143], v[28:31]
    ds_read_b64_tr_b16 a[20:21], v225 offset:16992
    v_mfma_f32_16x16x32_bf16 v[24:27], a[4:7], a[136:139], v[24:27]
    v_mfma_f32_16x16x32_bf16 v[20:23], a[4:7], a[132:135], v[20:23]
    ds_read_b64_tr_b16 a[22:23], v225 offset:17504
    v_mfma_f32_16x16x32_bf16 v[16:19], a[4:7], a[128:131], v[16:19]
    s_waitcnt lgkmcnt(6)
    v_mfma_f32_16x16x32_bf16 v[0:3], a[8:11], a[144:147], v[0:3]
    ds_read_b64_tr_b16 a[24:25], v225 offset:25408
    v_mfma_f32_16x16x32_bf16 v[4:7], a[8:11], a[148:151], v[4:7]
    v_mfma_f32_16x16x32_bf16 v[8:11], a[8:11], a[152:155], v[8:11]
    ds_read_b64_tr_b16 a[26:27], v225 offset:25920
    v_mfma_f32_16x16x32_bf16 v[12:15], a[8:11], a[156:159], v[12:15]
    s_waitcnt lgkmcnt(6)
    v_mfma_f32_16x16x32_bf16 v[28:31], a[12:15], a[156:159], v[28:31]
    ds_read_b64_tr_b16 a[28:29], v225 offset:25440
    v_mfma_f32_16x16x32_bf16 v[24:27], a[12:15], a[152:155], v[24:27]
    v_mfma_f32_16x16x32_bf16 v[20:23], a[12:15], a[148:151], v[20:23]
    ds_read_b64_tr_b16 a[30:31], v225 offset:25952
    v_mfma_f32_16x16x32_bf16 v[16:19], a[12:15], a[144:147], v[16:19]
    s_waitcnt lgkmcnt(6)
    v_mfma_f32_16x16x32_bf16 v[32:35], a[16:19], a[64:67], v[32:35]
    ds_read_b64_tr_b16 a[0:1], v225 offset:33856
    v_mfma_f32_16x16x32_bf16 v[36:39], a[16:19], a[68:71], v[36:39]
    v_mfma_f32_16x16x32_bf16 v[40:43], a[16:19], a[72:75], v[40:43]
    ds_read_b64_tr_b16 a[2:3], v225 offset:34368
    v_mfma_f32_16x16x32_bf16 v[44:47], a[16:19], a[76:79], v[44:47]
    s_waitcnt lgkmcnt(6)
    v_mfma_f32_16x16x32_bf16 v[60:63], a[20:23], a[76:79], v[60:63]
    ds_read_b64_tr_b16 a[4:5], v225 offset:33888
    v_mfma_f32_16x16x32_bf16 v[56:59], a[20:23], a[72:75], v[56:59]
    v_mfma_f32_16x16x32_bf16 v[52:55], a[20:23], a[68:71], v[52:55]
    ds_read_b64_tr_b16 a[6:7], v225 offset:34400
    v_mfma_f32_16x16x32_bf16 v[48:51], a[20:23], a[64:67], v[48:51]
    s_waitcnt lgkmcnt(6)
    v_mfma_f32_16x16x32_bf16 v[32:35], a[24:27], a[80:83], v[32:35]
    ds_read_b64_tr_b16 a[8:9], v225 offset:42304
    v_mfma_f32_16x16x32_bf16 v[36:39], a[24:27], a[84:87], v[36:39]
    v_mfma_f32_16x16x32_bf16 v[40:43], a[24:27], a[88:91], v[40:43]
    ds_read_b64_tr_b16 a[10:11], v225 offset:42816
    v_mfma_f32_16x16x32_bf16 v[44:47], a[24:27], a[92:95], v[44:47]
    s_waitcnt lgkmcnt(6)
    v_mfma_f32_16x16x32_bf16 v[60:63], a[28:31], a[92:95], v[60:63]
    ds_read_b64_tr_b16 a[12:13], v225 offset:42336
    v_mfma_f32_16x16x32_bf16 v[56:59], a[28:31], a[88:91], v[56:59]
    v_mfma_f32_16x16x32_bf16 v[52:55], a[28:31], a[84:87], v[52:55]
    ds_read_b64_tr_b16 a[14:15], v225 offset:42848
    v_mfma_f32_16x16x32_bf16 v[48:51], a[28:31], a[80:83], v[48:51]
    s_waitcnt lgkmcnt(6)
    v_mfma_f32_16x16x32_bf16 v[32:35], a[0:3], a[96:99], v[32:35]
    ds_read_b64_tr_b16 a[16:17], v225 offset:50752
    v_mfma_f32_16x16x32_bf16 v[36:39], a[0:3], a[100:103], v[36:39]
    v_mfma_f32_16x16x32_bf16 v[40:43], a[0:3], a[104:107], v[40:43]
    ds_read_b64_tr_b16 a[18:19], v225 offset:51264
    v_mfma_f32_16x16x32_bf16 v[44:47], a[0:3], a[108:111], v[44:47]
    s_waitcnt lgkmcnt(6)
    v_mfma_f32_16x16x32_bf16 v[60:63], a[4:7], a[108:111], v[60:63]
    ds_read_b64_tr_b16 a[20:21], v225 offset:50784
    v_mfma_f32_16x16x32_bf16 v[56:59], a[4:7], a[104:107], v[56:59]
    v_mfma_f32_16x16x32_bf16 v[52:55], a[4:7], a[100:103], v[52:55]
    ds_read_b64_tr_b16 a[22:23], v225 offset:51296
    v_mfma_f32_16x16x32_bf16 v[48:51], a[4:7], a[96:99], v[48:51]
    s_waitcnt lgkmcnt(6)
    v_mfma_f32_16x16x32_bf16 v[32:35], a[8:11], a[112:115], v[32:35]
    ds_read_b64_tr_b16 a[24:25], v225 offset:59200
    v_mfma_f32_16x16x32_bf16 v[36:39], a[8:11], a[116:119], v[36:39]
    buffer_load_dword v236, v240, s[12:15], s60 offen sc1
    v_mfma_f32_16x16x32_bf16 v[40:43], a[8:11], a[120:123], v[40:43]
    ds_read_b64_tr_b16 a[26:27], v225 offset:59712
    v_mfma_f32_16x16x32_bf16 v[44:47], a[8:11], a[124:127], v[44:47]
    s_waitcnt lgkmcnt(6)
    v_mfma_f32_16x16x32_bf16 v[60:63], a[12:15], a[124:127], v[60:63]
    ds_read_b64_tr_b16 a[28:29], v225 offset:59232
    v_mfma_f32_16x16x32_bf16 v[56:59], a[12:15], a[120:123], v[56:59]
    v_mfma_f32_16x16x32_bf16 v[52:55], a[12:15], a[116:119], v[52:55]
    ds_read_b64_tr_b16 a[30:31], v225 offset:59744
    v_mfma_f32_16x16x32_bf16 v[48:51], a[12:15], a[112:115], v[48:51]
    s_waitcnt lgkmcnt(6)
    v_mfma_f32_16x16x32_bf16 v[32:35], a[16:19], a[128:131], v[32:35]
    v_mfma_f32_16x16x32_bf16 v[36:39], a[16:19], a[132:135], v[36:39]
    v_mfma_f32_16x16x32_bf16 v[40:43], a[16:19], a[136:139], v[40:43]
    v_mfma_f32_16x16x32_bf16 v[44:47], a[16:19], a[140:143], v[44:47]
    s_waitcnt lgkmcnt(4)
    v_mfma_f32_16x16x32_bf16 v[60:63], a[20:23], a[140:143], v[60:63]
    v_mfma_f32_16x16x32_bf16 v[56:59], a[20:23], a[136:139], v[56:59]
    v_mfma_f32_16x16x32_bf16 v[52:55], a[20:23], a[132:135], v[52:55]
    v_mfma_f32_16x16x32_bf16 v[48:51], a[20:23], a[128:131], v[48:51]
    s_waitcnt lgkmcnt(2)
    v_mfma_f32_16x16x32_bf16 v[32:35], a[24:27], a[144:147], v[32:35]
    v_mfma_f32_16x16x32_bf16 v[36:39], a[24:27], a[148:151], v[36:39]
    v_mfma_f32_16x16x32_bf16 v[40:43], a[24:27], a[152:155], v[40:43]
    v_mfma_f32_16x16x32_bf16 v[44:47], a[24:27], a[156:159], v[44:47]
    s_waitcnt lgkmcnt(0)
    v_mfma_f32_16x16x32_bf16 v[60:63], a[28:31], a[156:159], v[60:63]
    v_mfma_f32_16x16x32_bf16 v[56:59], a[28:31], a[152:155], v[56:59]
    v_mfma_f32_16x16x32_bf16 v[52:55], a[28:31], a[148:151], v[52:55]
    v_mfma_f32_16x16x32_bf16 v[48:51], a[28:31], a[144:147], v[48:51]
    v_mov_b32 v230, s100
    s_waitcnt vmcnt(1)
    s_mov_b64 exec, 1
    buffer_store_dword v230, v240, s[12:15], s61 offen sc1
    s_mov_b64 exec, -1
    s_waitcnt vmcnt(1)
    v_readfirstlane_b32 s52, v236
    s_nop 4
    s_cmp_eq_u32 s52, s100
    s_cselect_b32 s54, s33, 0
    s_cmp_lg_u32 s54, 0
    s_cselect_b32 s55, s38, 0x7f000000
    s_mov_b32 s53, 0x80000
pb_pp:
    buffer_load_dword v242, v240, s[12:15], s62 offen sc1
    s_waitcnt vmcnt(0)
    v_readfirstlane_b32 s52, v242
    s_nop 4
    s_cmp_eq_u32 s52, s100
    s_cbranch_scc1 pb_pq
    s_sub_u32 s53, s53, 1
    s_cmp_lg_u32 s53, 0
    s_cbranch_scc1 pb_pp
pb_pq:
    s_add_u32 s31, s88, 0
    buffer_load_dwordx4 v[96:99], v229, s[12:15], s31 offen sc1
    s_add_u32 s31, s88, 1024
    buffer_load_dwordx4 v[100:103], v229, s[12:15], s31 offen sc1
    s_add_u32 s31, s88, 2048
    buffer_load_dwordx4 v[104:107], v229, s[12:15], s31 offen sc1
    s_add_u32 s31, s88, 3072
    buffer_load_dwordx4 v[108:111], v229, s[12:15], s31 offen sc1
    s_add_u32 s31, s88, 4096
    buffer_load_dwordx4 v[112:115], v229, s[12:15], s31 offen sc1
    s_add_u32 s31, s88, 5120
    buffer_load_dwordx4 v[116:119], v229, s[12:15], s31 offen sc1
    s_add_u32 s31, s88, 6144
    buffer_load_dwordx4 v[120:123], v229, s[12:15], s31 offen sc1
    s_add_u32 s31, s88, 7168
    buffer_load_dwordx4 v[124:127], v229, s[12:15], s31 offen sc1
    s_add_u32 s31, s55, 0
    buffer_load_dwordx4 v[64:67], v229, s[12:15], s31 offen sc1
    s_add_u32 s31, s55, 1024
    buffer_load_dwordx4 v[68:71], v229, s[12:15], s31 offen sc1
    s_add_u32 s31, s55, 2048
    buffer_load_dwordx4 v[72:75], v229, s[12:15], s31 offen sc1
    s_add_u32 s31, s55, 3072
    buffer_load_dwordx4 v[76:79], v229, s[12:15], s31 offen sc1
    s_add_u32 s31, s55, 4096
    buffer_load_dwordx4 v[80:83], v229, s[12:15], s31 offen sc1
    s_add_u32 s31, s55, 5120
    buffer_load_dwordx4 v[84:87], v229, s[12:15], s31 offen sc1
    s_add_u32 s31, s55, 6144
    buffer_load_dwordx4 v[88:91], v229, s[12:15], s31 offen sc1
    s_add_u32 s31, s55, 7168
    buffer_load_dwordx4 v[92:95], v229, s[12:15], s31 offen sc1
    s_cmp_eq_u32 s33, 1
    s_cbranch_scc0 pb_wg
    v_permlane16_swap_b32 v192, v194
    v_permlane16_swap_b32 v193, v195
    v_permlane16_swap_b32 v196, v198
    v_permlane16_swap_b32 v197, v199
    v_permlane16_swap_b32 v200, v202
    v_permlane16_swap_b32 v201, v203
    v_permlane16_swap_b32 v204, v206
    v_permlane16_swap_b32 v205, v207
    v_permlane16_swap_b32 v208, v210
    v_permlane16_swap_b32 v209, v211
    v_permlane16_swap_b32 v212, v214
    v_permlane16_swap_b32 v213, v215
    v_permlane16_swap_b32 v216, v218
    v_permlane16_swap_b32 v217, v219
    v_permlane16_swap_b32 v220, v222
    v_permlane16_swap_b32 v221, v223
    v_lshlrev_b32 v128, 16, v192
    v_and_b32 v129, 0xffff0000, v192
    v_lshlrev_b32 v130, 16, v193
    v_and_b32 v131, 0xffff0000, v193
    v_lshlrev_b32 v132, 16, v194
    v_and_b32 v133, 0xffff0000, v194
    v_lshlrev_b32 v134, 16, v195
    v_and_b32 v135, 0xffff0000, v195
    v_lshlrev_b32 v136, 16, v196
    v_and_b32 v137, 0xffff0000, v196
    v_lshlrev_b32 v138, 16, v197
    v_and_b32 v139, 0xffff0000, v197
    v_lshlrev_b32 v140, 16, v198
    v_and_b32 v141, 0xffff0000, v198
    v_lshlrev_b32 v142, 16, v199
    v_and_b32 v143, 0xffff0000, v199
    v_lshlrev_b32 v144, 16, v200
    v_and_b32 v145, 0xffff0000, v200
    v_lshlrev_b32 v146, 16, v201
    v_and_b32 v147, 0xffff0000, v201
    v_lshlrev_b32 v148, 16, v202
    v_and_b32 v149, 0xffff0000, v202
    v_lshlrev_b32 v150, 16, v203
    v_and_b32 v151, 0xffff0000, v203
    v_lshlrev_b32 v152, 16, v204
    v_and_b32 v153, 0xffff0000, v204
    v_lshlrev_b32 v154, 16, v205
    v_and_b32 v155, 0xffff0000, v205
    v_lshlrev_b32 v156, 16, v206
    v_and_b32 v157, 0xffff0000, v206
    v_lshlrev_b32 v158, 16, v207
    v_and_b32 v159, 0xffff0000, v207
    v_lshlrev_b32 v160, 16, v208
    v_and_b32 v161, 0xffff0000, v208
    v_lshlrev_b32 v162, 16, v209
    v_and_b32 v163, 0xffff0000, v209
    v_lshlrev_b32 v164, 16, v210
    v_and_b32 v165, 0xffff0000, v210
    v_lshlrev_b32 v166, 16, v211
    v_and_b32 v167, 0xffff0000, v211
    v_lshlrev_b32 v168, 16, v212
    v_and_b32 v169, 0xffff0000, v212
    v_lshlrev_b32 v170, 16, v213
    v_and_b32 v171, 0xffff0000, v213
    v_lshlrev_b32 v172, 16, v214
    v_and_b32 v173, 0xffff0000, v214
    v_lshlrev_b32 v174, 16, v215
    v_and_b32 v175, 0xffff0000, v215
    v_lshlrev_b32 v176, 16, v216
    v_and_b32 v177, 0xffff0000, v216
    v_lshlrev_b32 v178, 16, v217
    v_and_b32 v179, 0xffff0000, v217
    v_lshlrev_b32 v180, 16, v218
    v_and_b32 v181, 0xffff0000, v218
    v_lshlrev_b32 v182, 16, v219
    v_and_b32 v183, 0xffff0000, v219
    v_lshlrev_b32 v184, 16, v220
    v_and_b32 v185, 0xffff0000, v220
    v_lshlrev_b32 v186, 16, v221
    v_and_b32 v187, 0xffff0000, v221
    v_lshlrev_b32 v188, 16, v222
    v_and_b32 v189, 0xffff0000, v222
    v_lshlrev_b32 v190, 16, v223
    v_and_b32 v191, 0xffff0000, v223
    s_branch pb_wj
pb_wg:
    v_lshlrev_b32 v128, 16, v246
    v_and_b32 v129, 0xffff0000, v246
    v_lshlrev_b32 v130, 16, v247
    v_and_b32 v131, 0xffff0000, v247
    v_lshlrev_b32 v132, 16, v248
    v_and_b32 v133, 0xffff0000, v248
    v_lshlrev_b32 v134, 16, v249
    v_and_b32 v135, 0xffff0000, v249
    v_lshlrev_b32 v136, 16, v250
    v_and_b32 v137, 0xffff0000, v250
    v_lshlrev_b32 v138, 16, v251
    v_and_b32 v139, 0xffff0000, v251
    v_lshlrev_b32 v140, 16, v252
    v_and_b32 v141, 0xffff0000, v252
    v_lshlrev_b32 v142, 16, v253
    v_and_b32 v143, 0xffff0000, v253
    v_pk_add_f32 v[0:1], v[0:1], v[128:129]
    v_pk_add_f32 v[2:3], v[2:3], v[130:131]
    v_pk_add_f32 v[4:5], v[4:5], v[128:129]
    v_pk_add_f32 v[6:7], v[6:7], v[130:131]
    v_pk_add_f32 v[8:9], v[8:9], v[128:129]
    v_pk_add_f32 v[10:11], v[10:11], v[130:131]
    v_pk_add_f32 v[12:13], v[12:13], v[128:129]
    v_pk_add_f32 v[14:15], v[14:15], v[130:131]
    v_pk_add_f32 v[16:17], v[16:17], v[132:133]
    v_pk_add_f32 v[18:19], v[18:19], v[134:135]
    v_pk_add_f32 v[20:21], v[20:21], v[132:133]
    v_pk_add_f32 v[22:23], v[22:23], v[134:135]
    v_pk_add_f32 v[24:25], v[24:25], v[132:133]
    v_pk_add_f32 v[26:27], v[26:27], v[134:135]
    v_pk_add_f32 v[28:29], v[28:29], v[132:133]
    v_pk_add_f32 v[30:31], v[30:31], v[134:135]
    v_pk_add_f32 v[32:33], v[32:33], v[136:137]
    v_pk_add_f32 v[34:35], v[34:35], v[138:139]
    v_pk_add_f32 v[36:37], v[36:37], v[136:137]
    v_pk_add_f32 v[38:39], v[38:39], v[138:139]
    v_pk_add_f32 v[40:41], v[40:41], v[136:137]
    v_pk_add_f32 v[42:43], v[42:43], v[138:139]
    v_pk_add_f32 v[44:45], v[44:45], v[136:137]
    v_pk_add_f32 v[46:47], v[46:47], v[138:139]
    v_pk_add_f32 v[48:49], v[48:49], v[140:141]
    v_pk_add_f32 v[50:51], v[50:51], v[142:143]
    v_pk_add_f32 v[52:53], v[52:53], v[140:141]
    v_pk_add_f32 v[54:55], v[54:55], v[142:143]
    v_pk_add_f32 v[56:57], v[56:57], v[140:141]
    v_pk_add_f32 v[58:59], v[58:59], v[142:143]
    v_pk_add_f32 v[60:61], v[60:61], v[140:141]
    v_pk_add_f32 v[62:63], v[62:63], v[142:143]
pb_wj:
    s_waitcnt vmcnt(15)
    v_lshlrev_b32 v192, 16, v96
    v_and_b32 v193, 0xffff0000, v96
    v_pk_add_f32 v[0:1], v[0:1], v[192:193]
    v_lshlrev_b32 v194, 16, v97
    v_and_b32 v195, 0xffff0000, v97
    v_pk_add_f32 v[2:3], v[2:3], v[194:195]
    v_lshlrev_b32 v196, 16, v98
    v_and_b32 v197, 0xffff0000, v98
    v_pk_add_f32 v[4:5], v[4:5], v[196:197]
    v_lshlrev_b32 v198, 16, v99
    v_and_b32 v199, 0xffff0000, v99
    v_pk_add_f32 v[6:7], v[6:7], v[198:199]
    s_waitcnt vmcnt(14)
    v_lshlrev_b32 v200, 16, v100
    v_and_b32 v201, 0xffff0000, v100
    v_pk_add_f32 v[8:9], v[8:9], v[200:201]
    v_lshlrev_b32 v202, 16, v101
    v_and_b32 v203, 0xffff0000, v101
    v_pk_add_f32 v[10:11], v[10:11], v[202:203]
    v_lshlrev_b32 v204, 16, v102
    v_and_b32 v205, 0xffff0000, v102
    v_pk_add_f32 v[12:13], v[12:13], v[204:205]
    v_lshlrev_b32 v206, 16, v103
    v_and_b32 v207, 0xffff0000, v103
    v_pk_add_f32 v[14:15], v[14:15], v[206:207]
    s_waitcnt vmcnt(13)
    v_lshlrev_b32 v192, 16, v104
    v_and_b32 v193, 0xffff0000, v104
    v_pk_add_f32 v[16:17], v[16:17], v[192:193]
    v_lshlrev_b32 v194, 16, v105
    v_and_b32 v195, 0xffff0000, v105
    v_pk_add_f32 v[18:19], v[18:19], v[194:195]
    v_lshlrev_b32 v196, 16, v106
    v_and_b32 v197, 0xffff0000, v106
    v_pk_add_f32 v[20:21], v[20:21], v[196:197]
    v_lshlrev_b32 v198, 16, v107
    v_and_b32 v199, 0xffff0000, v107
    v_pk_add_f32 v[22:23], v[22:23], v[198:199]
    s_waitcnt vmcnt(12)
    v_lshlrev_b32 v200, 16, v108
    v_and_b32 v201, 0xffff0000, v108
    v_pk_add_f32 v[24:25], v[24:25], v[200:201]
    v_lshlrev_b32 v202, 16, v109
    v_and_b32 v203, 0xffff0000, v109
    v_pk_add_f32 v[26:27], v[26:27], v[202:203]
    v_lshlrev_b32 v204, 16, v110
    v_and_b32 v205, 0xffff0000, v110
    v_pk_add_f32 v[28:29], v[28:29], v[204:205]
    v_lshlrev_b32 v206, 16, v111
    v_and_b32 v207, 0xffff0000, v111
    v_pk_add_f32 v[30:31], v[30:31], v[206:207]
    s_waitcnt vmcnt(11)
    v_lshlrev_b32 v192, 16, v112
    v_and_b32 v193, 0xffff0000, v112
    v_pk_add_f32 v[32:33], v[32:33], v[192:193]
    v_lshlrev_b32 v194, 16, v113
    v_and_b32 v195, 0xffff0000, v113
    v_pk_add_f32 v[34:35], v[34:35], v[194:195]
    v_lshlrev_b32 v196, 16, v114
    v_and_b32 v197, 0xffff0000, v114
    v_pk_add_f32 v[36:37], v[36:37], v[196:197]
    v_lshlrev_b32 v198, 16, v115
    v_and_b32 v199, 0xffff0000, v115
    v_pk_add_f32 v[38:39], v[38:39], v[198:199]
    s_waitcnt vmcnt(10)
    v_lshlrev_b32 v200, 16, v116
    v_and_b32 v201, 0xffff0000, v116
    v_pk_add_f32 v[40:41], v[40:41], v[200:201]
    v_lshlrev_b32 v202, 16, v117
    v_and_b32 v203, 0xffff0000, v117
    v_pk_add_f32 v[42:43], v[42:43], v[202:203]
    v_lshlrev_b32 v204, 16, v118
    v_and_b32 v205, 0xffff0000, v118
    v_pk_add_f32 v[44:45], v[44:45], v[204:205]
    v_lshlrev_b32 v206, 16, v119
    v_and_b32 v207, 0xffff0000, v119
    v_pk_add_f32 v[46:47], v[46:47], v[206:207]
    s_waitcnt vmcnt(9)
    v_lshlrev_b32 v192, 16, v120
    v_and_b32 v193, 0xffff0000, v120
    v_pk_add_f32 v[48:49], v[48:49], v[192:193]
    v_lshlrev_b32 v194, 16, v121
    v_and_b32 v195, 0xffff0000, v121
    v_pk_add_f32 v[50:51], v[50:51], v[194:195]
    v_lshlrev_b32 v196, 16, v122
    v_and_b32 v197, 0xffff0000, v122
    v_pk_add_f32 v[52:53], v[52:53], v[196:197]
    v_lshlrev_b32 v198, 16, v123
    v_and_b32 v199, 0xffff0000, v123
    v_pk_add_f32 v[54:55], v[54:55], v[198:199]
    s_waitcnt vmcnt(8)
    v_lshlrev_b32 v200, 16, v124
    v_and_b32 v201, 0xffff0000, v124
    v_pk_add_f32 v[56:57], v[56:57], v[200:201]
    v_lshlrev_b32 v202, 16, v125
    v_and_b32 v203, 0xffff0000, v125
    v_pk_add_f32 v[58:59], v[58:59], v[202:203]
    v_lshlrev_b32 v204, 16, v126
    v_and_b32 v205, 0xffff0000, v126
    v_pk_add_f32 v[60:61], v[60:61], v[204:205]
    v_lshlrev_b32 v206, 16, v127
    v_and_b32 v207, 0xffff0000, v127
    v_pk_add_f32 v[62:63], v[62:63], v[206:207]
    s_cmp_eq_u32 s33, 1
    s_cbranch_scc1 pb_epis
    s_mov_b32 s52, 0xbfb8aa3b
    s_mov_b32 s53, s52
    s_mov_b32 s46, 1.0
    s_mov_b32 s47, 1.0
    v_pk_mul_f32 v[192:193], v[0:1], s[52:53]
    v_pk_mul_f32 v[194:195], v[2:3], s[52:53]
    v_pk_mul_f32 v[196:197], v[16:17], s[52:53]
    v_pk_mul_f32 v[198:199], v[18:19], s[52:53]
    v_exp_f32 v192, v192
    v_exp_f32 v193, v193
    v_exp_f32 v194, v194
    v_exp_f32 v195, v195
    v_exp_f32 v196, v196
    v_exp_f32 v197, v197
    v_exp_f32 v198, v198
    v_exp_f32 v199, v199
    v_pk_add_f32 v[192:193], v[192:193], s[46:47]
    v_pk_add_f32 v[194:195], v[194:195], s[46:47]
    v_pk_add_f32 v[196:197], v[196:197], s[46:47]
    v_pk_add_f32 v[198:199], v[198:199], s[46:47]
    v_rcp_f32 v192, v192
    v_rcp_f32 v193, v193
    v_rcp_f32 v194, v194
    v_rcp_f32 v195, v195
    v_rcp_f32 v196, v196
    v_rcp_f32 v197, v197
    v_rcp_f32 v198, v198
    v_rcp_f32 v199, v199
    v_pk_mul_f32 v[0:1], v[0:1], v[192:193]
    v_pk_mul_f32 v[2:3], v[2:3], v[194:195]
    v_pk_mul_f32 v[16:17], v[16:17], v[196:197]
    v_pk_mul_f32 v[18:19], v[18:19], v[198:199]
    v_cvt_pk_bf16_f32 v96, v0, v1
    v_cvt_pk_bf16_f32 v97, v2, v3
    v_cvt_pk_bf16_f32 v98, v16, v17
    v_cvt_pk_bf16_f32 v99, v18, v19
    s_add_u32 s31, s38, 0
    buffer_store_dwordx4 v[96:99], v229, s[12:15], s31 offen sc1
    v_pk_mul_f32 v[200:201], v[4:5], s[52:53]
    v_pk_mul_f32 v[202:203], v[6:7], s[52:53]
    v_pk_mul_f32 v[204:205], v[20:21], s[52:53]
    v_pk_mul_f32 v[206:207], v[22:23], s[52:53]
    v_exp_f32 v200, v200
    v_exp_f32 v201, v201
    v_exp_f32 v202, v202
    v_exp_f32 v203, v203
    v_exp_f32 v204, v204
    v_exp_f32 v205, v205
    v_exp_f32 v206, v206
    v_exp_f32 v207, v207
    v_pk_add_f32 v[200:201], v[200:201], s[46:47]
    v_pk_add_f32 v[202:203], v[202:203], s[46:47]
    v_pk_add_f32 v[204:205], v[204:205], s[46:47]
    v_pk_add_f32 v[206:207], v[206:207], s[46:47]
    v_rcp_f32 v200, v200
    v_rcp_f32 v201, v201
    v_rcp_f32 v202, v202
    v_rcp_f32 v203, v203
    v_rcp_f32 v204, v204
    v_rcp_f32 v205, v205
    v_rcp_f32 v206, v206
    v_rcp_f32 v207, v207
    v_pk_mul_f32 v[4:5], v[4:5], v[200:201]
    v_pk_mul_f32 v[6:7], v[6:7], v[202:203]
    v_pk_mul_f32 v[20:21], v[20:21], v[204:205]
    v_pk_mul_f32 v[22:23], v[22:23], v[206:207]
    v_cvt_pk_bf16_f32 v100, v4, v5
    v_cvt_pk_bf16_f32 v101, v6, v7
    v_cvt_pk_bf16_f32 v102, v20, v21
    v_cvt_pk_bf16_f32 v103, v22, v23
    s_add_u32 s31, s38, 1024
    buffer_store_dwordx4 v[100:103], v229, s[12:15], s31 offen sc1
    v_pk_mul_f32 v[192:193], v[8:9], s[52:53]
    v_pk_mul_f32 v[194:195], v[10:11], s[52:53]
    v_pk_mul_f32 v[196:197], v[24:25], s[52:53]
    v_pk_mul_f32 v[198:199], v[26:27], s[52:53]
    v_exp_f32 v192, v192
    v_exp_f32 v193, v193
    v_exp_f32 v194, v194
    v_exp_f32 v195, v195
    v_exp_f32 v196, v196
    v_exp_f32 v197, v197
    v_exp_f32 v198, v198
    v_exp_f32 v199, v199
    v_pk_add_f32 v[192:193], v[192:193], s[46:47]
    v_pk_add_f32 v[194:195], v[194:195], s[46:47]
    v_pk_add_f32 v[196:197], v[196:197], s[46:47]
    v_pk_add_f32 v[198:199], v[198:199], s[46:47]
    v_rcp_f32 v192, v192
    v_rcp_f32 v193, v193
    v_rcp_f32 v194, v194
    v_rcp_f32 v195, v195
    v_rcp_f32 v196, v196
    v_rcp_f32 v197, v197
    v_rcp_f32 v198, v198
    v_rcp_f32 v199, v199
    v_pk_mul_f32 v[8:9], v[8:9], v[192:193]
    v_pk_mul_f32 v[10:11], v[10:11], v[194:195]
    v_pk_mul_f32 v[24:25], v[24:25], v[196:197]
    v_pk_mul_f32 v[26:27], v[26:27], v[198:199]
    v_cvt_pk_bf16_f32 v104, v8, v9
    v_cvt_pk_bf16_f32 v105, v10, v11
    v_cvt_pk_bf16_f32 v106, v24, v25
    v_cvt_pk_bf16_f32 v107, v26, v27
    s_add_u32 s31, s38, 2048
    buffer_store_dwordx4 v[104:107], v229, s[12:15], s31 offen sc1
    v_pk_mul_f32 v[200:201], v[12:13], s[52:53]
    v_pk_mul_f32 v[202:203], v[14:15], s[52:53]
    v_pk_mul_f32 v[204:205], v[28:29], s[52:53]
    v_pk_mul_f32 v[206:207], v[30:31], s[52:53]
    v_exp_f32 v200, v200
    v_exp_f32 v201, v201
    v_exp_f32 v202, v202
    v_exp_f32 v203, v203
    v_exp_f32 v204, v204
    v_exp_f32 v205, v205
    v_exp_f32 v206, v206
    v_exp_f32 v207, v207
    v_pk_add_f32 v[200:201], v[200:201], s[46:47]
    v_pk_add_f32 v[202:203], v[202:203], s[46:47]
    v_pk_add_f32 v[204:205], v[204:205], s[46:47]
    v_pk_add_f32 v[206:207], v[206:207], s[46:47]
    v_rcp_f32 v200, v200
    v_rcp_f32 v201, v201
    v_rcp_f32 v202, v202
    v_rcp_f32 v203, v203
    v_rcp_f32 v204, v204
    v_rcp_f32 v205, v205
    v_rcp_f32 v206, v206
    v_rcp_f32 v207, v207
    v_pk_mul_f32 v[12:13], v[12:13], v[200:201]
    v_pk_mul_f32 v[14:15], v[14:15], v[202:203]
    v_pk_mul_f32 v[28:29], v[28:29], v[204:205]
    v_pk_mul_f32 v[30:31], v[30:31], v[206:207]
    v_cvt_pk_bf16_f32 v108, v12, v13
    v_cvt_pk_bf16_f32 v109, v14, v15
    v_cvt_pk_bf16_f32 v110, v28, v29
    v_cvt_pk_bf16_f32 v111, v30, v31
    s_add_u32 s31, s38, 3072
    buffer_store_dwordx4 v[108:111], v229, s[12:15], s31 offen sc1
    v_pk_mul_f32 v[192:193], v[32:33], s[52:53]
    v_pk_mul_f32 v[194:195], v[34:35], s[52:53]
    v_pk_mul_f32 v[196:197], v[48:49], s[52:53]
    v_pk_mul_f32 v[198:199], v[50:51], s[52:53]
    v_exp_f32 v192, v192
    v_exp_f32 v193, v193
    v_exp_f32 v194, v194
    v_exp_f32 v195, v195
    v_exp_f32 v196, v196
    v_exp_f32 v197, v197
    v_exp_f32 v198, v198
    v_exp_f32 v199, v199
    v_pk_add_f32 v[192:193], v[192:193], s[46:47]
    v_pk_add_f32 v[194:195], v[194:195], s[46:47]
    v_pk_add_f32 v[196:197], v[196:197], s[46:47]
    v_pk_add_f32 v[198:199], v[198:199], s[46:47]
    v_rcp_f32 v192, v192
    v_rcp_f32 v193, v193
    v_rcp_f32 v194, v194
    v_rcp_f32 v195, v195
    v_rcp_f32 v196, v196
    v_rcp_f32 v197, v197
    v_rcp_f32 v198, v198
    v_rcp_f32 v199, v199
    v_pk_mul_f32 v[32:33], v[32:33], v[192:193]
    v_pk_mul_f32 v[34:35], v[34:35], v[194:195]
    v_pk_mul_f32 v[48:49], v[48:49], v[196:197]
    v_pk_mul_f32 v[50:51], v[50:51], v[198:199]
    v_cvt_pk_bf16_f32 v112, v32, v33
    v_cvt_pk_bf16_f32 v113, v34, v35
    v_cvt_pk_bf16_f32 v114, v48, v49
    v_cvt_pk_bf16_f32 v115, v50, v51
    s_add_u32 s31, s38, 4096
    buffer_store_dwordx4 v[112:115], v229, s[12:15], s31 offen sc1
    v_pk_mul_f32 v[200:201], v[36:37], s[52:53]
    v_pk_mul_f32 v[202:203], v[38:39], s[52:53]
    v_pk_mul_f32 v[204:205], v[52:53], s[52:53]
    v_pk_mul_f32 v[206:207], v[54:55], s[52:53]
    v_exp_f32 v200, v200
    v_exp_f32 v201, v201
    v_exp_f32 v202, v202
    v_exp_f32 v203, v203
    v_exp_f32 v204, v204
    v_exp_f32 v205, v205
    v_exp_f32 v206, v206
    v_exp_f32 v207, v207
    v_pk_add_f32 v[200:201], v[200:201], s[46:47]
    v_pk_add_f32 v[202:203], v[202:203], s[46:47]
    v_pk_add_f32 v[204:205], v[204:205], s[46:47]
    v_pk_add_f32 v[206:207], v[206:207], s[46:47]
    v_rcp_f32 v200, v200
    v_rcp_f32 v201, v201
    v_rcp_f32 v202, v202
    v_rcp_f32 v203, v203
    v_rcp_f32 v204, v204
    v_rcp_f32 v205, v205
    v_rcp_f32 v206, v206
    v_rcp_f32 v207, v207
    v_pk_mul_f32 v[36:37], v[36:37], v[200:201]
    v_pk_mul_f32 v[38:39], v[38:39], v[202:203]
    v_pk_mul_f32 v[52:53], v[52:53], v[204:205]
    v_pk_mul_f32 v[54:55], v[54:55], v[206:207]
    v_cvt_pk_bf16_f32 v116, v36, v37
    v_cvt_pk_bf16_f32 v117, v38, v39
    v_cvt_pk_bf16_f32 v118, v52, v53
    v_cvt_pk_bf16_f32 v119, v54, v55
    s_add_u32 s31, s38, 5120
    buffer_store_dwordx4 v[116:119], v229, s[12:15], s31 offen sc1
    v_pk_mul_f32 v[192:193], v[40:41], s[52:53]
    v_pk_mul_f32 v[194:195], v[42:43], s[52:53]
    v_pk_mul_f32 v[196:197], v[56:57], s[52:53]
    v_pk_mul_f32 v[198:199], v[58:59], s[52:53]
    v_exp_f32 v192, v192
    v_exp_f32 v193, v193
    v_exp_f32 v194, v194
    v_exp_f32 v195, v195
    v_exp_f32 v196, v196
    v_exp_f32 v197, v197
    v_exp_f32 v198, v198
    v_exp_f32 v199, v199
    v_pk_add_f32 v[192:193], v[192:193], s[46:47]
    v_pk_add_f32 v[194:195], v[194:195], s[46:47]
    v_pk_add_f32 v[196:197], v[196:197], s[46:47]
    v_pk_add_f32 v[198:199], v[198:199], s[46:47]
    v_rcp_f32 v192, v192
    v_rcp_f32 v193, v193
    v_rcp_f32 v194, v194
    v_rcp_f32 v195, v195
    v_rcp_f32 v196, v196
    v_rcp_f32 v197, v197
    v_rcp_f32 v198, v198
    v_rcp_f32 v199, v199
    v_pk_mul_f32 v[40:41], v[40:41], v[192:193]
    v_pk_mul_f32 v[42:43], v[42:43], v[194:195]
    v_pk_mul_f32 v[56:57], v[56:57], v[196:197]
    v_pk_mul_f32 v[58:59], v[58:59], v[198:199]
    v_cvt_pk_bf16_f32 v120, v40, v41
    v_cvt_pk_bf16_f32 v121, v42, v43
    v_cvt_pk_bf16_f32 v122, v56, v57
    v_cvt_pk_bf16_f32 v123, v58, v59
    s_add_u32 s31, s38, 6144
    buffer_store_dwordx4 v[120:123], v229, s[12:15], s31 offen sc1
    v_pk_mul_f32 v[200:201], v[44:45], s[52:53]
    v_pk_mul_f32 v[202:203], v[46:47], s[52:53]
    v_pk_mul_f32 v[204:205], v[60:61], s[52:53]
    v_pk_mul_f32 v[206:207], v[62:63], s[52:53]
    v_exp_f32 v200, v200
    v_exp_f32 v201, v201
    v_exp_f32 v202, v202
    v_exp_f32 v203, v203
    v_exp_f32 v204, v204
    v_exp_f32 v205, v205
    v_exp_f32 v206, v206
    v_exp_f32 v207, v207
    v_pk_add_f32 v[200:201], v[200:201], s[46:47]
    v_pk_add_f32 v[202:203], v[202:203], s[46:47]
    v_pk_add_f32 v[204:205], v[204:205], s[46:47]
    v_pk_add_f32 v[206:207], v[206:207], s[46:47]
    v_rcp_f32 v200, v200
    v_rcp_f32 v201, v201
    v_rcp_f32 v202, v202
    v_rcp_f32 v203, v203
    v_rcp_f32 v204, v204
    v_rcp_f32 v205, v205
    v_rcp_f32 v206, v206
    v_rcp_f32 v207, v207
    v_pk_mul_f32 v[44:45], v[44:45], v[200:201]
    v_pk_mul_f32 v[46:47], v[46:47], v[202:203]
    v_pk_mul_f32 v[60:61], v[60:61], v[204:205]
    v_pk_mul_f32 v[62:63], v[62:63], v[206:207]
    v_cvt_pk_bf16_f32 v124, v44, v45
    v_cvt_pk_bf16_f32 v125, v46, v47
    v_cvt_pk_bf16_f32 v126, v60, v61
    v_cvt_pk_bf16_f32 v127, v62, v63
    s_add_u32 s31, s38, 7168
    buffer_store_dwordx4 v[124:127], v229, s[12:15], s31 offen sc1
    s_waitcnt vmcnt(0)
    s_mov_b64 exec, 1
    v_mov_b32 v230, s100
    buffer_store_dword v230, v240, s[12:15], s60 offen sc1
    s_waitcnt vmcnt(0)
    s_branch pb_fin
pb_epis:
    s_cmp_lg_u32 s54, 0
    s_cbranch_scc1 pb_haveg
    s_mov_b32 s53, 0x80000
pb_poll:
    buffer_load_dword v236, v240, s[12:15], s60 offen sc1
    s_waitcnt vmcnt(0)
    v_readfirstlane_b32 s54, v236
    s_nop 4
    s_cmp_eq_u32 s54, s100
    s_cbranch_scc1 pb_polled
    s_sleep 1
    s_sub_u32 s53, s53, 1
    s_cmp_lg_u32 s53, 0
    s_cbranch_scc1 pb_poll
pb_polled:
    s_add_u32 s31, s38, 0
    buffer_load_dwordx4 v[64:67], v229, s[12:15], s31 offen sc1
    s_add_u32 s31, s38, 1024
    buffer_load_dwordx4 v[68:71], v229, s[12:15], s31 offen sc1
    s_add_u32 s31, s38, 2048
    buffer_load_dwordx4 v[72:75], v229, s[12:15], s31 offen sc1
    s_add_u32 s31, s38, 3072
    buffer_load_dwordx4 v[76:79], v229, s[12:15], s31 offen sc1
    s_add_u32 s31, s38, 4096
    buffer_load_dwordx4 v[80:83], v229, s[12:15], s31 offen sc1
    s_add_u32 s31, s38, 5120
    buffer_load_dwordx4 v[84:87], v229, s[12:15], s31 offen sc1
    s_add_u32 s31, s38, 6144
    buffer_load_dwordx4 v[88:91], v229, s[12:15], s31 offen sc1
    s_add_u32 s31, s38, 7168
    buffer_load_dwordx4 v[92:95], v229, s[12:15], s31 offen sc1
pb_haveg:
    s_waitcnt vmcnt(0)
    s_add_u32 s31, s50, 0
    v_lshlrev_b32 v192, 16, v64
    v_and_b32 v193, 0xffff0000, v64
    v_lshlrev_b32 v194, 16, v65
    v_and_b32 v195, 0xffff0000, v65
    v_lshlrev_b32 v200, 16, v66
    v_and_b32 v201, 0xffff0000, v66
    v_lshlrev_b32 v202, 16, v67
    v_and_b32 v203, 0xffff0000, v67
    v_pk_fma_f32 v[0:1], v[0:1], v[192:193], v[128:129]
    v_pk_fma_f32 v[2:3], v[2:3], v[194:195], v[130:131]
    v_pk_fma_f32 v[16:17], v[16:17], v[200:201], v[132:133]
    v_pk_fma_f32 v[18:19], v[18:19], v[202:203], v[134:135]
    v_cvt_pk_bf16_f32 v96, v0, v1
    v_cvt_pk_bf16_f32 v97, v2, v3
    v_cvt_pk_bf16_f32 v98, v16, v17
    v_cvt_pk_bf16_f32 v99, v18, v19
    s_nop 0
    v_permlane16_swap_b32 v96, v98
    v_permlane16_swap_b32 v97, v99
    buffer_store_dwordx4 v[96:99], v234, s[20:23], s31 offen offset:0 sc1
    v_lshlrev_b32 v208, 16, v80
    v_and_b32 v209, 0xffff0000, v80
    v_lshlrev_b32 v210, 16, v81
    v_and_b32 v211, 0xffff0000, v81
    v_lshlrev_b32 v216, 16, v82
    v_and_b32 v217, 0xffff0000, v82
    v_lshlrev_b32 v218, 16, v83
    v_and_b32 v219, 0xffff0000, v83
    v_pk_fma_f32 v[32:33], v[32:33], v[208:209], v[160:161]
    v_pk_fma_f32 v[34:35], v[34:35], v[210:211], v[162:163]
    v_pk_fma_f32 v[48:49], v[48:49], v[216:217], v[164:165]
    v_pk_fma_f32 v[50:51], v[50:51], v[218:219], v[166:167]
    v_cvt_pk_bf16_f32 v112, v32, v33
    v_cvt_pk_bf16_f32 v113, v34, v35
    v_cvt_pk_bf16_f32 v114, v48, v49
    v_cvt_pk_bf16_f32 v115, v50, v51
    s_nop 0
    v_permlane16_swap_b32 v112, v114
    v_permlane16_swap_b32 v113, v115
    buffer_store_dwordx4 v[112:115], v234, s[20:23], s31 offen offset:64 sc1
    s_add_u32 s31, s50, 32768
    v_lshlrev_b32 v192, 16, v68
    v_and_b32 v193, 0xffff0000, v68
    v_lshlrev_b32 v194, 16, v69
    v_and_b32 v195, 0xffff0000, v69
    v_lshlrev_b32 v200, 16, v70
    v_and_b32 v201, 0xffff0000, v70
    v_lshlrev_b32 v202, 16, v71
    v_and_b32 v203, 0xffff0000, v71
    v_pk_fma_f32 v[4:5], v[4:5], v[192:193], v[136:137]
    v_pk_fma_f32 v[6:7], v[6:7], v[194:195], v[138:139]
    v_pk_fma_f32 v[20:21], v[20:21], v[200:201], v[140:141]
    v_pk_fma_f32 v[22:23], v[22:23], v[202:203], v[142:143]
    v_cvt_pk_bf16_f32 v100, v4, v5
    v_cvt_pk_bf16_f32 v101, v6, v7
    v_cvt_pk_bf16_f32 v102, v20, v21
    v_cvt_pk_bf16_f32 v103, v22, v23
    s_nop 0
    v_permlane16_swap_b32 v100, v102
    v_permlane16_swap_b32 v101, v103
    buffer_store_dwordx4 v[100:103], v234, s[20:23], s31 offen offset:0 sc1
    v_lshlrev_b32 v208, 16, v84
    v_and_b32 v209, 0xffff0000, v84
    v_lshlrev_b32 v210, 16, v85
    v_and_b32 v211, 0xffff0000, v85
    v_lshlrev_b32 v216, 16, v86
    v_and_b32 v217, 0xffff0000, v86
    v_lshlrev_b32 v218, 16, v87
    v_and_b32 v219, 0xffff0000, v87
    v_pk_fma_f32 v[36:37], v[36:37], v[208:209], v[168:169]
    v_pk_fma_f32 v[38:39], v[38:39], v[210:211], v[170:171]
    v_pk_fma_f32 v[52:53], v[52:53], v[216:217], v[172:173]
    v_pk_fma_f32 v[54:55], v[54:55], v[218:219], v[174:175]
    v_cvt_pk_bf16_f32 v116, v36, v37
    v_cvt_pk_bf16_f32 v117, v38, v39
    v_cvt_pk_bf16_f32 v118, v52, v53
    v_cvt_pk_bf16_f32 v119, v54, v55
    s_nop 0
    v_permlane16_swap_b32 v116, v118
    v_permlane16_swap_b32 v117, v119
    buffer_store_dwordx4 v[116:119], v234, s[20:23], s31 offen offset:64 sc1
    s_add_u32 s31, s50, 65536
    v_lshlrev_b32 v192, 16, v72
    v_and_b32 v193, 0xffff0000, v72
    v_lshlrev_b32 v194, 16, v73
    v_and_b32 v195, 0xffff0000, v73
    v_lshlrev_b32 v200, 16, v74
    v_and_b32 v201, 0xffff0000, v74
    v_lshlrev_b32 v202, 16, v75
    v_and_b32 v203, 0xffff0000, v75
    v_pk_fma_f32 v[8:9], v[8:9], v[192:193], v[144:145]
    v_pk_fma_f32 v[10:11], v[10:11], v[194:195], v[146:147]
    v_pk_fma_f32 v[24:25], v[24:25], v[200:201], v[148:149]
    v_pk_fma_f32 v[26:27], v[26:27], v[202:203], v[150:151]
    v_cvt_pk_bf16_f32 v104, v8, v9
    v_cvt_pk_bf16_f32 v105, v10, v11
    v_cvt_pk_bf16_f32 v106, v24, v25
    v_cvt_pk_bf16_f32 v107, v26, v27
    s_nop 0
    v_permlane16_swap_b32 v104, v106
    v_permlane16_swap_b32 v105, v107
    buffer_store_dwordx4 v[104:107], v234, s[20:23], s31 offen offset:0 sc1
    v_lshlrev_b32 v208, 16, v88
    v_and_b32 v209, 0xffff0000, v88
    v_lshlrev_b32 v210, 16, v89
    v_and_b32 v211, 0xffff0000, v89
    v_lshlrev_b32 v216, 16, v90
    v_and_b32 v217, 0xffff0000, v90
    v_lshlrev_b32 v218, 16, v91
    v_and_b32 v219, 0xffff0000, v91
    v_pk_fma_f32 v[40:41], v[40:41], v[208:209], v[176:177]
    v_pk_fma_f32 v[42:43], v[42:43], v[210:211], v[178:179]
    v_pk_fma_f32 v[56:57], v[56:57], v[216:217], v[180:181]
    v_pk_fma_f32 v[58:59], v[58:59], v[218:219], v[182:183]
    v_cvt_pk_bf16_f32 v120, v40, v41
    v_cvt_pk_bf16_f32 v121, v42, v43
    v_cvt_pk_bf16_f32 v122, v56, v57
    v_cvt_pk_bf16_f32 v123, v58, v59
    s_nop 0
    v_permlane16_swap_b32 v120, v122
    v_permlane16_swap_b32 v121, v123
    buffer_store_dwordx4 v[120:123], v234, s[20:23], s31 offen offset:64 sc1
    s_add_u32 s31, s50, 98304
    v_lshlrev_b32 v192, 16, v76
    v_and_b32 v193, 0xffff0000, v76
    v_lshlrev_b32 v194, 16, v77
    v_and_b32 v195, 0xffff0000, v77
    v_lshlrev_b32 v200, 16, v78
    v_and_b32 v201, 0xffff0000, v78
    v_lshlrev_b32 v202, 16, v79
    v_and_b32 v203, 0xffff0000, v79
    v_pk_fma_f32 v[12:13], v[12:13], v[192:193], v[152:153]
    v_pk_fma_f32 v[14:15], v[14:15], v[194:195], v[154:155]
    v_pk_fma_f32 v[28:29], v[28:29], v[200:201], v[156:157]
    v_pk_fma_f32 v[30:31], v[30:31], v[202:203], v[158:159]
    v_cvt_pk_bf16_f32 v108, v12, v13
    v_cvt_pk_bf16_f32 v109, v14, v15
    v_cvt_pk_bf16_f32 v110, v28, v29
    v_cvt_pk_bf16_f32 v111, v30, v31
    s_nop 0
    v_permlane16_swap_b32 v108, v110
    v_permlane16_swap_b32 v109, v111
    buffer_store_dwordx4 v[108:111], v234, s[20:23], s31 offen offset:0 sc1
    v_lshlrev_b32 v208, 16, v92
    v_and_b32 v209, 0xffff0000, v92
    v_lshlrev_b32 v210, 16, v93
    v_and_b32 v211, 0xffff0000, v93
    v_lshlrev_b32 v216, 16, v94
    v_and_b32 v217, 0xffff0000, v94
    v_lshlrev_b32 v218, 16, v95
    v_and_b32 v219, 0xffff0000, v95
    v_pk_fma_f32 v[44:45], v[44:45], v[208:209], v[184:185]
    v_pk_fma_f32 v[46:47], v[46:47], v[210:211], v[186:187]
    v_pk_fma_f32 v[60:61], v[60:61], v[216:217], v[188:189]
    v_pk_fma_f32 v[62:63], v[62:63], v[218:219], v[190:191]
    v_cvt_pk_bf16_f32 v124, v44, v45
    v_cvt_pk_bf16_f32 v125, v46, v47
    v_cvt_pk_bf16_f32 v126, v60, v61
    v_cvt_pk_bf16_f32 v127, v62, v63
    s_nop 0
    v_permlane16_swap_b32 v124, v126
    v_permlane16_swap_b32 v125, v127
    buffer_store_dwordx4 v[124:127], v234, s[20:23], s31 offen offset:64 sc1
pb_fin:
    s_endpgm
pa_slow:
    s_nop 15
    s_waitcnt vmcnt(0) lgkmcnt(0)
    v_mov_b32 v0, 0
    v_mov_b32 v1, 0
    v_mov_b32 v2, 0
    v_mov_b32 v3, 0
    v_mov_b32 v4, 0
    v_mov_b32 v5, 0
    v_mov_b32 v6, 0
    v_mov_b32 v7, 0
    v_mov_b32 v8, 0
    v_mov_b32 v9, 0
    v_mov_b32 v10, 0
    v_mov_b32 v11, 0
    v_mov_b32 v12, 0
    v_mov_b32 v13, 0
    v_mov_b32 v14, 0
    v_mov_b32 v15, 0
    v_mov_b32 v16, 0
    v_mov_b32 v17, 0
    v_mov_b32 v18, 0
    v_mov_b32 v19, 0
    v_mov_b32 v20, 0
    v_mov_b32 v21, 0
    v_mov_b32 v22, 0
    v_mov_b32 v23, 0
    v_mov_b32 v24, 0
    v_mov_b32 v25, 0
    v_mov_b32 v26, 0
    v_mov_b32 v27, 0
    v_mov_b32 v28, 0
    v_mov_b32 v29, 0
    v_mov_b32 v30, 0
    v_mov_b32 v31, 0
    v_mov_b32 v32, 0
    v_mov_b32 v33, 0
    v_mov_b32 v34, 0
    v_mov_b32 v35, 0
    v_mov_b32 v36, 0
    v_mov_b32 v37, 0
    v_mov_b32 v38, 0
    v_mov_b32 v39, 0
    v_mov_b32 v40, 0
    v_mov_b32 v41, 0
    v_mov_b32 v42, 0
    v_mov_b32 v43, 0
    v_mov_b32 v44, 0
    v_mov_b32 v45, 0
    v_mov_b32 v46, 0
    v_mov_b32 v47, 0
    v_mov_b32 v48, 0
    v_mov_b32 v49, 0
    v_mov_b32 v50, 0
    v_mov_b32 v51, 0
    v_mov_b32 v52, 0
    v_mov_b32 v53, 0
    v_mov_b32 v54, 0
    v_mov_b32 v55, 0
    v_mov_b32 v56, 0
    v_mov_b32 v57, 0
    v_mov_b32 v58, 0
    v_mov_b32 v59, 0
    v_mov_b32 v60, 0
    v_mov_b32 v61, 0
    v_mov_b32 v62, 0
    v_mov_b32 v63, 0
    v_mov_b32 v64, 0
    v_mov_b32 v65, 0
    v_mov_b32 v66, 0
    v_mov_b32 v67, 0
    v_mov_b32 v68, 0
    v_mov_b32 v69, 0
    v_mov_b32 v70, 0
    v_mov_b32 v71, 0
    v_mov_b32 v72, 0
    v_mov_b32 v73, 0
    v_mov_b32 v74, 0
    v_mov_b32 v75, 0
    v_mov_b32 v76, 0
    v_mov_b32 v77, 0
    v_mov_b32 v78, 0
    v_mov_b32 v79, 0
    v_mov_b32 v80, 0
    v_mov_b32 v81, 0
    v_mov_b32 v82, 0
    v_mov_b32 v83, 0
    v_mov_b32 v84, 0
    v_mov_b32 v85, 0
    v_mov_b32 v86, 0
    v_mov_b32 v87, 0
    v_mov_b32 v88, 0
    v_mov_b32 v89, 0
    v_mov_b32 v90, 0
    v_mov_b32 v91, 0
    v_mov_b32 v92, 0
    v_mov_b32 v93, 0
    v_mov_b32 v94, 0
    v_mov_b32 v95, 0
    v_mov_b32 v96, 0
    v_mov_b32 v97, 0
    v_mov_b32 v98, 0
    v_mov_b32 v99, 0
    v_mov_b32 v100, 0
    v_mov_b32 v101, 0
    v_mov_b32 v102, 0
    v_mov_b32 v103, 0
    v_mov_b32 v104, 0
    v_mov_b32 v105, 0
    v_mov_b32 v106, 0
    v_mov_b32 v107, 0
    v_mov_b32 v108, 0
    v_mov_b32 v109, 0
    v_mov_b32 v110, 0
    v_mov_b32 v111, 0
    v_mov_b32 v112, 0
    v_mov_b32 v113, 0
    v_mov_b32 v114, 0
    v_mov_b32 v115, 0
    v_mov_b32 v116, 0
    v_mov_b32 v117, 0
    v_mov_b32 v118, 0
    v_mov_b32 v119, 0
    v_mov_b32 v120, 0
    v_mov_b32 v121, 0
    v_mov_b32 v122, 0
    v_mov_b32 v123, 0
    v_mov_b32 v124, 0
    v_mov_b32 v125, 0
    v_mov_b32 v126, 0
    v_mov_b32 v127, 0
    v_mov_b32 v245, 0
    v_accvgpr_write_b32 a128, v245
    v_accvgpr_write_b32 a129, v245
    v_accvgpr_write_b32 a130, v245
    v_accvgpr_write_b32 a131, v245
    v_accvgpr_write_b32 a132, v245
    v_accvgpr_write_b32 a133, v245
    v_accvgpr_write_b32 a134, v245
    v_accvgpr_write_b32 a135, v245
    v_accvgpr_write_b32 a136, v245
    v_accvgpr_write_b32 a137, v245
    v_accvgpr_write_b32 a138, v245
    v_accvgpr_write_b32 a139, v245
    v_accvgpr_write_b32 a140, v245
    v_accvgpr_write_b32 a141, v245
    v_accvgpr_write_b32 a142, v245
    v_accvgpr_write_b32 a143, v245
    v_mov_b32 v232, 0xff7fffff
    v_mov_b32 v233, 0xff7fffff
    v_mov_b32 v234, 0xff7fffff
    v_mov_b32 v235, 0xff7fffff
    s_add_u32 s47, s50, 5242880
    s_add_u32 s48, s50, 5767168
    s_mov_b32 s44, 16
pa_sl:
    s_add_u32 s40, s47, 0
    buffer_load_dwordx4 a[64:67], v244, s[16:19], s40 offen sc1
    s_add_u32 s40, s47, 1024
    buffer_load_dwordx4 a[68:71], v244, s[16:19], s40 offen sc1
    s_add_u32 s40, s47, 2048
    buffer_load_dwordx4 a[72:75], v244, s[16:19], s40 offen sc1
    s_add_u32 s40, s47, 3072
    buffer_load_dwordx4 a[76:79], v244, s[16:19], s40 offen sc1
    s_add_u32 s40, s47, 4096
    buffer_load_dwordx4 a[80:83], v244, s[16:19], s40 offen sc1
    s_add_u32 s40, s47, 5120
    buffer_load_dwordx4 a[84:87], v244, s[16:19], s40 offen sc1
    s_add_u32 s40, s47, 6144
    buffer_load_dwordx4 a[88:91], v244, s[16:19], s40 offen sc1
    s_add_u32 s40, s47, 7168
    buffer_load_dwordx4 a[92:95], v244, s[16:19], s40 offen sc1
    s_add_u32 s40, s48, 0
    buffer_load_dwordx4 a[96:99], v244, s[16:19], s40 offen sc1
    s_add_u32 s40, s48, 1024
    buffer_load_dwordx4 a[100:103], v244, s[16:19], s40 offen sc1
    s_add_u32 s40, s48, 2048
    buffer_load_dwordx4 a[104:107], v244, s[16:19], s40 offen sc1
    s_add_u32 s40, s48, 3072
    buffer_load_dwordx4 a[108:111], v244, s[16:19], s40 offen sc1
    s_add_u32 s40, s48, 4096
    buffer_load_dwordx4 a[112:115], v244, s[16:19], s40 offen sc1
    s_add_u32 s40, s48, 5120
    buffer_load_dwordx4 a[116:119], v244, s[16:19], s40 offen sc1
    s_add_u32 s40, s48, 6144
    buffer_load_dwordx4 a[120:123], v244, s[16:19], s40 offen sc1
    s_add_u32 s40, s48, 7168
    buffer_load_dwordx4 a[124:127], v244, s[16:19], s40 offen sc1
    s_waitcnt vmcnt(0)
    v_mfma_f32_16x16x32_bf16 v[128:131], a[64:67], a[0:3], 0
    v_mfma_f32_16x16x32_bf16 v[132:135], a[64:67], a[16:19], 0
    v_mfma_f32_16x16x32_bf16 v[136:139], a[64:67], a[32:35], 0
    v_mfma_f32_16x16x32_bf16 v[140:143], a[64:67], a[48:51], 0
    v_mfma_f32_16x16x32_bf16 v[128:131], a[68:71], a[4:7], v[128:131]
    v_mfma_f32_16x16x32_bf16 v[132:135], a[68:71], a[20:23], v[132:135]
    v_mfma_f32_16x16x32_bf16 v[136:139], a[68:71], a[36:39], v[136:139]
    v_mfma_f32_16x16x32_bf16 v[140:143], a[68:71], a[52:55], v[140:143]
    v_mfma_f32_16x16x32_bf16 v[128:131], a[72:75], a[8:11], v[128:131]
    v_mfma_f32_16x16x32_bf16 v[132:135], a[72:75], a[24:27], v[132:135]
    v_mfma_f32_16x16x32_bf16 v[136:139], a[72:75], a[40:43], v[136:139]
    v_mfma_f32_16x16x32_bf16 v[140:143], a[72:75], a[56:59], v[140:143]
    v_mfma_f32_16x16x32_bf16 v[128:131], a[76:79], a[12:15], v[128:131]
    v_mfma_f32_16x16x32_bf16 v[132:135], a[76:79], a[28:31], v[132:135]
    v_mfma_f32_16x16x32_bf16 v[136:139], a[76:79], a[44:47], v[136:139]
    v_mfma_f32_16x16x32_bf16 v[140:143], a[76:79], a[60:63], v[140:143]
    v_mfma_f32_16x16x32_bf16 v[144:147], a[80:83], a[0:3], 0
    v_mfma_f32_16x16x32_bf16 v[148:151], a[80:83], a[16:19], 0
    v_mfma_f32_16x16x32_bf16 v[152:155], a[80:83], a[32:35], 0
    v_mfma_f32_16x16x32_bf16 v[156:159], a[80:83], a[48:51], 0
    v_mfma_f32_16x16x32_bf16 v[144:147], a[84:87], a[4:7], v[144:147]
    v_mfma_f32_16x16x32_bf16 v[148:151], a[84:87], a[20:23], v[148:151]
    v_mfma_f32_16x16x32_bf16 v[152:155], a[84:87], a[36:39], v[152:155]
    v_mfma_f32_16x16x32_bf16 v[156:159], a[84:87], a[52:55], v[156:159]
    v_mfma_f32_16x16x32_bf16 v[144:147], a[88:91], a[8:11], v[144:147]
    v_mfma_f32_16x16x32_bf16 v[148:151], a[88:91], a[24:27], v[148:151]
    v_mfma_f32_16x16x32_bf16 v[152:155], a[88:91], a[40:43], v[152:155]
    v_mfma_f32_16x16x32_bf16 v[156:159], a[88:91], a[56:59], v[156:159]
    v_mfma_f32_16x16x32_bf16 v[144:147], a[92:95], a[12:15], v[144:147]
    v_mfma_f32_16x16x32_bf16 v[148:151], a[92:95], a[28:31], v[148:151]
    v_mfma_f32_16x16x32_bf16 v[152:155], a[92:95], a[44:47], v[152:155]
    v_mfma_f32_16x16x32_bf16 v[156:159], a[92:95], a[60:63], v[156:159]
    s_nop 15
    v_max3_f32 v245, v128, v129, v130
    v_max3_f32 v246, v131, v144, v145
    v_max3_f32 v245, v245, v146, v147
    v_max_f32 v245, v245, v246
    v_mov_b32 v246, v245
    s_nop 1
    v_permlane32_swap_b32 v245, v246
    v_max_f32 v245, v245, v246
    v_mov_b32 v246, v245
    s_nop 1
    v_permlane16_swap_b32 v245, v246
    v_max3_f32 v245, v245, v246, v232
    v_sub_f32 v247, v232, v245
    v_exp_f32 v247, v247
    v_mov_b32 v232, v245
    v_sub_f32 v128, v128, v245
    v_sub_f32 v144, v144, v245
    v_sub_f32 v129, v129, v245
    v_sub_f32 v145, v145, v245
    v_sub_f32 v130, v130, v245
    v_sub_f32 v146, v146, v245
    v_sub_f32 v131, v131, v245
    v_sub_f32 v147, v147, v245
    v_exp_f32 v128, v128
    v_exp_f32 v144, v144
    v_exp_f32 v129, v129
    v_exp_f32 v145, v145
    v_exp_f32 v130, v130
    v_exp_f32 v146, v146
    v_exp_f32 v131, v131
    v_exp_f32 v147, v147
    v_cvt_pk_bf16_f32 v192, v128, v129
    v_cvt_pk_bf16_f32 v193, v130, v131
    v_cvt_pk_bf16_f32 v194, v144, v145
    v_cvt_pk_bf16_f32 v195, v146, v147
    v_mul_f32 v0, v0, v247
    v_mul_f32 v1, v1, v247
    v_mul_f32 v2, v2, v247
    v_mul_f32 v3, v3, v247
    v_mul_f32 v16, v16, v247
    v_mul_f32 v17, v17, v247
    v_mul_f32 v18, v18, v247
    v_mul_f32 v19, v19, v247
    v_mul_f32 v32, v32, v247
    v_mul_f32 v33, v33, v247
    v_mul_f32 v34, v34, v247
    v_mul_f32 v35, v35, v247
    v_mul_f32 v48, v48, v247
    v_mul_f32 v49, v49, v247
    v_mul_f32 v50, v50, v247
    v_mul_f32 v51, v51, v247
    v_mul_f32 v64, v64, v247
    v_mul_f32 v65, v65, v247
    v_mul_f32 v66, v66, v247
    v_mul_f32 v67, v67, v247
    v_mul_f32 v80, v80, v247
    v_mul_f32 v81, v81, v247
    v_mul_f32 v82, v82, v247
    v_mul_f32 v83, v83, v247
    v_mul_f32 v96, v96, v247
    v_mul_f32 v97, v97, v247
    v_mul_f32 v98, v98, v247
    v_mul_f32 v99, v99, v247
    v_mul_f32 v112, v112, v247
    v_mul_f32 v113, v113, v247
    v_mul_f32 v114, v114, v247
    v_mul_f32 v115, v115, v247
    v_accvgpr_read_b32 v246, a128
    v_mul_f32 v246, v246, v247
    v_accvgpr_write_b32 a128, v246
    v_max3_f32 v245, v132, v133, v134
    v_max3_f32 v246, v135, v148, v149
    v_max3_f32 v245, v245, v150, v151
    v_max_f32 v245, v245, v246
    v_mov_b32 v246, v245
    s_nop 1
    v_permlane32_swap_b32 v245, v246
    v_max_f32 v245, v245, v246
    v_mov_b32 v246, v245
    s_nop 1
    v_permlane16_swap_b32 v245, v246
    v_max3_f32 v245, v245, v246, v233
    v_sub_f32 v247, v233, v245
    v_exp_f32 v247, v247
    v_mov_b32 v233, v245
    v_sub_f32 v132, v132, v245
    v_sub_f32 v148, v148, v245
    v_sub_f32 v133, v133, v245
    v_sub_f32 v149, v149, v245
    v_sub_f32 v134, v134, v245
    v_sub_f32 v150, v150, v245
    v_sub_f32 v135, v135, v245
    v_sub_f32 v151, v151, v245
    v_exp_f32 v132, v132
    v_exp_f32 v148, v148
    v_exp_f32 v133, v133
    v_exp_f32 v149, v149
    v_exp_f32 v134, v134
    v_exp_f32 v150, v150
    v_exp_f32 v135, v135
    v_exp_f32 v151, v151
    v_cvt_pk_bf16_f32 v196, v132, v133
    v_cvt_pk_bf16_f32 v197, v134, v135
    v_cvt_pk_bf16_f32 v198, v148, v149
    v_cvt_pk_bf16_f32 v199, v150, v151
    v_mul_f32 v4, v4, v247
    v_mul_f32 v5, v5, v247
    v_mul_f32 v6, v6, v247
    v_mul_f32 v7, v7, v247
    v_mul_f32 v20, v20, v247
    v_mul_f32 v21, v21, v247
    v_mul_f32 v22, v22, v247
    v_mul_f32 v23, v23, v247
    v_mul_f32 v36, v36, v247
    v_mul_f32 v37, v37, v247
    v_mul_f32 v38, v38, v247
    v_mul_f32 v39, v39, v247
    v_mul_f32 v52, v52, v247
    v_mul_f32 v53, v53, v247
    v_mul_f32 v54, v54, v247
    v_mul_f32 v55, v55, v247
    v_mul_f32 v68, v68, v247
    v_mul_f32 v69, v69, v247
    v_mul_f32 v70, v70, v247
    v_mul_f32 v71, v71, v247
    v_mul_f32 v84, v84, v247
    v_mul_f32 v85, v85, v247
    v_mul_f32 v86, v86, v247
    v_mul_f32 v87, v87, v247
    v_mul_f32 v100, v100, v247
    v_mul_f32 v101, v101, v247
    v_mul_f32 v102, v102, v247
    v_mul_f32 v103, v103, v247
    v_mul_f32 v116, v116, v247
    v_mul_f32 v117, v117, v247
    v_mul_f32 v118, v118, v247
    v_mul_f32 v119, v119, v247
    v_accvgpr_read_b32 v246, a132
    v_mul_f32 v246, v246, v247
    v_accvgpr_write_b32 a132, v246
    v_max3_f32 v245, v136, v137, v138
    v_max3_f32 v246, v139, v152, v153
    v_max3_f32 v245, v245, v154, v155
    v_max_f32 v245, v245, v246
    v_mov_b32 v246, v245
    s_nop 1
    v_permlane32_swap_b32 v245, v246
    v_max_f32 v245, v245, v246
    v_mov_b32 v246, v245
    s_nop 1
    v_permlane16_swap_b32 v245, v246
    v_max3_f32 v245, v245, v246, v234
    v_sub_f32 v247, v234, v245
    v_exp_f32 v247, v247
    v_mov_b32 v234, v245
    v_sub_f32 v136, v136, v245
    v_sub_f32 v152, v152, v245
    v_sub_f32 v137, v137, v245
    v_sub_f32 v153, v153, v245
    v_sub_f32 v138, v138, v245
    v_sub_f32 v154, v154, v245
    v_sub_f32 v139, v139, v245
    v_sub_f32 v155, v155, v245
    v_exp_f32 v136, v136
    v_exp_f32 v152, v152
    v_exp_f32 v137, v137
    v_exp_f32 v153, v153
    v_exp_f32 v138, v138
    v_exp_f32 v154, v154
    v_exp_f32 v139, v139
    v_exp_f32 v155, v155
    v_cvt_pk_bf16_f32 v200, v136, v137
    v_cvt_pk_bf16_f32 v201, v138, v139
    v_cvt_pk_bf16_f32 v202, v152, v153
    v_cvt_pk_bf16_f32 v203, v154, v155
    v_mul_f32 v8, v8, v247
    v_mul_f32 v9, v9, v247
    v_mul_f32 v10, v10, v247
    v_mul_f32 v11, v11, v247
    v_mul_f32 v24, v24, v247
    v_mul_f32 v25, v25, v247
    v_mul_f32 v26, v26, v247
    v_mul_f32 v27, v27, v247
    v_mul_f32 v40, v40, v247
    v_mul_f32 v41, v41, v247
    v_mul_f32 v42, v42, v247
    v_mul_f32 v43, v43, v247
    v_mul_f32 v56, v56, v247
    v_mul_f32 v57, v57, v247
    v_mul_f32 v58, v58, v247
    v_mul_f32 v59, v59, v247
    v_mul_f32 v72, v72, v247
    v_mul_f32 v73, v73, v247
    v_mul_f32 v74, v74, v247
    v_mul_f32 v75, v75, v247
    v_mul_f32 v88, v88, v247
    v_mul_f32 v89, v89, v247
    v_mul_f32 v90, v90, v247
    v_mul_f32 v91, v91, v247
    v_mul_f32 v104, v104, v247
    v_mul_f32 v105, v105, v247
    v_mul_f32 v106, v106, v247
    v_mul_f32 v107, v107, v247
    v_mul_f32 v120, v120, v247
    v_mul_f32 v121, v121, v247
    v_mul_f32 v122, v122, v247
    v_mul_f32 v123, v123, v247
    v_accvgpr_read_b32 v246, a136
    v_mul_f32 v246, v246, v247
    v_accvgpr_write_b32 a136, v246
    v_max3_f32 v245, v140, v141, v142
    v_max3_f32 v246, v143, v156, v157
    v_max3_f32 v245, v245, v158, v159
    v_max_f32 v245, v245, v246
    v_mov_b32 v246, v245
    s_nop 1
    v_permlane32_swap_b32 v245, v246
    v_max_f32 v245, v245, v246
    v_mov_b32 v246, v245
    s_nop 1
    v_permlane16_swap_b32 v245, v246
    v_max3_f32 v245, v245, v246, v235
    v_sub_f32 v247, v235, v245
    v_exp_f32 v247, v247
    v_mov_b32 v235, v245
    v_sub_f32 v140, v140, v245
    v_sub_f32 v156, v156, v245
    v_sub_f32 v141, v141, v245
    v_sub_f32 v157, v157, v245
    v_sub_f32 v142, v142, v245
    v_sub_f32 v158, v158, v245
    v_sub_f32 v143, v143, v245
    v_sub_f32 v159, v159, v245
    v_exp_f32 v140, v140
    v_exp_f32 v156, v156
    v_exp_f32 v141, v141
    v_exp_f32 v157, v157
    v_exp_f32 v142, v142
    v_exp_f32 v158, v158
    v_exp_f32 v143, v143
    v_exp_f32 v159, v159
    v_cvt_pk_bf16_f32 v204, v140, v141
    v_cvt_pk_bf16_f32 v205, v142, v143
    v_cvt_pk_bf16_f32 v206, v156, v157
    v_cvt_pk_bf16_f32 v207, v158, v159
    v_mul_f32 v12, v12, v247
    v_mul_f32 v13, v13, v247
    v_mul_f32 v14, v14, v247
    v_mul_f32 v15, v15, v247
    v_mul_f32 v28, v28, v247
    v_mul_f32 v29, v29, v247
    v_mul_f32 v30, v30, v247
    v_mul_f32 v31, v31, v247
    v_mul_f32 v44, v44, v247
    v_mul_f32 v45, v45, v247
    v_mul_f32 v46, v46, v247
    v_mul_f32 v47, v47, v247
    v_mul_f32 v60, v60, v247
    v_mul_f32 v61, v61, v247
    v_mul_f32 v62, v62, v247
    v_mul_f32 v63, v63, v247
    v_mul_f32 v76, v76, v247
    v_mul_f32 v77, v77, v247
    v_mul_f32 v78, v78, v247
    v_mul_f32 v79, v79, v247
    v_mul_f32 v92, v92, v247
    v_mul_f32 v93, v93, v247
    v_mul_f32 v94, v94, v247
    v_mul_f32 v95, v95, v247
    v_mul_f32 v108, v108, v247
    v_mul_f32 v109, v109, v247
    v_mul_f32 v110, v110, v247
    v_mul_f32 v111, v111, v247
    v_mul_f32 v124, v124, v247
    v_mul_f32 v125, v125, v247
    v_mul_f32 v126, v126, v247
    v_mul_f32 v127, v127, v247
    v_accvgpr_read_b32 v246, a140
    v_mul_f32 v246, v246, v247
    v_accvgpr_write_b32 a140, v246
    s_nop 3
    v_mfma_f32_16x16x32_bf16 v[0:3], a[96:99], v[192:195], v[0:3]
    v_mfma_f32_16x16x32_bf16 v[4:7], a[96:99], v[196:199], v[4:7]
    v_mfma_f32_16x16x32_bf16 v[8:11], a[96:99], v[200:203], v[8:11]
    v_mfma_f32_16x16x32_bf16 v[12:15], a[96:99], v[204:207], v[12:15]
    v_mfma_f32_16x16x32_bf16 v[28:31], a[100:103], v[204:207], v[28:31]
    v_mfma_f32_16x16x32_bf16 v[24:27], a[100:103], v[200:203], v[24:27]
    v_mfma_f32_16x16x32_bf16 v[20:23], a[100:103], v[196:199], v[20:23]
    v_mfma_f32_16x16x32_bf16 v[16:19], a[100:103], v[192:195], v[16:19]
    v_mfma_f32_16x16x32_bf16 v[32:35], a[104:107], v[192:195], v[32:35]
    v_mfma_f32_16x16x32_bf16 v[36:39], a[104:107], v[196:199], v[36:39]
    v_mfma_f32_16x16x32_bf16 v[40:43], a[104:107], v[200:203], v[40:43]
    v_mfma_f32_16x16x32_bf16 v[44:47], a[104:107], v[204:207], v[44:47]
    v_mfma_f32_16x16x32_bf16 v[60:63], a[108:111], v[204:207], v[60:63]
    v_mfma_f32_16x16x32_bf16 v[56:59], a[108:111], v[200:203], v[56:59]
    v_mfma_f32_16x16x32_bf16 v[52:55], a[108:111], v[196:199], v[52:55]
    v_mfma_f32_16x16x32_bf16 v[48:51], a[108:111], v[192:195], v[48:51]
    v_mfma_f32_16x16x32_bf16 v[64:67], a[112:115], v[192:195], v[64:67]
    v_mfma_f32_16x16x32_bf16 v[68:71], a[112:115], v[196:199], v[68:71]
    v_mfma_f32_16x16x32_bf16 v[72:75], a[112:115], v[200:203], v[72:75]
    v_mfma_f32_16x16x32_bf16 v[76:79], a[112:115], v[204:207], v[76:79]
    v_mfma_f32_16x16x32_bf16 v[92:95], a[116:119], v[204:207], v[92:95]
    v_mfma_f32_16x16x32_bf16 v[88:91], a[116:119], v[200:203], v[88:91]
    v_mfma_f32_16x16x32_bf16 v[84:87], a[116:119], v[196:199], v[84:87]
    v_mfma_f32_16x16x32_bf16 v[80:83], a[116:119], v[192:195], v[80:83]
    v_mfma_f32_16x16x32_bf16 v[96:99], a[120:123], v[192:195], v[96:99]
    v_mfma_f32_16x16x32_bf16 v[100:103], a[120:123], v[196:199], v[100:103]
    v_mfma_f32_16x16x32_bf16 v[104:107], a[120:123], v[200:203], v[104:107]
    v_mfma_f32_16x16x32_bf16 v[108:111], a[120:123], v[204:207], v[108:111]
    v_mfma_f32_16x16x32_bf16 v[124:127], a[124:127], v[204:207], v[124:127]
    v_mfma_f32_16x16x32_bf16 v[120:123], a[124:127], v[200:203], v[120:123]
    v_mfma_f32_16x16x32_bf16 v[116:119], a[124:127], v[196:199], v[116:119]
    v_mfma_f32_16x16x32_bf16 v[112:115], a[124:127], v[192:195], v[112:115]
    v_mfma_f32_16x16x32_bf16 a[128:131], a[144:147], v[192:195], a[128:131]
    v_mfma_f32_16x16x32_bf16 a[132:135], a[144:147], v[196:199], a[132:135]
    v_mfma_f32_16x16x32_bf16 a[136:139], a[144:147], v[200:203], a[136:139]
    v_mfma_f32_16x16x32_bf16 a[140:143], a[144:147], v[204:207], a[140:143]
    s_nop 15
    s_add_u32 s47, s47, 8192
    s_add_u32 s48, s48, 8192
    s_sub_u32 s44, s44, 1
    s_cmp_lg_u32 s44, 0
    s_cbranch_scc1 pa_sl
    v_accvgpr_read_b32 v224, a128
    v_accvgpr_read_b32 v228, a132
    v_accvgpr_read_b32 v232, a136
    v_accvgpr_read_b32 v236, a140
    v_rcp_f32 v226, v224
    v_rcp_f32 v230, v228
    v_rcp_f32 v234, v232
    v_rcp_f32 v238, v236
    v_fma_f32 v225, -v224, v226, 2.0
    v_mul_f32 v226, v225, v226
    v_mov_b32 v227, v226
    v_fma_f32 v229, -v228, v230, 2.0
    v_mul_f32 v230, v229, v230
    v_mov_b32 v231, v230
    v_fma_f32 v233, -v232, v234, 2.0
    v_mul_f32 v234, v233, v234
    v_mov_b32 v235, v234
    v_fma_f32 v237, -v236, v238, 2.0
    v_mul_f32 v238, v237, v238
    v_mov_b32 v239, v238
    v_pk_mul_f32 v[0:1], v[0:1], v[226:227]
    v_pk_mul_f32 v[16:17], v[16:17], v[226:227]
    v_pk_mul_f32 v[2:3], v[2:3], v[226:227]
    v_pk_mul_f32 v[18:19], v[18:19], v[226:227]
    v_cvt_pk_bf16_f32 v0, v0, v1
    v_cvt_pk_bf16_f32 v1, v2, v3
    v_cvt_pk_bf16_f32 v2, v16, v17
    v_cvt_pk_bf16_f32 v3, v18, v19
    s_add_u32 s40, s49, 0
    buffer_store_dwordx4 v[0:3], v244, s[16:19], s40 offen sc1
    v_pk_mul_f32 v[32:33], v[32:33], v[226:227]
    v_pk_mul_f32 v[48:49], v[48:49], v[226:227]
    v_pk_mul_f32 v[34:35], v[34:35], v[226:227]
    v_pk_mul_f32 v[50:51], v[50:51], v[226:227]
    v_cvt_pk_bf16_f32 v32, v32, v33
    v_cvt_pk_bf16_f32 v33, v34, v35
    v_cvt_pk_bf16_f32 v34, v48, v49
    v_cvt_pk_bf16_f32 v35, v50, v51
    s_add_u32 s40, s49, 2048
    buffer_store_dwordx4 v[32:35], v244, s[16:19], s40 offen sc1
    v_pk_mul_f32 v[64:65], v[64:65], v[226:227]
    v_pk_mul_f32 v[80:81], v[80:81], v[226:227]
    v_pk_mul_f32 v[66:67], v[66:67], v[226:227]
    v_pk_mul_f32 v[82:83], v[82:83], v[226:227]
    v_cvt_pk_bf16_f32 v64, v64, v65
    v_cvt_pk_bf16_f32 v65, v66, v67
    v_cvt_pk_bf16_f32 v66, v80, v81
    v_cvt_pk_bf16_f32 v67, v82, v83
    s_add_u32 s40, s49, 4096
    buffer_store_dwordx4 v[64:67], v244, s[16:19], s40 offen sc1
    v_pk_mul_f32 v[96:97], v[96:97], v[226:227]
    v_pk_mul_f32 v[112:113], v[112:113], v[226:227]
    v_pk_mul_f32 v[98:99], v[98:99], v[226:227]
    v_pk_mul_f32 v[114:115], v[114:115], v[226:227]
    v_cvt_pk_bf16_f32 v96, v96, v97
    v_cvt_pk_bf16_f32 v97, v98, v99
    v_cvt_pk_bf16_f32 v98, v112, v113
    v_cvt_pk_bf16_f32 v99, v114, v115
    s_add_u32 s40, s49, 6144
    buffer_store_dwordx4 v[96:99], v244, s[16:19], s40 offen sc1
    v_pk_mul_f32 v[4:5], v[4:5], v[230:231]
    v_pk_mul_f32 v[20:21], v[20:21], v[230:231]
    v_pk_mul_f32 v[6:7], v[6:7], v[230:231]
    v_pk_mul_f32 v[22:23], v[22:23], v[230:231]
    v_cvt_pk_bf16_f32 v4, v4, v5
    v_cvt_pk_bf16_f32 v5, v6, v7
    v_cvt_pk_bf16_f32 v6, v20, v21
    v_cvt_pk_bf16_f32 v7, v22, v23
    s_add_u32 s40, s49, 1024
    buffer_store_dwordx4 v[4:7], v244, s[16:19], s40 offen sc1
    v_pk_mul_f32 v[36:37], v[36:37], v[230:231]
    v_pk_mul_f32 v[52:53], v[52:53], v[230:231]
    v_pk_mul_f32 v[38:39], v[38:39], v[230:231]
    v_pk_mul_f32 v[54:55], v[54:55], v[230:231]
    v_cvt_pk_bf16_f32 v36, v36, v37
    v_cvt_pk_bf16_f32 v37, v38, v39
    v_cvt_pk_bf16_f32 v38, v52, v53
    v_cvt_pk_bf16_f32 v39, v54, v55
    s_add_u32 s40, s49, 3072
    buffer_store_dwordx4 v[36:39], v244, s[16:19], s40 offen sc1
    v_pk_mul_f32 v[68:69], v[68:69], v[230:231]
    v_pk_mul_f32 v[84:85], v[84:85], v[230:231]
    v_pk_mul_f32 v[70:71], v[70:71], v[230:231]
    v_pk_mul_f32 v[86:87], v[86:87], v[230:231]
    v_cvt_pk_bf16_f32 v68, v68, v69
    v_cvt_pk_bf16_f32 v69, v70, v71
    v_cvt_pk_bf16_f32 v70, v84, v85
    v_cvt_pk_bf16_f32 v71, v86, v87
    s_add_u32 s40, s49, 5120
    buffer_store_dwordx4 v[68:71], v244, s[16:19], s40 offen sc1
    v_pk_mul_f32 v[100:101], v[100:101], v[230:231]
    v_pk_mul_f32 v[116:117], v[116:117], v[230:231]
    v_pk_mul_f32 v[102:103], v[102:103], v[230:231]
    v_pk_mul_f32 v[118:119], v[118:119], v[230:231]
    v_cvt_pk_bf16_f32 v100, v100, v101
    v_cvt_pk_bf16_f32 v101, v102, v103
    v_cvt_pk_bf16_f32 v102, v116, v117
    v_cvt_pk_bf16_f32 v103, v118, v119
    s_add_u32 s40, s49, 7168
    buffer_store_dwordx4 v[100:103], v244, s[16:19], s40 offen sc1
    v_pk_mul_f32 v[8:9], v[8:9], v[234:235]
    v_pk_mul_f32 v[24:25], v[24:25], v[234:235]
    v_pk_mul_f32 v[10:11], v[10:11], v[234:235]
    v_pk_mul_f32 v[26:27], v[26:27], v[234:235]
    v_cvt_pk_bf16_f32 v8, v8, v9
    v_cvt_pk_bf16_f32 v9, v10, v11
    v_cvt_pk_bf16_f32 v10, v24, v25
    v_cvt_pk_bf16_f32 v11, v26, v27
    s_add_u32 s40, s49, 270336
    buffer_store_dwordx4 v[8:11], v244, s[16:19], s40 offen sc1
    v_pk_mul_f32 v[40:41], v[40:41], v[234:235]
    v_pk_mul_f32 v[56:57], v[56:57], v[234:235]
    v_pk_mul_f32 v[42:43], v[42:43], v[234:235]
    v_pk_mul_f32 v[58:59], v[58:59], v[234:235]
    v_cvt_pk_bf16_f32 v40, v40, v41
    v_cvt_pk_bf16_f32 v41, v42, v43
    v_cvt_pk_bf16_f32 v42, v56, v57
    v_cvt_pk_bf16_f32 v43, v58, v59
    s_add_u32 s40, s49, 272384
    buffer_store_dwordx4 v[40:43], v244, s[16:19], s40 offen sc1
    v_pk_mul_f32 v[72:73], v[72:73], v[234:235]
    v_pk_mul_f32 v[88:89], v[88:89], v[234:235]
    v_pk_mul_f32 v[74:75], v[74:75], v[234:235]
    v_pk_mul_f32 v[90:91], v[90:91], v[234:235]
    v_cvt_pk_bf16_f32 v72, v72, v73
    v_cvt_pk_bf16_f32 v73, v74, v75
    v_cvt_pk_bf16_f32 v74, v88, v89
    v_cvt_pk_bf16_f32 v75, v90, v91
    s_add_u32 s40, s49, 274432
    buffer_store_dwordx4 v[72:75], v244, s[16:19], s40 offen sc1
    v_pk_mul_f32 v[104:105], v[104:105], v[234:235]
    v_pk_mul_f32 v[120:121], v[120:121], v[234:235]
    v_pk_mul_f32 v[106:107], v[106:107], v[234:235]
    v_pk_mul_f32 v[122:123], v[122:123], v[234:235]
    v_cvt_pk_bf16_f32 v104, v104, v105
    v_cvt_pk_bf16_f32 v105, v106, v107
    v_cvt_pk_bf16_f32 v106, v120, v121
    v_cvt_pk_bf16_f32 v107, v122, v123
    s_add_u32 s40, s49, 276480
    buffer_store_dwordx4 v[104:107], v244, s[16:19], s40 offen sc1
    v_pk_mul_f32 v[12:13], v[12:13], v[238:239]
    v_pk_mul_f32 v[28:29], v[28:29], v[238:239]
    v_pk_mul_f32 v[14:15], v[14:15], v[238:239]
    v_pk_mul_f32 v[30:31], v[30:31], v[238:239]
    v_cvt_pk_bf16_f32 v12, v12, v13
    v_cvt_pk_bf16_f32 v13, v14, v15
    v_cvt_pk_bf16_f32 v14, v28, v29
    v_cvt_pk_bf16_f32 v15, v30, v31
    s_add_u32 s40, s49, 271360
    buffer_store_dwordx4 v[12:15], v244, s[16:19], s40 offen sc1
    v_pk_mul_f32 v[44:45], v[44:45], v[238:239]
    v_pk_mul_f32 v[60:61], v[60:61], v[238:239]
    v_pk_mul_f32 v[46:47], v[46:47], v[238:239]
    v_pk_mul_f32 v[62:63], v[62:63], v[238:239]
    v_cvt_pk_bf16_f32 v44, v44, v45
    v_cvt_pk_bf16_f32 v45, v46, v47
    v_cvt_pk_bf16_f32 v46, v60, v61
    v_cvt_pk_bf16_f32 v47, v62, v63
    s_add_u32 s40, s49, 273408
    buffer_store_dwordx4 v[44:47], v244, s[16:19], s40 offen sc1
    v_pk_mul_f32 v[76:77], v[76:77], v[238:239]
    v_pk_mul_f32 v[92:93], v[92:93], v[238:239]
    v_pk_mul_f32 v[78:79], v[78:79], v[238:239]
    v_pk_mul_f32 v[94:95], v[94:95], v[238:239]
    v_cvt_pk_bf16_f32 v76, v76, v77
    v_cvt_pk_bf16_f32 v77, v78, v79
    v_cvt_pk_bf16_f32 v78, v92, v93
    v_cvt_pk_bf16_f32 v79, v94, v95
    s_add_u32 s40, s49, 275456
    buffer_store_dwordx4 v[76:79], v244, s[16:19], s40 offen sc1
    v_pk_mul_f32 v[108:109], v[108:109], v[238:239]
    v_pk_mul_f32 v[124:125], v[124:125], v[238:239]
    v_pk_mul_f32 v[110:111], v[110:111], v[238:239]
    v_pk_mul_f32 v[126:127], v[126:127], v[238:239]
    v_cvt_pk_bf16_f32 v108, v108, v109
    v_cvt_pk_bf16_f32 v109, v110, v111
    v_cvt_pk_bf16_f32 v110, v124, v125
    v_cvt_pk_bf16_f32 v111, v126, v127
    s_add_u32 s40, s49, 277504
    buffer_store_dwordx4 v[108:111], v244, s[16:19], s40 offen sc1
    s_branch pa_oend
pa_done:
    s_endpgm
code_end_label:
    s_endpgm
.section .rodata,"a"
.p2align 6
.amdhsa_kernel pa_kernel
  .amdhsa_next_free_vgpr 512
  .amdhsa_next_free_sgpr 102
  .amdhsa_accum_offset 256
  .amdhsa_group_segment_fixed_size 0
  .amdhsa_kernarg_size 104
  .amdhsa_user_sgpr_count 2
  .amdhsa_user_sgpr_kernarg_segment_ptr 1
  .amdhsa_system_sgpr_workgroup_id_x 1
  .amdhsa_float_denorm_mode_32 3
  .amdhsa_float_denorm_mode_16_64 3
.end_amdhsa_kernel
```
